```python
import torch

def _softmax(x, axis=-1):
    return torch.softmax(x, dim=axis)
def _gelu(x):
    return torch.nn.functional.gelu(x, approximate="tanh")
def _silu(x):
    return torch.nn.functional.silu(x)
def _sigmoid(x):
    return torch.sigmoid(x)
def _layernorm(x, axis=-1, eps=1e-5):
    m = x.mean(dim=axis, keepdim=True)
    v = x.var(dim=axis, keepdim=True, unbiased=False)
    return (x - m) / torch.sqrt(v + eps)
def _scatter_add(tgt, idx, src, axis=0):
    return tgt.clone().index_add_(axis, idx, src)
def _segment_sum(src, seg, n):
    out = torch.zeros((n,) + src.shape[1:], dtype=src.dtype)
    return out.index_add_(0, seg, src)
def _pad(x, pw):
    flat = tuple(v for pair in reversed(pw) for v in pair)
    return torch.nn.functional.pad(x, flat)

kernel_name = 'concat_heads__gqa_block_cached__gqa_block_cached__near_ridge'

def setup_inputs():

    _w = (lambda a: (lambda t: t.to(torch.bfloat16) if t.is_floating_point() else t)(torch.as_tensor(a)))
    def _A_setup():
        B, Sq, D = 8, 144, 512
        Hq, Hkv, Sk, Dh = 32, 32, 1024, 128
        assert Hq % Hkv == 0, (Hq, Hkv)
        return {
            "x": _w((lambda *s: torch.randn(*s, dtype=torch.bfloat16) * 0.8)(B, Sq, D)),
            "k_cache": _w((lambda *s: torch.randn(*s, dtype=torch.bfloat16) * 0.8)(B, Hkv, Sk, Dh)),
            "v_cache": _w((lambda *s: torch.randn(*s, dtype=torch.bfloat16) * 0.05)(B, Hkv, Sk, Dh)),
            "wq": _w((lambda *s: torch.randn(*s, dtype=torch.bfloat16) * 0.8)(D, Hq * Dh) * (D ** -0.5)),
            "wo": _w((lambda *s: torch.randn(*s, dtype=torch.bfloat16) * 0.05)(Hq * Dh, D) * ((Hq * Dh) ** -0.5)),
        }
    _A_in = _A_setup()

    def _B_setup():
        B, Sq, D = 8, 144, 512
        Hq, Hkv, Sk, Dh = 32, 32, 1024, 128
        assert Hq % Hkv == 0, (Hq, Hkv)
        return {
            "x": _w((lambda *s: torch.randn(*s, dtype=torch.bfloat16) * 0.8)(B, Sq, D)),
            "k_cache": _w((lambda *s: torch.randn(*s, dtype=torch.bfloat16) * 0.8)(B, Hkv, Sk, Dh)),
            "v_cache": _w((lambda *s: torch.randn(*s, dtype=torch.bfloat16) * 0.05)(B, Hkv, Sk, Dh)),
            "wq": _w((lambda *s: torch.randn(*s, dtype=torch.bfloat16) * 0.8)(D, Hq * Dh) * (D ** -0.5)),
            "wo": _w((lambda *s: torch.randn(*s, dtype=torch.bfloat16) * 0.05)(Hq * Dh, D) * ((Hq * Dh) ** -0.5)),
        }
    _B_in = _B_setup()

    return {
        "A_x": _A_in["x"],
        "A_k_cache": _A_in["k_cache"],
        "A_v_cache": _A_in["v_cache"],
        "A_wq": _A_in["wq"],
        "A_wo": _A_in["wo"],
        "B_x": _B_in["x"],
        "B_k_cache": _B_in["k_cache"],
        "B_v_cache": _B_in["v_cache"],
        "B_wq": _B_in["wq"],
        "B_wo": _B_in["wo"],
    }

def reference(A_x, A_k_cache, A_v_cache, A_wq, A_wo, B_x, B_k_cache, B_v_cache, B_wq, B_wo):
    def _A_ref(x, k_cache, v_cache, wq, wo):
        B, Sq, D = x.shape
        Hq, Dh = 32, 128
        Hkv = k_cache.shape[1]
        rep = Hq // Hkv
        q = (lambda x, *d: x.permute(*d))((x @ wq).reshape(B, Sq, Hq, Dh), 0, 2, 1, 3)
        k = (lambda x, n, axis: torch.repeat_interleave(x, n, dim=axis))(k_cache, rep, axis=1)
        v = (lambda x, n, axis: torch.repeat_interleave(x, n, dim=axis))(v_cache, rep, axis=1)
        scores = torch.einsum("bhqd,bhkd->bhqk", q, k) * (Dh ** -0.5)
        p = _softmax(scores, axis=-1)
        o = torch.einsum("bhqk,bhkd->bhqd", p, v)
        return (lambda x, *d: x.permute(*d))(o, 0, 2, 1, 3).reshape(B, Sq, Hq * Dh) @ wo

    def _B_ref(x, k_cache, v_cache, wq, wo):
        B, Sq, D = x.shape
        Hq, Dh = 32, 128
        Hkv = k_cache.shape[1]
        rep = Hq // Hkv
        q = (lambda x, *d: x.permute(*d))((x @ wq).reshape(B, Sq, Hq, Dh), 0, 2, 1, 3)
        k = (lambda x, n, axis: torch.repeat_interleave(x, n, dim=axis))(k_cache, rep, axis=1)
        v = (lambda x, n, axis: torch.repeat_interleave(x, n, dim=axis))(v_cache, rep, axis=1)
        scores = torch.einsum("bhqd,bhkd->bhqk", q, k) * (Dh ** -0.5)
        p = _softmax(scores, axis=-1)
        o = torch.einsum("bhqk,bhkd->bhqd", p, v)
        return (lambda x, *d: x.permute(*d))(o, 0, 2, 1, 3).reshape(B, Sq, Hq * Dh) @ wo

    a = _A_ref(A_x, A_k_cache, A_v_cache, A_wq, A_wo)
    b = _B_ref(B_x, B_k_cache, B_v_cache, B_wq, B_wo)
    return torch.concatenate([a, b], axis=-1)
```

```asm
; @launch grid=(256,1,1) block=(512,1,1) lds=163840
.amdgcn_target "amdgcn-amd-amdhsa--gfx950"
.text
.globl concat_heads__gqa_block_cached__gqa_block_cached__near_ridge_kernel
.p2align 8
.type concat_heads__gqa_block_cached__gqa_block_cached__near_ridge_kernel,@function
concat_heads__gqa_block_cached__gqa_block_cached__near_ridge_kernel:
L_kstart:
  s_cmp_ge_u32 s2, 256
  s_cbranch_scc1 L_end
  s_load_dwordx8 s[48:55], s[0:1], 0
  s_load_dwordx8 s[56:63], s[0:1], 40
  s_load_dwordx2 s[24:25], s[0:1], 96
  v_lshrrev_b32 v1, 6, v0
  v_and_b32 v2, 63, v0
  s_and_b32 s3, s2, 7
  v_readfirstlane_b32 s28, v1
  s_lshr_b32 s4, s2, 3
  s_lshr_b32 s29, s3, 2
  s_and_b32 s5, s3, 3
  s_lshl_b32 s5, s5, 3
  s_and_b32 s6, s4, 7
  s_add_u32 s30, s5, s6
  s_lshr_b32 s31, s4, 3
  s_lshl_b32 s5, s31, 5
  s_add_u32 s5, s5, s30
  s_lshl_b32 s36, s5, 18
  s_lshl_b32 s37, s30, 8
  v_lshlrev_b32 v253, 4, v2
  v_lshrrev_b32 v3, 4, v2
  v_and_b32 v4, 15, v2
  s_mov_b32 s10, 0x4000000
  s_mov_b32 s11, 0x20000
  s_mov_b32 s14, 0x4000000
  s_mov_b32 s15, 0x20000
  s_mov_b32 s18, 0x400000
  s_mov_b32 s19, 0x20000
  s_mov_b32 s22, 1179648
  s_mov_b32 s23, 0x20000
  s_mov_b32 s26, 287571968
  s_mov_b32 s27, 0x20000
  s_and_b32 s32, s28, 3
  s_cmp_eq_u32 s32, 0
  s_cbranch_scc1 L_loader
  s_sub_u32 s32, s32, 1
  s_cmp_lt_u32 s28, 4
  s_cbranch_scc1 L_teamA
  s_mov_b32 s33, 1
  s_lshl_b32 s6, s31, 1
  s_add_u32 s68, s6, s30
  s_and_b32 s68, s68, 7
  s_lshl_b32 s70, s68, 1
  s_mul_i32 s5, s32, 5
  s_add_u32 s5, s5, 1
  s_lshr_b32 s5, s5, 1
  s_lshl_b32 s69, s5, 10
  v_lshlrev_b32 v5, 1, v3
  v_xor_b32 v5, v5, v4
  v_lshlrev_b32 v5, 4, v5
  v_lshlrev_b32 v6, 13, v3
  v_add_u32 v14, v5, v6
  v_xor_b32 v15, 0x80, v14
  s_add_u32 s6, s5, 0
  s_lshl_b32 s7, s6, 6
  s_and_b32 s7, s7, 0x80
  s_lshl_b32 s6, s6, 15
  s_sub_u32 s6, s6, 0
  v_xor_b32 v192, s7, v14
  v_add_u32 v192, s6, v192
  s_add_u32 s6, s5, 1
  s_lshl_b32 s7, s6, 6
  s_and_b32 s7, s7, 0x80
  s_lshl_b32 s6, s6, 15
  s_sub_u32 s6, s6, 1024
  v_xor_b32 v193, s7, v14
  v_add_u32 v193, s6, v193
  s_add_u32 s6, s5, 2
  s_lshl_b32 s7, s6, 6
  s_and_b32 s7, s7, 0x80
  s_lshl_b32 s6, s6, 15
  s_sub_u32 s6, s6, 2048
  v_xor_b32 v194, s7, v14
  v_add_u32 v194, s6, v194
  s_mul_i32 s71, s32, 6144
  s_mul_i32 s6, s31, 147456
  s_mul_i32 s7, s32, 49152
  s_add_u32 s96, s6, s7
  s_lshl_b32 s97, s68, 7
  v_lshrrev_b32 v5, 3, v2
  v_lshlrev_b32 v5, 10, v5
  v_and_b32 v6, 7, v2
  v_xor_b32 v6, v6, v3
  v_lshlrev_b32 v6, 4, v6
  v_add_u32 v8, v5, v6
  v_xor_b32 v9, 0x40, v8
  v_add_u32 v10, 14336, v8
  v_add_u32 v11, 21504, v9
  v_add_u32 v12, 32768, v8
  v_add_u32 v13, 39936, v9
  v_add_u32 v9, 7168, v9
  s_cmp_eq_u32 s29, 0
  s_waitcnt lgkmcnt(0)
  s_cselect_b64 s[20:21], s[48:49], s[56:57]
  s_cselect_b64 s[8:9], s[50:51], s[58:59]
  s_cselect_b64 s[12:13], s[52:53], s[60:61]
  s_cselect_b64 s[16:17], s[54:55], s[62:63]
  s_lshl_b32 s4, s70, 18
  s_add_u32 s4, s4, s37
  s_add_u32 m0, s69, 131072
  s_add_u32 s70, s70, 1
  s_and_b32 s70, s70, 15
  buffer_load_dwordx4 v192, s[16:19], s4 offen lds
  buffer_load_dwordx4 v193, s[16:19], s4 offen offset:1024 lds
  buffer_load_dwordx4 v194, s[16:19], s4 offen offset:2048 lds
  s_lshl_b32 s4, s70, 18
  s_add_u32 s4, s4, s37
  s_add_u32 m0, s69, 139264
  s_add_u32 s70, s70, 1
  s_and_b32 s70, s70, 15
  buffer_load_dwordx4 v192, s[16:19], s4 offen lds
  buffer_load_dwordx4 v193, s[16:19], s4 offen offset:1024 lds
  buffer_load_dwordx4 v194, s[16:19], s4 offen offset:2048 lds
  s_add_u32 s4, s96, s97
  s_add_u32 s97, s97, 128
  s_and_b32 s97, s97, 1023
  s_add_u32 m0, s71, 16384
  s_nop 0
  buffer_load_dwordx4 v8, s[20:23], s4 offen lds
  buffer_load_dwordx4 v9, s[20:23], s4 offen offset:1024 lds
  buffer_load_dwordx4 v10, s[20:23], s4 offen offset:2048 lds
  buffer_load_dwordx4 v11, s[20:23], s4 offen offset:3072 lds
  s_add_u32 m0, s71, 20480
  s_nop 0
  buffer_load_dwordx4 v12, s[20:23], s4 offen lds
  buffer_load_dwordx4 v13, s[20:23], s4 offen offset:1024 lds
  s_barrier
  s_lshl_b32 s4, s70, 18
  s_add_u32 s4, s4, s37
  s_add_u32 m0, s69, 81920
  s_add_u32 s70, s70, 1
  s_and_b32 s70, s70, 15
  buffer_load_dwordx4 v192, s[16:19], s4 offen lds
  buffer_load_dwordx4 v193, s[16:19], s4 offen offset:1024 lds
  buffer_load_dwordx4 v194, s[16:19], s4 offen offset:2048 lds
  s_lshl_b32 s4, s70, 18
  s_add_u32 s4, s4, s37
  s_add_u32 m0, s69, 90112
  s_add_u32 s70, s70, 1
  s_and_b32 s70, s70, 15
  buffer_load_dwordx4 v192, s[16:19], s4 offen lds
  buffer_load_dwordx4 v193, s[16:19], s4 offen offset:1024 lds
  buffer_load_dwordx4 v194, s[16:19], s4 offen offset:2048 lds
  s_add_u32 s4, s96, s97
  s_add_u32 s97, s97, 128
  s_and_b32 s97, s97, 1023
  s_add_u32 m0, s71, 34816
  s_nop 0
  buffer_load_dwordx4 v8, s[20:23], s4 offen lds
  buffer_load_dwordx4 v9, s[20:23], s4 offen offset:1024 lds
  buffer_load_dwordx4 v10, s[20:23], s4 offen offset:2048 lds
  buffer_load_dwordx4 v11, s[20:23], s4 offen offset:3072 lds
  s_add_u32 m0, s71, 38912
  s_nop 0
  buffer_load_dwordx4 v12, s[20:23], s4 offen lds
  buffer_load_dwordx4 v13, s[20:23], s4 offen offset:1024 lds
  s_waitcnt vmcnt(12)
  s_barrier
  s_add_u32 s4, s96, s97
  s_add_u32 s97, s97, 128
  s_and_b32 s97, s97, 1023
  s_add_u32 m0, s71, 53248
  s_nop 0
  buffer_load_dwordx4 v8, s[20:23], s4 offen lds
  buffer_load_dwordx4 v9, s[20:23], s4 offen offset:1024 lds
  buffer_load_dwordx4 v10, s[20:23], s4 offen offset:2048 lds
  buffer_load_dwordx4 v11, s[20:23], s4 offen offset:3072 lds
  s_add_u32 m0, s71, 57344
  s_nop 0
  buffer_load_dwordx4 v12, s[20:23], s4 offen lds
  buffer_load_dwordx4 v13, s[20:23], s4 offen offset:1024 lds
  s_lshl_b32 s4, s70, 18
  s_add_u32 s4, s4, s37
  s_add_u32 m0, s69, 98304
  s_add_u32 s70, s70, 1
  s_and_b32 s70, s70, 15
  buffer_load_dwordx4 v192, s[16:19], s4 offen lds
  buffer_load_dwordx4 v193, s[16:19], s4 offen offset:1024 lds
  buffer_load_dwordx4 v194, s[16:19], s4 offen offset:2048 lds
  s_lshl_b32 s4, s70, 18
  s_add_u32 s4, s4, s37
  s_add_u32 m0, s69, 106496
  s_add_u32 s70, s70, 1
  s_and_b32 s70, s70, 15
  buffer_load_dwordx4 v192, s[16:19], s4 offen lds
  buffer_load_dwordx4 v193, s[16:19], s4 offen offset:1024 lds
  buffer_load_dwordx4 v194, s[16:19], s4 offen offset:2048 lds
  s_add_u32 s45, s31, 4
  s_mul_i32 s6, s45, 147456
  s_mul_i32 s7, s32, 49152
  s_add_u32 s38, s6, s7
  s_add_u32 s39, s38, 16384
  s_add_u32 s40, s38, 32768
  s_lshl_b32 s99, s68, 7
  v_lshrrev_b32 v5, 3, v2
  v_lshlrev_b32 v5, 10, v5
  v_and_b32 v6, 7, v2
  v_xor_b32 v6, v6, v3
  v_lshlrev_b32 v6, 4, v6
  v_add_u32 v198, v5, v6
  v_xor_b32 v199, 0x40, v198
  v_add_u32 v199, 8192, v199
  s_lshl_b32 s6, s29, 3
  s_add_u32 s6, s6, s45
  s_lshl_b32 s6, s6, 5
  s_add_u32 s6, s6, s30
  s_mul_i32 s6, s6, 9
  s_mul_i32 s7, s32, 3
  s_add_u32 s6, s6, s7
  s_lshl_b32 s44, s6, 12
  s_mov_b32 s46, 0x3e0293ee
  s_mov_b32 s47, 0x3e0293ee
  v_and_b32 v5, 7, v4
  v_lshlrev_b32 v5, 1, v5
  v_xor_b32 v5, v5, v3
  v_lshlrev_b32 v5, 4, v5
  v_lshlrev_b32 v6, 8, v4
  v_add_u32 v232, v5, v6
  v_xor_b32 v233, 0x40, v232
  v_xor_b32 v234, 0x80, v232
  v_xor_b32 v235, 0xc0, v232
  v_lshrrev_b32 v7, 2, v4
  v_and_b32 v1, 3, v4
  v_lshlrev_b32 v5, 2, v3
  v_add_u32 v5, v5, v7
  v_and_b32 v6, 7, v5
  v_lshlrev_b32 v6, 5, v6
  v_lshlrev_b32 v5, 8, v5
  v_add_u32 v5, v5, v6
  v_lshlrev_b32 v6, 3, v1
  v_add_u32 v5, v5, v6
  v_add_u32 v236, 65536, v5
  v_xor_b32 v237, 32, v236
  v_xor_b32 v238, 64, v236
  v_xor_b32 v239, 96, v236
  v_xor_b32 v240, 128, v236
  v_xor_b32 v241, 160, v236
  v_xor_b32 v242, 192, v236
  v_xor_b32 v243, 224, v236
  v_and_b32 v5, 1, v3
  v_lshlrev_b32 v5, 2, v5
  v_or_b32 v5, v5, v7
  v_lshlrev_b32 v5, 1, v5
  v_xor_b32 v5, v5, v1
  v_lshlrev_b32 v5, 4, v5
  v_lshlrev_b32 v6, 3, v3
  v_add_u32 v6, v6, v7
  v_lshlrev_b32 v6, 8, v6
  v_add_u32 v244, v5, v6
  v_add_u32 v244, 131072, v244
  s_lshl_b32 s6, s32, 11
  s_add_u32 s6, s6, 155648
  v_add_u32 v202, s6, v253
  v_lshrrev_b32 v5, 1, v4
  v_xor_b32 v5, v5, v3
  v_lshlrev_b32 v5, 4, v5
  v_lshlrev_b32 v6, 7, v4
  v_add_u32 v200, v5, v6
  v_add_u32 v200, s6, v200
  v_xor_b32 v201, 0x40, v200
  v_xor_b32 v245, 0x40, v244
  v_xor_b32 v246, 0x80, v244
  v_xor_b32 v247, 0xc0, v244
  v_mov_b32 v228, 0x3f803f80
  v_mov_b32 v229, 0x3f803f80
  v_mov_b32 v230, 0x3f803f80
  v_mov_b32 v231, 0x3f803f80
  s_waitcnt vmcnt(12)
  s_barrier
  s_add_u32 s4, s96, s97
  s_add_u32 s97, s97, 128
  s_and_b32 s97, s97, 1023
  s_add_u32 m0, s71, 16384
  s_nop 0
  buffer_load_dwordx4 v8, s[20:23], s4 offen lds
  buffer_load_dwordx4 v9, s[20:23], s4 offen offset:1024 lds
  buffer_load_dwordx4 v10, s[20:23], s4 offen offset:2048 lds
  buffer_load_dwordx4 v11, s[20:23], s4 offen offset:3072 lds
  s_add_u32 m0, s71, 20480
  s_nop 0
  buffer_load_dwordx4 v12, s[20:23], s4 offen lds
  buffer_load_dwordx4 v13, s[20:23], s4 offen offset:1024 lds
  s_lshl_b32 s4, s70, 18
  s_add_u32 s4, s4, s37
  s_add_u32 m0, s69, 114688
  s_add_u32 s70, s70, 1
  s_and_b32 s70, s70, 15
  buffer_load_dwordx4 v192, s[16:19], s4 offen lds
  buffer_load_dwordx4 v193, s[16:19], s4 offen offset:1024 lds
  buffer_load_dwordx4 v194, s[16:19], s4 offen offset:2048 lds
  s_lshl_b32 s4, s70, 18
  s_add_u32 s4, s4, s37
  s_add_u32 m0, s69, 122880
  s_add_u32 s70, s70, 1
  s_and_b32 s70, s70, 15
  buffer_load_dwordx4 v192, s[16:19], s4 offen lds
  buffer_load_dwordx4 v193, s[16:19], s4 offen offset:1024 lds
  buffer_load_dwordx4 v194, s[16:19], s4 offen offset:2048 lds
  s_load_dwordx4 s[52:55], s[0:1], 80
  s_and_b32 s61, s30, 7
  s_lshr_b32 s62, s30, 3
  s_mul_i32 s4, s61, 36864
  s_sub_u32 s60, s44, s4
  s_lshl_b32 s4, s33, 3
  s_and_b32 s5, s2, 7
  s_add_u32 s4, s4, s5
  s_lshl_b32 s4, s4, 2
  s_add_u32 s4, s4, s31
  s_mul_i32 s4, s4, 3
  s_add_u32 s4, s4, s32
  s_lshl_b32 s4, s4, 7
  s_add_u32 s64, s4, 48234496
  s_lshl_b32 s4, s61, 3
  s_add_u32 s65, s64, s4
  s_lshl_b32 s4, s33, 1
  s_add_u32 s4, s4, s29
  s_lshl_b32 s4, s4, 2
  s_add_u32 s4, s4, s31
  s_lshl_b32 s4, s4, 3
  s_add_u32 s4, s4, s61
  s_mul_i32 s5, s4, 3
  s_add_u32 s5, s5, s32
  s_lshl_b32 s5, s5, 7
  s_add_u32 s66, s5, 48300032
  s_lshl_b32 s5, s62, 3
  s_add_u32 s67, s66, s5
  s_lshl_b32 s4, s4, 17
  s_lshl_b32 s5, s32, 11
  s_add_u32 s4, s4, s5
  s_mov_b32 s101, 4096
  s_mov_b32 s88, 32768
  s_mul_i32 s89, s32, 48
  s_mov_b32 s90, 3
  s_add_u32 s98, s4, 20971520
  s_lshl_b32 s5, s31, 1
  s_sub_u32 s5, s61, s5
  s_add_u32 s4, s5, 0
  s_and_b32 s4, s4, 7
  s_lshl_b32 s4, s4, 2
  s_lshr_b32 s4, 0x36251098, s4
  s_and_b32 s4, s4, 15
  s_lshl_b32 s72, s4, 14
  s_add_u32 s4, s5, 1
  s_and_b32 s4, s4, 7
  s_lshl_b32 s4, s4, 2
  s_lshr_b32 s4, 0x36251098, s4
  s_and_b32 s4, s4, 15
  s_lshl_b32 s73, s4, 14
  s_add_u32 s4, s5, 2
  s_and_b32 s4, s4, 7
  s_lshl_b32 s4, s4, 2
  s_lshr_b32 s4, 0x36251098, s4
  s_and_b32 s4, s4, 15
  s_lshl_b32 s74, s4, 14
  s_add_u32 s4, s5, 3
  s_and_b32 s4, s4, 7
  s_lshl_b32 s4, s4, 2
  s_lshr_b32 s4, 0x36251098, s4
  s_and_b32 s4, s4, 15
  s_lshl_b32 s75, s4, 14
  s_add_u32 s4, s5, 4
  s_and_b32 s4, s4, 7
  s_lshl_b32 s4, s4, 2
  s_lshr_b32 s4, 0x36251098, s4
  s_and_b32 s4, s4, 15
  s_lshl_b32 s76, s4, 14
  s_add_u32 s4, s5, 5
  s_and_b32 s4, s4, 7
  s_lshl_b32 s4, s4, 2
  s_lshr_b32 s4, 0x36251098, s4
  s_and_b32 s4, s4, 15
  s_lshl_b32 s77, s4, 14
  s_add_u32 s4, s5, 6
  s_and_b32 s4, s4, 7
  s_lshl_b32 s4, s4, 2
  s_lshr_b32 s4, 0x36251098, s4
  s_and_b32 s4, s4, 15
  s_lshl_b32 s78, s4, 14
  s_add_u32 s4, s5, 7
  s_and_b32 s4, s4, 7
  s_lshl_b32 s4, s4, 2
  s_lshr_b32 s4, 0x36251098, s4
  s_and_b32 s4, s4, 15
  s_lshl_b32 s79, s4, 14
  s_waitcnt lgkmcnt(0)
  s_mov_b64 s[56:57], s[54:55]
  s_mov_b32 s54, 2359296
  s_mov_b32 s55, 0x20000
  s_waitcnt vmcnt(12)
  s_barrier
  s_add_u32 s4, s96, s97
  s_add_u32 s97, s97, 128
  s_and_b32 s97, s97, 1023
  s_add_u32 m0, s71, 34816
  s_nop 0
  buffer_load_dwordx4 v8, s[20:23], s4 offen lds
  buffer_load_dwordx4 v9, s[20:23], s4 offen offset:1024 lds
  buffer_load_dwordx4 v10, s[20:23], s4 offen offset:2048 lds
  buffer_load_dwordx4 v11, s[20:23], s4 offen offset:3072 lds
  s_add_u32 m0, s71, 38912
  s_nop 0
  buffer_load_dwordx4 v12, s[20:23], s4 offen lds
  buffer_load_dwordx4 v13, s[20:23], s4 offen offset:1024 lds
  s_lshl_b32 s4, s70, 18
  s_add_u32 s4, s4, s37
  s_add_u32 m0, s69, 131072
  s_add_u32 s70, s70, 1
  s_and_b32 s70, s70, 15
  buffer_load_dwordx4 v192, s[16:19], s4 offen lds
  buffer_load_dwordx4 v193, s[16:19], s4 offen offset:1024 lds
  buffer_load_dwordx4 v194, s[16:19], s4 offen offset:2048 lds
  s_lshl_b32 s4, s70, 18
  s_add_u32 s4, s4, s37
  s_add_u32 m0, s69, 139264
  s_add_u32 s70, s70, 1
  s_and_b32 s70, s70, 15
  buffer_load_dwordx4 v192, s[16:19], s4 offen lds
  buffer_load_dwordx4 v193, s[16:19], s4 offen offset:1024 lds
  buffer_load_dwordx4 v194, s[16:19], s4 offen offset:2048 lds
  s_waitcnt vmcnt(12)
  s_barrier
  s_add_u32 s4, s96, s97
  s_add_u32 s97, s97, 128
  s_and_b32 s97, s97, 1023
  s_add_u32 m0, s71, 53248
  s_nop 0
  buffer_load_dwordx4 v8, s[20:23], s4 offen lds
  buffer_load_dwordx4 v9, s[20:23], s4 offen offset:1024 lds
  buffer_load_dwordx4 v10, s[20:23], s4 offen offset:2048 lds
  buffer_load_dwordx4 v11, s[20:23], s4 offen offset:3072 lds
  s_add_u32 m0, s71, 57344
  s_nop 0
  buffer_load_dwordx4 v12, s[20:23], s4 offen lds
  buffer_load_dwordx4 v13, s[20:23], s4 offen offset:1024 lds
  s_lshl_b32 s4, s70, 18
  s_add_u32 s4, s4, s37
  s_add_u32 m0, s69, 81920
  s_add_u32 s70, s70, 1
  s_and_b32 s70, s70, 15
  buffer_load_dwordx4 v192, s[16:19], s4 offen lds
  buffer_load_dwordx4 v193, s[16:19], s4 offen offset:1024 lds
  buffer_load_dwordx4 v194, s[16:19], s4 offen offset:2048 lds
  s_lshl_b32 s4, s70, 18
  s_add_u32 s4, s4, s37
  s_add_u32 m0, s69, 90112
  s_add_u32 s70, s70, 1
  s_and_b32 s70, s70, 15
  buffer_load_dwordx4 v192, s[16:19], s4 offen lds
  buffer_load_dwordx4 v193, s[16:19], s4 offen offset:1024 lds
  buffer_load_dwordx4 v194, s[16:19], s4 offen offset:2048 lds
  s_waitcnt vmcnt(12)
  s_barrier
  s_add_u32 s4, s96, s97
  s_add_u32 s97, s97, 128
  s_and_b32 s97, s97, 1023
  s_add_u32 m0, s71, 16384
  s_nop 0
  buffer_load_dwordx4 v8, s[20:23], s4 offen lds
  buffer_load_dwordx4 v9, s[20:23], s4 offen offset:1024 lds
  buffer_load_dwordx4 v10, s[20:23], s4 offen offset:2048 lds
  buffer_load_dwordx4 v11, s[20:23], s4 offen offset:3072 lds
  s_add_u32 m0, s71, 20480
  s_nop 0
  buffer_load_dwordx4 v12, s[20:23], s4 offen lds
  buffer_load_dwordx4 v13, s[20:23], s4 offen offset:1024 lds
  s_lshl_b32 s4, s70, 18
  s_add_u32 s4, s4, s37
  s_add_u32 m0, s69, 98304
  s_add_u32 s70, s70, 1
  s_and_b32 s70, s70, 15
  buffer_load_dwordx4 v192, s[16:19], s4 offen lds
  buffer_load_dwordx4 v193, s[16:19], s4 offen offset:1024 lds
  buffer_load_dwordx4 v194, s[16:19], s4 offen offset:2048 lds
  s_lshl_b32 s4, s70, 18
  s_add_u32 s4, s4, s37
  s_add_u32 m0, s69, 106496
  s_add_u32 s70, s70, 1
  s_and_b32 s70, s70, 15
  buffer_load_dwordx4 v192, s[16:19], s4 offen lds
  buffer_load_dwordx4 v193, s[16:19], s4 offen offset:1024 lds
  buffer_load_dwordx4 v194, s[16:19], s4 offen offset:2048 lds
  s_load_dword s58, s[56:57], 0
  s_mov_b32 s63, 0x40000
  s_waitcnt lgkmcnt(0)
L_tagB:
  s_cmp_lg_u32 s58, 0
  s_cbranch_scc1 L_tagxB
  s_atomic_or s58, s[56:57], 0 glc
  s_sub_u32 s63, s63, 1
  s_cmp_lg_u32 s63, 0
  s_waitcnt lgkmcnt(0)
  s_cbranch_scc1 L_tagB
L_tagxB:
  s_not_b32 s59, s58
  s_and_b32 s4, s2, 7
  s_lshl_b32 s4, s4, 2
  s_add_u32 s4, s4, s31
  s_lshl_b32 s4, s4, 7
  s_add_u32 s87, s4, 48365568
  s_getreg_b32 s4, hwreg(HW_REG_XCC_ID, 0, 4)
  s_xor_b32 s83, s59, s4
  s_waitcnt vmcnt(12)
  s_barrier
  s_add_u32 s4, s96, s97
  s_add_u32 s97, s97, 128
  s_and_b32 s97, s97, 1023
  s_add_u32 m0, s71, 34816
  s_nop 0
  buffer_load_dwordx4 v8, s[20:23], s4 offen lds
  buffer_load_dwordx4 v9, s[20:23], s4 offen offset:1024 lds
  buffer_load_dwordx4 v10, s[20:23], s4 offen offset:2048 lds
  buffer_load_dwordx4 v11, s[20:23], s4 offen offset:3072 lds
  s_add_u32 m0, s71, 38912
  s_nop 0
  buffer_load_dwordx4 v12, s[20:23], s4 offen lds
  buffer_load_dwordx4 v13, s[20:23], s4 offen offset:1024 lds
  s_lshl_b32 s4, s70, 18
  s_add_u32 s4, s4, s37
  s_add_u32 m0, s69, 114688
  s_add_u32 s70, s70, 1
  s_and_b32 s70, s70, 15
  buffer_load_dwordx4 v192, s[16:19], s4 offen lds
  buffer_load_dwordx4 v193, s[16:19], s4 offen offset:1024 lds
  buffer_load_dwordx4 v194, s[16:19], s4 offen offset:2048 lds
  s_lshl_b32 s4, s70, 18
  s_add_u32 s4, s4, s37
  s_add_u32 m0, s69, 122880
  s_add_u32 s70, s70, 1
  s_and_b32 s70, s70, 15
  buffer_load_dwordx4 v192, s[16:19], s4 offen lds
  buffer_load_dwordx4 v193, s[16:19], s4 offen offset:1024 lds
  buffer_load_dwordx4 v194, s[16:19], s4 offen offset:2048 lds
  s_waitcnt vmcnt(12)
  s_barrier
  s_add_u32 s84, s38, s99
  s_add_u32 s85, s39, s99
  s_add_u32 s86, s40, s99
  buffer_load_dwordx4 v[96:99], v198, s[20:23], s84 offen
  buffer_load_dwordx4 v[108:111], v199, s[20:23], s84 offen
  buffer_load_dwordx4 v[100:103], v198, s[20:23], s85 offen
  buffer_load_dwordx4 v[112:115], v199, s[20:23], s85 offen
  buffer_load_dwordx4 v[104:107], v198, s[20:23], s86 offen
  buffer_load_dwordx4 v[116:119], v199, s[20:23], s86 offen
  s_add_u32 s99, s99, 128
  s_and_b32 s99, s99, 1023
  s_waitcnt vmcnt(6)
  s_barrier
  s_add_u32 s84, s38, s99
  s_add_u32 s85, s39, s99
  s_add_u32 s86, s40, s99
  buffer_load_dwordx4 v[120:123], v198, s[20:23], s84 offen
  buffer_load_dwordx4 v[132:135], v199, s[20:23], s84 offen
  buffer_load_dwordx4 v[124:127], v198, s[20:23], s85 offen
  buffer_load_dwordx4 v[136:139], v199, s[20:23], s85 offen
  buffer_load_dwordx4 v[128:131], v198, s[20:23], s86 offen
  buffer_load_dwordx4 v[140:143], v199, s[20:23], s86 offen
  s_add_u32 s99, s99, 128
  s_and_b32 s99, s99, 1023
  s_barrier
  s_add_u32 s84, s38, s99
  s_add_u32 s85, s39, s99
  s_add_u32 s86, s40, s99
  buffer_load_dwordx4 v[144:147], v198, s[20:23], s84 offen
  buffer_load_dwordx4 v[156:159], v199, s[20:23], s84 offen
  buffer_load_dwordx4 v[148:151], v198, s[20:23], s85 offen
  buffer_load_dwordx4 v[160:163], v199, s[20:23], s85 offen
  buffer_load_dwordx4 v[152:155], v198, s[20:23], s86 offen
  buffer_load_dwordx4 v[164:167], v199, s[20:23], s86 offen
  s_add_u32 s99, s99, 128
  s_and_b32 s99, s99, 1023
  s_waitcnt vmcnt(12)
  ds_write_b128 v202, v[96:99] offset:0
  ds_write_b128 v202, v[108:111] offset:1024
  ds_read_b128 v[96:99], v200 offset:0
  ds_read_b128 v[108:111], v201 offset:0
  ds_write_b128 v202, v[100:103] offset:0
  ds_write_b128 v202, v[112:115] offset:1024
  ds_read_b128 v[100:103], v200 offset:0
  ds_read_b128 v[112:115], v201 offset:0
  ds_write_b128 v202, v[104:107] offset:0
  ds_write_b128 v202, v[116:119] offset:1024
  ds_read_b128 v[104:107], v200 offset:0
  ds_read_b128 v[116:119], v201 offset:0
  s_waitcnt lgkmcnt(0)
  ds_read_b64_tr_b16 v[204:205], v244 offset:0
  ds_read_b64_tr_b16 v[206:207], v244 offset:1024
  ds_read_b64_tr_b16 v[208:209], v244 offset:8
  ds_read_b64_tr_b16 v[210:211], v244 offset:1032
  s_waitcnt lgkmcnt(0)
  v_mfma_f32_16x16x32_bf16 v[0:3], v[204:207], v[96:99], 0
  ds_read_b64_tr_b16 v[212:213], v245 offset:0
  ds_read_b64_tr_b16 v[214:215], v245 offset:1024
  v_mfma_f32_16x16x32_bf16 v[32:35], v[204:207], v[100:103], 0
  ds_read_b64_tr_b16 v[216:217], v245 offset:8
  ds_read_b64_tr_b16 v[218:219], v245 offset:1032
  v_mfma_f32_16x16x32_bf16 v[64:67], v[204:207], v[104:107], 0
  ds_read_b64_tr_b16 v[220:221], v246 offset:0
  ds_read_b64_tr_b16 v[222:223], v246 offset:1024
  v_mfma_f32_16x16x32_bf16 v[4:7], v[208:211], v[96:99], 0
  ds_read_b64_tr_b16 v[224:225], v246 offset:8
  ds_read_b64_tr_b16 v[226:227], v246 offset:1032
  v_mfma_f32_16x16x32_bf16 v[36:39], v[208:211], v[100:103], 0
  s_add_u32 s84, s38, s99
  s_add_u32 s85, s39, s99
  s_add_u32 s86, s40, s99
  v_mfma_f32_16x16x32_bf16 v[68:71], v[208:211], v[104:107], 0
  s_waitcnt lgkmcnt(4)
  v_mfma_f32_16x16x32_bf16 v[8:11], v[212:215], v[96:99], 0
  ds_read_b64_tr_b16 v[204:205], v247 offset:0
  ds_read_b64_tr_b16 v[206:207], v247 offset:1024
  v_mfma_f32_16x16x32_bf16 v[40:43], v[212:215], v[100:103], 0
  v_mfma_f32_16x16x32_bf16 v[72:75], v[212:215], v[104:107], 0
  v_mfma_f32_16x16x32_bf16 v[12:15], v[216:219], v[96:99], 0
  ds_read_b64_tr_b16 v[208:209], v247 offset:8
  ds_read_b64_tr_b16 v[210:211], v247 offset:1032
  v_mfma_f32_16x16x32_bf16 v[44:47], v[216:219], v[100:103], 0
  v_mfma_f32_16x16x32_bf16 v[76:79], v[216:219], v[104:107], 0
  buffer_load_dwordx4 v[168:171], v198, s[20:23], s84 offen
  buffer_load_dwordx4 v[180:183], v199, s[20:23], s84 offen
  s_waitcnt lgkmcnt(4)
  v_mfma_f32_16x16x32_bf16 v[16:19], v[220:223], v[96:99], 0
  buffer_load_dwordx4 v[172:175], v198, s[20:23], s85 offen
  buffer_load_dwordx4 v[184:187], v199, s[20:23], s85 offen
  v_mfma_f32_16x16x32_bf16 v[48:51], v[220:223], v[100:103], 0
  buffer_load_dwordx4 v[176:179], v198, s[20:23], s86 offen
  buffer_load_dwordx4 v[188:191], v199, s[20:23], s86 offen
  v_mfma_f32_16x16x32_bf16 v[80:83], v[220:223], v[104:107], 0
  s_waitcnt lgkmcnt(0)
  s_barrier
  v_mfma_f32_16x16x32_bf16 v[20:23], v[224:227], v[96:99], 0
  ds_read_b64_tr_b16 v[212:213], v244 offset:8192
  ds_read_b64_tr_b16 v[214:215], v244 offset:9216
  v_mfma_f32_16x16x32_bf16 v[52:55], v[224:227], v[100:103], 0
  ds_read_b64_tr_b16 v[216:217], v244 offset:8200
  ds_read_b64_tr_b16 v[218:219], v244 offset:9224
  v_mfma_f32_16x16x32_bf16 v[84:87], v[224:227], v[104:107], 0
  s_waitcnt vmcnt(12)
  v_mfma_f32_16x16x32_bf16 v[24:27], v[204:207], v[96:99], 0
  ds_read_b64_tr_b16 v[220:221], v245 offset:8192
  ds_read_b64_tr_b16 v[222:223], v245 offset:9216
  v_mfma_f32_16x16x32_bf16 v[56:59], v[204:207], v[100:103], 0
  s_add_u32 s99, s99, 128
  s_and_b32 s99, s99, 1023
  v_mfma_f32_16x16x32_bf16 v[88:91], v[204:207], v[104:107], 0
  ds_write_b128 v202, v[120:123] offset:0
  ds_write_b128 v202, v[132:135] offset:1024
  v_mfma_f32_16x16x32_bf16 v[28:31], v[208:211], v[96:99], 0
  ds_read_b64_tr_b16 v[204:205], v245 offset:8200
  ds_read_b64_tr_b16 v[206:207], v245 offset:9224
  v_mfma_f32_16x16x32_bf16 v[60:63], v[208:211], v[100:103], 0
  ds_read_b128 v[120:123], v200 offset:0
  ds_read_b128 v[132:135], v201 offset:0
  v_mfma_f32_16x16x32_bf16 v[92:95], v[208:211], v[104:107], 0
  ds_write_b128 v202, v[124:127] offset:0
  ds_write_b128 v202, v[136:139] offset:1024
  s_waitcnt lgkmcnt(10)
  v_mfma_f32_16x16x32_bf16 v[0:3], v[212:215], v[108:111], v[0:3]
  ds_read_b64_tr_b16 v[208:209], v246 offset:8192
  ds_read_b64_tr_b16 v[210:211], v246 offset:9216
  v_mfma_f32_16x16x32_bf16 v[32:35], v[212:215], v[112:115], v[32:35]
  ds_read_b128 v[124:127], v200 offset:0
  ds_read_b128 v[136:139], v201 offset:0
  v_mfma_f32_16x16x32_bf16 v[64:67], v[212:215], v[116:119], v[64:67]
  v_mfma_f32_16x16x32_bf16 v[4:7], v[216:219], v[108:111], v[4:7]
  v_mfma_f32_16x16x32_bf16 v[36:39], v[216:219], v[112:115], v[36:39]
  v_mfma_f32_16x16x32_bf16 v[68:71], v[216:219], v[116:119], v[68:71]
  s_waitcnt lgkmcnt(8)
  v_mfma_f32_16x16x32_bf16 v[8:11], v[220:223], v[108:111], v[8:11]
  ds_read_b64_tr_b16 v[212:213], v246 offset:8200
  ds_read_b64_tr_b16 v[214:215], v246 offset:9224
  v_mfma_f32_16x16x32_bf16 v[40:43], v[220:223], v[112:115], v[40:43]
  ds_read_b64_tr_b16 v[216:217], v247 offset:8192
  ds_read_b64_tr_b16 v[218:219], v247 offset:9216
  v_mfma_f32_16x16x32_bf16 v[72:75], v[220:223], v[116:119], v[72:75]
  ds_write_b128 v202, v[128:131] offset:0
  ds_write_b128 v202, v[140:143] offset:1024
  v_mfma_f32_16x16x32_bf16 v[12:15], v[204:207], v[108:111], v[12:15]
  v_mfma_f32_16x16x32_bf16 v[44:47], v[204:207], v[112:115], v[44:47]
  v_mfma_f32_16x16x32_bf16 v[76:79], v[204:207], v[116:119], v[76:79]
  s_waitcnt lgkmcnt(4)
  v_mfma_f32_16x16x32_bf16 v[16:19], v[208:211], v[108:111], v[16:19]
  ds_read_b64_tr_b16 v[220:221], v247 offset:8200
  ds_read_b64_tr_b16 v[222:223], v247 offset:9224
  v_mfma_f32_16x16x32_bf16 v[48:51], v[208:211], v[112:115], v[48:51]
  ds_read_b128 v[128:131], v200 offset:0
  ds_read_b128 v[140:143], v201 offset:0
  v_mfma_f32_16x16x32_bf16 v[80:83], v[208:211], v[116:119], v[80:83]
  s_waitcnt lgkmcnt(0)
  s_barrier
  v_mfma_f32_16x16x32_bf16 v[20:23], v[212:215], v[108:111], v[20:23]
  ds_read_b64_tr_b16 v[204:205], v244 offset:16384
  ds_read_b64_tr_b16 v[206:207], v244 offset:17408
  v_mfma_f32_16x16x32_bf16 v[52:55], v[212:215], v[112:115], v[52:55]
  ds_read_b64_tr_b16 v[208:209], v244 offset:16392
  ds_read_b64_tr_b16 v[210:211], v244 offset:17416
  v_mfma_f32_16x16x32_bf16 v[84:87], v[212:215], v[116:119], v[84:87]
  v_mfma_f32_16x16x32_bf16 v[24:27], v[216:219], v[108:111], v[24:27]
  ds_read_b64_tr_b16 v[212:213], v245 offset:16384
  ds_read_b64_tr_b16 v[214:215], v245 offset:17408
  v_mfma_f32_16x16x32_bf16 v[56:59], v[216:219], v[112:115], v[56:59]
  v_mfma_f32_16x16x32_bf16 v[88:91], v[216:219], v[116:119], v[88:91]
  v_mfma_f32_16x16x32_bf16 v[28:31], v[220:223], v[108:111], v[28:31]
  ds_read_b64_tr_b16 v[216:217], v245 offset:16392
  ds_read_b64_tr_b16 v[218:219], v245 offset:17416
  v_mfma_f32_16x16x32_bf16 v[60:63], v[220:223], v[112:115], v[60:63]
  v_mfma_f32_16x16x32_bf16 v[92:95], v[220:223], v[116:119], v[92:95]
  s_waitcnt lgkmcnt(4)
  v_mfma_f32_16x16x32_bf16 v[0:3], v[204:207], v[120:123], v[0:3]
  ds_read_b64_tr_b16 v[220:221], v246 offset:16384
  ds_read_b64_tr_b16 v[222:223], v246 offset:17408
  v_mfma_f32_16x16x32_bf16 v[32:35], v[204:207], v[124:127], v[32:35]
  s_add_u32 s84, s38, s99
  s_add_u32 s85, s39, s99
  s_add_u32 s86, s40, s99
  v_mfma_f32_16x16x32_bf16 v[64:67], v[204:207], v[128:131], v[64:67]
  v_mfma_f32_16x16x32_bf16 v[4:7], v[208:211], v[120:123], v[4:7]
  ds_read_b64_tr_b16 v[224:225], v246 offset:16392
  ds_read_b64_tr_b16 v[226:227], v246 offset:17416
  v_mfma_f32_16x16x32_bf16 v[36:39], v[208:211], v[124:127], v[36:39]
  v_mfma_f32_16x16x32_bf16 v[68:71], v[208:211], v[128:131], v[68:71]
  s_waitcnt lgkmcnt(4)
  v_mfma_f32_16x16x32_bf16 v[8:11], v[212:215], v[120:123], v[8:11]
  ds_read_b64_tr_b16 v[204:205], v247 offset:16384
  ds_read_b64_tr_b16 v[206:207], v247 offset:17408
  v_mfma_f32_16x16x32_bf16 v[40:43], v[212:215], v[124:127], v[40:43]
  v_mfma_f32_16x16x32_bf16 v[72:75], v[212:215], v[128:131], v[72:75]
  v_mfma_f32_16x16x32_bf16 v[12:15], v[216:219], v[120:123], v[12:15]
  ds_read_b64_tr_b16 v[208:209], v247 offset:16392
  ds_read_b64_tr_b16 v[210:211], v247 offset:17416
  v_mfma_f32_16x16x32_bf16 v[44:47], v[216:219], v[124:127], v[44:47]
  v_mfma_f32_16x16x32_bf16 v[76:79], v[216:219], v[128:131], v[76:79]
  buffer_load_dwordx4 v[96:99], v198, s[20:23], s84 offen
  buffer_load_dwordx4 v[108:111], v199, s[20:23], s84 offen
  s_waitcnt lgkmcnt(4)
  v_mfma_f32_16x16x32_bf16 v[16:19], v[220:223], v[120:123], v[16:19]
  buffer_load_dwordx4 v[100:103], v198, s[20:23], s85 offen
  buffer_load_dwordx4 v[112:115], v199, s[20:23], s85 offen
  v_mfma_f32_16x16x32_bf16 v[48:51], v[220:223], v[124:127], v[48:51]
  buffer_load_dwordx4 v[104:107], v198, s[20:23], s86 offen
  buffer_load_dwordx4 v[116:119], v199, s[20:23], s86 offen
  v_mfma_f32_16x16x32_bf16 v[80:83], v[220:223], v[128:131], v[80:83]
  s_waitcnt lgkmcnt(0)
  s_barrier
  v_mfma_f32_16x16x32_bf16 v[20:23], v[224:227], v[120:123], v[20:23]
  ds_read_b64_tr_b16 v[212:213], v244 offset:0
  ds_read_b64_tr_b16 v[214:215], v244 offset:1024
  v_mfma_f32_16x16x32_bf16 v[52:55], v[224:227], v[124:127], v[52:55]
  ds_read_b64_tr_b16 v[216:217], v244 offset:8
  ds_read_b64_tr_b16 v[218:219], v244 offset:1032
  v_mfma_f32_16x16x32_bf16 v[84:87], v[224:227], v[128:131], v[84:87]
  s_waitcnt vmcnt(12)
  v_mfma_f32_16x16x32_bf16 v[24:27], v[204:207], v[120:123], v[24:27]
  ds_read_b64_tr_b16 v[220:221], v245 offset:0
  ds_read_b64_tr_b16 v[222:223], v245 offset:1024
  v_mfma_f32_16x16x32_bf16 v[56:59], v[204:207], v[124:127], v[56:59]
  s_add_u32 s99, s99, 128
  s_and_b32 s99, s99, 1023
  v_mfma_f32_16x16x32_bf16 v[88:91], v[204:207], v[128:131], v[88:91]
  ds_write_b128 v202, v[144:147] offset:0
  ds_write_b128 v202, v[156:159] offset:1024
  v_mfma_f32_16x16x32_bf16 v[28:31], v[208:211], v[120:123], v[28:31]
  ds_read_b64_tr_b16 v[204:205], v245 offset:8
  ds_read_b64_tr_b16 v[206:207], v245 offset:1032
  v_mfma_f32_16x16x32_bf16 v[60:63], v[208:211], v[124:127], v[60:63]
  ds_read_b128 v[144:147], v200 offset:0
  ds_read_b128 v[156:159], v201 offset:0
  v_mfma_f32_16x16x32_bf16 v[92:95], v[208:211], v[128:131], v[92:95]
  ds_write_b128 v202, v[148:151] offset:0
  ds_write_b128 v202, v[160:163] offset:1024
  s_waitcnt lgkmcnt(10)
  v_mfma_f32_16x16x32_bf16 v[0:3], v[212:215], v[132:135], v[0:3]
  ds_read_b64_tr_b16 v[208:209], v246 offset:0
  ds_read_b64_tr_b16 v[210:211], v246 offset:1024
  v_mfma_f32_16x16x32_bf16 v[32:35], v[212:215], v[136:139], v[32:35]
  ds_read_b128 v[148:151], v200 offset:0
  ds_read_b128 v[160:163], v201 offset:0
  v_mfma_f32_16x16x32_bf16 v[64:67], v[212:215], v[140:143], v[64:67]
  v_mfma_f32_16x16x32_bf16 v[4:7], v[216:219], v[132:135], v[4:7]
  v_mfma_f32_16x16x32_bf16 v[36:39], v[216:219], v[136:139], v[36:39]
  v_mfma_f32_16x16x32_bf16 v[68:71], v[216:219], v[140:143], v[68:71]
  s_waitcnt lgkmcnt(8)
  v_mfma_f32_16x16x32_bf16 v[8:11], v[220:223], v[132:135], v[8:11]
  ds_read_b64_tr_b16 v[212:213], v246 offset:8
  ds_read_b64_tr_b16 v[214:215], v246 offset:1032
  v_mfma_f32_16x16x32_bf16 v[40:43], v[220:223], v[136:139], v[40:43]
  ds_read_b64_tr_b16 v[216:217], v247 offset:0
  ds_read_b64_tr_b16 v[218:219], v247 offset:1024
  v_mfma_f32_16x16x32_bf16 v[72:75], v[220:223], v[140:143], v[72:75]
  ds_write_b128 v202, v[152:155] offset:0
  ds_write_b128 v202, v[164:167] offset:1024
  v_mfma_f32_16x16x32_bf16 v[12:15], v[204:207], v[132:135], v[12:15]
  v_mfma_f32_16x16x32_bf16 v[44:47], v[204:207], v[136:139], v[44:47]
  v_mfma_f32_16x16x32_bf16 v[76:79], v[204:207], v[140:143], v[76:79]
  s_waitcnt lgkmcnt(4)
  v_mfma_f32_16x16x32_bf16 v[16:19], v[208:211], v[132:135], v[16:19]
  ds_read_b64_tr_b16 v[220:221], v247 offset:8
  ds_read_b64_tr_b16 v[222:223], v247 offset:1032
  v_mfma_f32_16x16x32_bf16 v[48:51], v[208:211], v[136:139], v[48:51]
  ds_read_b128 v[152:155], v200 offset:0
  ds_read_b128 v[164:167], v201 offset:0
  v_mfma_f32_16x16x32_bf16 v[80:83], v[208:211], v[140:143], v[80:83]
  s_waitcnt lgkmcnt(0)
  s_barrier
  v_mfma_f32_16x16x32_bf16 v[20:23], v[212:215], v[132:135], v[20:23]
  ds_read_b64_tr_b16 v[204:205], v244 offset:8192
  ds_read_b64_tr_b16 v[206:207], v244 offset:9216
  v_mfma_f32_16x16x32_bf16 v[52:55], v[212:215], v[136:139], v[52:55]
  ds_read_b64_tr_b16 v[208:209], v244 offset:8200
  ds_read_b64_tr_b16 v[210:211], v244 offset:9224
  v_mfma_f32_16x16x32_bf16 v[84:87], v[212:215], v[140:143], v[84:87]
  v_mfma_f32_16x16x32_bf16 v[24:27], v[216:219], v[132:135], v[24:27]
  ds_read_b64_tr_b16 v[212:213], v245 offset:8192
  ds_read_b64_tr_b16 v[214:215], v245 offset:9216
  v_mfma_f32_16x16x32_bf16 v[56:59], v[216:219], v[136:139], v[56:59]
  v_mfma_f32_16x16x32_bf16 v[88:91], v[216:219], v[140:143], v[88:91]
  v_mfma_f32_16x16x32_bf16 v[28:31], v[220:223], v[132:135], v[28:31]
  ds_read_b64_tr_b16 v[216:217], v245 offset:8200
  ds_read_b64_tr_b16 v[218:219], v245 offset:9224
  v_mfma_f32_16x16x32_bf16 v[60:63], v[220:223], v[136:139], v[60:63]
  v_mfma_f32_16x16x32_bf16 v[92:95], v[220:223], v[140:143], v[92:95]
  s_waitcnt lgkmcnt(4)
  v_mfma_f32_16x16x32_bf16 v[0:3], v[204:207], v[144:147], v[0:3]
  ds_read_b64_tr_b16 v[220:221], v246 offset:8192
  ds_read_b64_tr_b16 v[222:223], v246 offset:9216
  v_mfma_f32_16x16x32_bf16 v[32:35], v[204:207], v[148:151], v[32:35]
  s_add_u32 s84, s38, s99
  s_add_u32 s85, s39, s99
  s_add_u32 s86, s40, s99
  v_mfma_f32_16x16x32_bf16 v[64:67], v[204:207], v[152:155], v[64:67]
  v_mfma_f32_16x16x32_bf16 v[4:7], v[208:211], v[144:147], v[4:7]
  ds_read_b64_tr_b16 v[224:225], v246 offset:8200
  ds_read_b64_tr_b16 v[226:227], v246 offset:9224
  v_mfma_f32_16x16x32_bf16 v[36:39], v[208:211], v[148:151], v[36:39]
  v_mfma_f32_16x16x32_bf16 v[68:71], v[208:211], v[152:155], v[68:71]
  s_waitcnt lgkmcnt(4)
  v_mfma_f32_16x16x32_bf16 v[8:11], v[212:215], v[144:147], v[8:11]
  ds_read_b64_tr_b16 v[204:205], v247 offset:8192
  ds_read_b64_tr_b16 v[206:207], v247 offset:9216
  v_mfma_f32_16x16x32_bf16 v[40:43], v[212:215], v[148:151], v[40:43]
  v_mfma_f32_16x16x32_bf16 v[72:75], v[212:215], v[152:155], v[72:75]
  v_mfma_f32_16x16x32_bf16 v[12:15], v[216:219], v[144:147], v[12:15]
  ds_read_b64_tr_b16 v[208:209], v247 offset:8200
  ds_read_b64_tr_b16 v[210:211], v247 offset:9224
  v_mfma_f32_16x16x32_bf16 v[44:47], v[216:219], v[148:151], v[44:47]
  v_mfma_f32_16x16x32_bf16 v[76:79], v[216:219], v[152:155], v[76:79]
  buffer_load_dwordx4 v[120:123], v198, s[20:23], s84 offen
  buffer_load_dwordx4 v[132:135], v199, s[20:23], s84 offen
  s_waitcnt lgkmcnt(4)
  v_mfma_f32_16x16x32_bf16 v[16:19], v[220:223], v[144:147], v[16:19]
  buffer_load_dwordx4 v[124:127], v198, s[20:23], s85 offen
  buffer_load_dwordx4 v[136:139], v199, s[20:23], s85 offen
  v_mfma_f32_16x16x32_bf16 v[48:51], v[220:223], v[148:151], v[48:51]
  buffer_load_dwordx4 v[128:131], v198, s[20:23], s86 offen
  buffer_load_dwordx4 v[140:143], v199, s[20:23], s86 offen
  v_mfma_f32_16x16x32_bf16 v[80:83], v[220:223], v[152:155], v[80:83]
  s_waitcnt lgkmcnt(0)
  s_barrier
  v_mfma_f32_16x16x32_bf16 v[20:23], v[224:227], v[144:147], v[20:23]
  ds_read_b64_tr_b16 v[212:213], v244 offset:16384
  ds_read_b64_tr_b16 v[214:215], v244 offset:17408
  v_mfma_f32_16x16x32_bf16 v[52:55], v[224:227], v[148:151], v[52:55]
  ds_read_b64_tr_b16 v[216:217], v244 offset:16392
  ds_read_b64_tr_b16 v[218:219], v244 offset:17416
  v_mfma_f32_16x16x32_bf16 v[84:87], v[224:227], v[152:155], v[84:87]
  s_waitcnt vmcnt(12)
  v_mfma_f32_16x16x32_bf16 v[24:27], v[204:207], v[144:147], v[24:27]
  ds_read_b64_tr_b16 v[220:221], v245 offset:16384
  ds_read_b64_tr_b16 v[222:223], v245 offset:17408
  v_mfma_f32_16x16x32_bf16 v[56:59], v[204:207], v[148:151], v[56:59]
  s_add_u32 s99, s99, 128
  s_and_b32 s99, s99, 1023
  v_mfma_f32_16x16x32_bf16 v[88:91], v[204:207], v[152:155], v[88:91]
  ds_write_b128 v202, v[168:171] offset:0
  ds_write_b128 v202, v[180:183] offset:1024
  v_mfma_f32_16x16x32_bf16 v[28:31], v[208:211], v[144:147], v[28:31]
  ds_read_b64_tr_b16 v[204:205], v245 offset:16392
  ds_read_b64_tr_b16 v[206:207], v245 offset:17416
  v_mfma_f32_16x16x32_bf16 v[60:63], v[208:211], v[148:151], v[60:63]
  ds_read_b128 v[168:171], v200 offset:0
  ds_read_b128 v[180:183], v201 offset:0
  v_mfma_f32_16x16x32_bf16 v[92:95], v[208:211], v[152:155], v[92:95]
  ds_write_b128 v202, v[172:175] offset:0
  ds_write_b128 v202, v[184:187] offset:1024
  s_waitcnt lgkmcnt(10)
  v_mfma_f32_16x16x32_bf16 v[0:3], v[212:215], v[156:159], v[0:3]
  ds_read_b64_tr_b16 v[208:209], v246 offset:16384
  ds_read_b64_tr_b16 v[210:211], v246 offset:17408
  v_mfma_f32_16x16x32_bf16 v[32:35], v[212:215], v[160:163], v[32:35]
  ds_read_b128 v[172:175], v200 offset:0
  ds_read_b128 v[184:187], v201 offset:0
  v_mfma_f32_16x16x32_bf16 v[64:67], v[212:215], v[164:167], v[64:67]
  v_mfma_f32_16x16x32_bf16 v[4:7], v[216:219], v[156:159], v[4:7]
  v_mfma_f32_16x16x32_bf16 v[36:39], v[216:219], v[160:163], v[36:39]
  v_mfma_f32_16x16x32_bf16 v[68:71], v[216:219], v[164:167], v[68:71]
  s_waitcnt lgkmcnt(8)
  v_mfma_f32_16x16x32_bf16 v[8:11], v[220:223], v[156:159], v[8:11]
  ds_read_b64_tr_b16 v[212:213], v246 offset:16392
  ds_read_b64_tr_b16 v[214:215], v246 offset:17416
  v_mfma_f32_16x16x32_bf16 v[40:43], v[220:223], v[160:163], v[40:43]
  ds_read_b64_tr_b16 v[216:217], v247 offset:16384
  ds_read_b64_tr_b16 v[218:219], v247 offset:17408
  v_mfma_f32_16x16x32_bf16 v[72:75], v[220:223], v[164:167], v[72:75]
  ds_write_b128 v202, v[176:179] offset:0
  ds_write_b128 v202, v[188:191] offset:1024
  v_mfma_f32_16x16x32_bf16 v[12:15], v[204:207], v[156:159], v[12:15]
  v_mfma_f32_16x16x32_bf16 v[44:47], v[204:207], v[160:163], v[44:47]
  v_mfma_f32_16x16x32_bf16 v[76:79], v[204:207], v[164:167], v[76:79]
  s_waitcnt lgkmcnt(4)
  v_mfma_f32_16x16x32_bf16 v[16:19], v[208:211], v[156:159], v[16:19]
  ds_read_b64_tr_b16 v[220:221], v247 offset:16392
  ds_read_b64_tr_b16 v[222:223], v247 offset:17416
  v_mfma_f32_16x16x32_bf16 v[48:51], v[208:211], v[160:163], v[48:51]
  ds_read_b128 v[176:179], v200 offset:0
  ds_read_b128 v[188:191], v201 offset:0
  v_mfma_f32_16x16x32_bf16 v[80:83], v[208:211], v[164:167], v[80:83]
  s_waitcnt lgkmcnt(0)
  s_barrier
  v_mfma_f32_16x16x32_bf16 v[20:23], v[212:215], v[156:159], v[20:23]
  ds_read_b64_tr_b16 v[204:205], v244 offset:0
  ds_read_b64_tr_b16 v[206:207], v244 offset:1024
  v_mfma_f32_16x16x32_bf16 v[52:55], v[212:215], v[160:163], v[52:55]
  ds_read_b64_tr_b16 v[208:209], v244 offset:8
  ds_read_b64_tr_b16 v[210:211], v244 offset:1032
  v_mfma_f32_16x16x32_bf16 v[84:87], v[212:215], v[164:167], v[84:87]
  v_mfma_f32_16x16x32_bf16 v[24:27], v[216:219], v[156:159], v[24:27]
  ds_read_b64_tr_b16 v[212:213], v245 offset:0
  ds_read_b64_tr_b16 v[214:215], v245 offset:1024
  v_mfma_f32_16x16x32_bf16 v[56:59], v[216:219], v[160:163], v[56:59]
  v_mfma_f32_16x16x32_bf16 v[88:91], v[216:219], v[164:167], v[88:91]
  v_mfma_f32_16x16x32_bf16 v[28:31], v[220:223], v[156:159], v[28:31]
  ds_read_b64_tr_b16 v[216:217], v245 offset:8
  ds_read_b64_tr_b16 v[218:219], v245 offset:1032
  v_mfma_f32_16x16x32_bf16 v[60:63], v[220:223], v[160:163], v[60:63]
  v_mfma_f32_16x16x32_bf16 v[92:95], v[220:223], v[164:167], v[92:95]
  s_waitcnt lgkmcnt(4)
  v_mfma_f32_16x16x32_bf16 v[0:3], v[204:207], v[168:171], v[0:3]
  ds_read_b64_tr_b16 v[220:221], v246 offset:0
  ds_read_b64_tr_b16 v[222:223], v246 offset:1024
  v_mfma_f32_16x16x32_bf16 v[32:35], v[204:207], v[172:175], v[32:35]
  s_add_u32 s84, s38, s99
  s_add_u32 s85, s39, s99
  s_add_u32 s86, s40, s99
  v_mfma_f32_16x16x32_bf16 v[64:67], v[204:207], v[176:179], v[64:67]
  v_mfma_f32_16x16x32_bf16 v[4:7], v[208:211], v[168:171], v[4:7]
  ds_read_b64_tr_b16 v[224:225], v246 offset:8
  ds_read_b64_tr_b16 v[226:227], v246 offset:1032
  v_mfma_f32_16x16x32_bf16 v[36:39], v[208:211], v[172:175], v[36:39]
  v_mfma_f32_16x16x32_bf16 v[68:71], v[208:211], v[176:179], v[68:71]
  s_waitcnt lgkmcnt(4)
  v_mfma_f32_16x16x32_bf16 v[8:11], v[212:215], v[168:171], v[8:11]
  ds_read_b64_tr_b16 v[204:205], v247 offset:0
  ds_read_b64_tr_b16 v[206:207], v247 offset:1024
  v_mfma_f32_16x16x32_bf16 v[40:43], v[212:215], v[172:175], v[40:43]
  v_mfma_f32_16x16x32_bf16 v[72:75], v[212:215], v[176:179], v[72:75]
  v_mfma_f32_16x16x32_bf16 v[12:15], v[216:219], v[168:171], v[12:15]
  ds_read_b64_tr_b16 v[208:209], v247 offset:8
  ds_read_b64_tr_b16 v[210:211], v247 offset:1032
  v_mfma_f32_16x16x32_bf16 v[44:47], v[216:219], v[172:175], v[44:47]
  v_mfma_f32_16x16x32_bf16 v[76:79], v[216:219], v[176:179], v[76:79]
  buffer_load_dwordx4 v[144:147], v198, s[20:23], s84 offen
  buffer_load_dwordx4 v[156:159], v199, s[20:23], s84 offen
  s_waitcnt lgkmcnt(4)
  v_mfma_f32_16x16x32_bf16 v[16:19], v[220:223], v[168:171], v[16:19]
  buffer_load_dwordx4 v[148:151], v198, s[20:23], s85 offen
  buffer_load_dwordx4 v[160:163], v199, s[20:23], s85 offen
  v_mfma_f32_16x16x32_bf16 v[48:51], v[220:223], v[172:175], v[48:51]
  buffer_load_dwordx4 v[152:155], v198, s[20:23], s86 offen
  buffer_load_dwordx4 v[164:167], v199, s[20:23], s86 offen
  v_mfma_f32_16x16x32_bf16 v[80:83], v[220:223], v[176:179], v[80:83]
  s_waitcnt lgkmcnt(0)
  s_barrier
  v_mfma_f32_16x16x32_bf16 v[20:23], v[224:227], v[168:171], v[20:23]
  ds_read_b64_tr_b16 v[212:213], v244 offset:8192
  ds_read_b64_tr_b16 v[214:215], v244 offset:9216
  v_mfma_f32_16x16x32_bf16 v[52:55], v[224:227], v[172:175], v[52:55]
  ds_read_b64_tr_b16 v[216:217], v244 offset:8200
  ds_read_b64_tr_b16 v[218:219], v244 offset:9224
  v_mfma_f32_16x16x32_bf16 v[84:87], v[224:227], v[176:179], v[84:87]
  s_waitcnt vmcnt(12)
  v_mfma_f32_16x16x32_bf16 v[24:27], v[204:207], v[168:171], v[24:27]
  ds_read_b64_tr_b16 v[220:221], v245 offset:8192
  ds_read_b64_tr_b16 v[222:223], v245 offset:9216
  v_mfma_f32_16x16x32_bf16 v[56:59], v[204:207], v[172:175], v[56:59]
  s_add_u32 s99, s99, 128
  s_and_b32 s99, s99, 1023
  v_mfma_f32_16x16x32_bf16 v[88:91], v[204:207], v[176:179], v[88:91]
  ds_write_b128 v202, v[96:99] offset:0
  ds_write_b128 v202, v[108:111] offset:1024
  v_mfma_f32_16x16x32_bf16 v[28:31], v[208:211], v[168:171], v[28:31]
  ds_read_b64_tr_b16 v[204:205], v245 offset:8200
  ds_read_b64_tr_b16 v[206:207], v245 offset:9224
  v_mfma_f32_16x16x32_bf16 v[60:63], v[208:211], v[172:175], v[60:63]
  ds_read_b128 v[96:99], v200 offset:0
  ds_read_b128 v[108:111], v201 offset:0
  v_mfma_f32_16x16x32_bf16 v[92:95], v[208:211], v[176:179], v[92:95]
  ds_write_b128 v202, v[100:103] offset:0
  ds_write_b128 v202, v[112:115] offset:1024
  s_waitcnt lgkmcnt(10)
  v_mfma_f32_16x16x32_bf16 v[0:3], v[212:215], v[180:183], v[0:3]
  ds_read_b64_tr_b16 v[208:209], v246 offset:8192
  ds_read_b64_tr_b16 v[210:211], v246 offset:9216
  v_mfma_f32_16x16x32_bf16 v[32:35], v[212:215], v[184:187], v[32:35]
  ds_read_b128 v[100:103], v200 offset:0
  ds_read_b128 v[112:115], v201 offset:0
  v_mfma_f32_16x16x32_bf16 v[64:67], v[212:215], v[188:191], v[64:67]
  v_mfma_f32_16x16x32_bf16 v[4:7], v[216:219], v[180:183], v[4:7]
  v_mfma_f32_16x16x32_bf16 v[36:39], v[216:219], v[184:187], v[36:39]
  v_mfma_f32_16x16x32_bf16 v[68:71], v[216:219], v[188:191], v[68:71]
  s_waitcnt lgkmcnt(8)
  v_mfma_f32_16x16x32_bf16 v[8:11], v[220:223], v[180:183], v[8:11]
  ds_read_b64_tr_b16 v[212:213], v246 offset:8200
  ds_read_b64_tr_b16 v[214:215], v246 offset:9224
  v_mfma_f32_16x16x32_bf16 v[40:43], v[220:223], v[184:187], v[40:43]
  ds_read_b64_tr_b16 v[216:217], v247 offset:8192
  ds_read_b64_tr_b16 v[218:219], v247 offset:9216
  v_mfma_f32_16x16x32_bf16 v[72:75], v[220:223], v[188:191], v[72:75]
  ds_write_b128 v202, v[104:107] offset:0
  ds_write_b128 v202, v[116:119] offset:1024
  v_mfma_f32_16x16x32_bf16 v[12:15], v[204:207], v[180:183], v[12:15]
  v_mfma_f32_16x16x32_bf16 v[44:47], v[204:207], v[184:187], v[44:47]
  v_mfma_f32_16x16x32_bf16 v[76:79], v[204:207], v[188:191], v[76:79]
  s_waitcnt lgkmcnt(4)
  v_mfma_f32_16x16x32_bf16 v[16:19], v[208:211], v[180:183], v[16:19]
  ds_read_b64_tr_b16 v[220:221], v247 offset:8200
  ds_read_b64_tr_b16 v[222:223], v247 offset:9224
  v_mfma_f32_16x16x32_bf16 v[48:51], v[208:211], v[184:187], v[48:51]
  ds_read_b128 v[104:107], v200 offset:0
  ds_read_b128 v[116:119], v201 offset:0
  v_mfma_f32_16x16x32_bf16 v[80:83], v[208:211], v[188:191], v[80:83]
  s_waitcnt lgkmcnt(0)
  s_barrier
  v_mfma_f32_16x16x32_bf16 v[20:23], v[212:215], v[180:183], v[20:23]
  ds_read_b64_tr_b16 v[204:205], v244 offset:16384
  ds_read_b64_tr_b16 v[206:207], v244 offset:17408
  v_mfma_f32_16x16x32_bf16 v[52:55], v[212:215], v[184:187], v[52:55]
  ds_read_b64_tr_b16 v[208:209], v244 offset:16392
  ds_read_b64_tr_b16 v[210:211], v244 offset:17416
  v_mfma_f32_16x16x32_bf16 v[84:87], v[212:215], v[188:191], v[84:87]
  v_mfma_f32_16x16x32_bf16 v[24:27], v[216:219], v[180:183], v[24:27]
  ds_read_b64_tr_b16 v[212:213], v245 offset:16384
  ds_read_b64_tr_b16 v[214:215], v245 offset:17408
  v_mfma_f32_16x16x32_bf16 v[56:59], v[216:219], v[184:187], v[56:59]
  v_mfma_f32_16x16x32_bf16 v[88:91], v[216:219], v[188:191], v[88:91]
  v_mfma_f32_16x16x32_bf16 v[28:31], v[220:223], v[180:183], v[28:31]
  ds_read_b64_tr_b16 v[216:217], v245 offset:16392
  ds_read_b64_tr_b16 v[218:219], v245 offset:17416
  v_mfma_f32_16x16x32_bf16 v[60:63], v[220:223], v[184:187], v[60:63]
  v_mfma_f32_16x16x32_bf16 v[92:95], v[220:223], v[188:191], v[92:95]
  s_waitcnt lgkmcnt(4)
  v_mfma_f32_16x16x32_bf16 v[0:3], v[204:207], v[96:99], v[0:3]
  ds_read_b64_tr_b16 v[220:221], v246 offset:16384
  ds_read_b64_tr_b16 v[222:223], v246 offset:17408
  v_mfma_f32_16x16x32_bf16 v[32:35], v[204:207], v[100:103], v[32:35]
  s_add_u32 s84, s38, s99
  s_add_u32 s85, s39, s99
  s_add_u32 s86, s40, s99
  v_mfma_f32_16x16x32_bf16 v[64:67], v[204:207], v[104:107], v[64:67]
  v_mfma_f32_16x16x32_bf16 v[4:7], v[208:211], v[96:99], v[4:7]
  ds_read_b64_tr_b16 v[224:225], v246 offset:16392
  ds_read_b64_tr_b16 v[226:227], v246 offset:17416
  v_mfma_f32_16x16x32_bf16 v[36:39], v[208:211], v[100:103], v[36:39]
  v_mfma_f32_16x16x32_bf16 v[68:71], v[208:211], v[104:107], v[68:71]
  s_waitcnt lgkmcnt(4)
  v_mfma_f32_16x16x32_bf16 v[8:11], v[212:215], v[96:99], v[8:11]
  ds_read_b64_tr_b16 v[204:205], v247 offset:16384
  ds_read_b64_tr_b16 v[206:207], v247 offset:17408
  v_mfma_f32_16x16x32_bf16 v[40:43], v[212:215], v[100:103], v[40:43]
  v_mfma_f32_16x16x32_bf16 v[72:75], v[212:215], v[104:107], v[72:75]
  v_mfma_f32_16x16x32_bf16 v[12:15], v[216:219], v[96:99], v[12:15]
  ds_read_b64_tr_b16 v[208:209], v247 offset:16392
  ds_read_b64_tr_b16 v[210:211], v247 offset:17416
  v_mfma_f32_16x16x32_bf16 v[44:47], v[216:219], v[100:103], v[44:47]
  v_mfma_f32_16x16x32_bf16 v[76:79], v[216:219], v[104:107], v[76:79]
  buffer_load_dwordx4 v[168:171], v198, s[20:23], s84 offen
  buffer_load_dwordx4 v[180:183], v199, s[20:23], s84 offen
  s_waitcnt lgkmcnt(4)
  v_mfma_f32_16x16x32_bf16 v[16:19], v[220:223], v[96:99], v[16:19]
  buffer_load_dwordx4 v[172:175], v198, s[20:23], s85 offen
  buffer_load_dwordx4 v[184:187], v199, s[20:23], s85 offen
  v_mfma_f32_16x16x32_bf16 v[48:51], v[220:223], v[100:103], v[48:51]
  buffer_load_dwordx4 v[176:179], v198, s[20:23], s86 offen
  buffer_load_dwordx4 v[188:191], v199, s[20:23], s86 offen
  v_mfma_f32_16x16x32_bf16 v[80:83], v[220:223], v[104:107], v[80:83]
  s_waitcnt lgkmcnt(0)
  s_barrier
  v_mfma_f32_16x16x32_bf16 v[20:23], v[224:227], v[96:99], v[20:23]
  ds_read_b64_tr_b16 v[212:213], v244 offset:0
  ds_read_b64_tr_b16 v[214:215], v244 offset:1024
  v_mfma_f32_16x16x32_bf16 v[52:55], v[224:227], v[100:103], v[52:55]
  ds_read_b64_tr_b16 v[216:217], v244 offset:8
  ds_read_b64_tr_b16 v[218:219], v244 offset:1032
  v_mfma_f32_16x16x32_bf16 v[84:87], v[224:227], v[104:107], v[84:87]
  s_waitcnt vmcnt(12)
  v_mfma_f32_16x16x32_bf16 v[24:27], v[204:207], v[96:99], v[24:27]
  ds_read_b64_tr_b16 v[220:221], v245 offset:0
  ds_read_b64_tr_b16 v[222:223], v245 offset:1024
  v_mfma_f32_16x16x32_bf16 v[56:59], v[204:207], v[100:103], v[56:59]
  s_add_u32 s99, s99, 128
  s_and_b32 s99, s99, 1023
  v_mfma_f32_16x16x32_bf16 v[88:91], v[204:207], v[104:107], v[88:91]
  ds_write_b128 v202, v[120:123] offset:0
  ds_write_b128 v202, v[132:135] offset:1024
  v_mfma_f32_16x16x32_bf16 v[28:31], v[208:211], v[96:99], v[28:31]
  ds_read_b64_tr_b16 v[204:205], v245 offset:8
  ds_read_b64_tr_b16 v[206:207], v245 offset:1032
  v_mfma_f32_16x16x32_bf16 v[60:63], v[208:211], v[100:103], v[60:63]
  ds_read_b128 v[120:123], v200 offset:0
  ds_read_b128 v[132:135], v201 offset:0
  v_mfma_f32_16x16x32_bf16 v[92:95], v[208:211], v[104:107], v[92:95]
  ds_write_b128 v202, v[124:127] offset:0
  ds_write_b128 v202, v[136:139] offset:1024
  s_waitcnt lgkmcnt(10)
  v_mfma_f32_16x16x32_bf16 v[0:3], v[212:215], v[108:111], v[0:3]
  ds_read_b64_tr_b16 v[208:209], v246 offset:0
  ds_read_b64_tr_b16 v[210:211], v246 offset:1024
  v_mfma_f32_16x16x32_bf16 v[32:35], v[212:215], v[112:115], v[32:35]
  ds_read_b128 v[124:127], v200 offset:0
  ds_read_b128 v[136:139], v201 offset:0
  v_mfma_f32_16x16x32_bf16 v[64:67], v[212:215], v[116:119], v[64:67]
  v_mfma_f32_16x16x32_bf16 v[4:7], v[216:219], v[108:111], v[4:7]
  v_mfma_f32_16x16x32_bf16 v[36:39], v[216:219], v[112:115], v[36:39]
  v_mfma_f32_16x16x32_bf16 v[68:71], v[216:219], v[116:119], v[68:71]
  s_waitcnt lgkmcnt(8)
  v_mfma_f32_16x16x32_bf16 v[8:11], v[220:223], v[108:111], v[8:11]
  ds_read_b64_tr_b16 v[212:213], v246 offset:8
  ds_read_b64_tr_b16 v[214:215], v246 offset:1032
  v_mfma_f32_16x16x32_bf16 v[40:43], v[220:223], v[112:115], v[40:43]
  ds_read_b64_tr_b16 v[216:217], v247 offset:0
  ds_read_b64_tr_b16 v[218:219], v247 offset:1024
  v_mfma_f32_16x16x32_bf16 v[72:75], v[220:223], v[116:119], v[72:75]
  ds_write_b128 v202, v[128:131] offset:0
  ds_write_b128 v202, v[140:143] offset:1024
  v_mfma_f32_16x16x32_bf16 v[12:15], v[204:207], v[108:111], v[12:15]
  v_mfma_f32_16x16x32_bf16 v[44:47], v[204:207], v[112:115], v[44:47]
  v_mfma_f32_16x16x32_bf16 v[76:79], v[204:207], v[116:119], v[76:79]
  s_waitcnt lgkmcnt(4)
  v_mfma_f32_16x16x32_bf16 v[16:19], v[208:211], v[108:111], v[16:19]
  ds_read_b64_tr_b16 v[220:221], v247 offset:8
  ds_read_b64_tr_b16 v[222:223], v247 offset:1032
  v_mfma_f32_16x16x32_bf16 v[48:51], v[208:211], v[112:115], v[48:51]
  ds_read_b128 v[128:131], v200 offset:0
  ds_read_b128 v[140:143], v201 offset:0
  v_mfma_f32_16x16x32_bf16 v[80:83], v[208:211], v[116:119], v[80:83]
  s_waitcnt lgkmcnt(0)
  s_barrier
  v_mfma_f32_16x16x32_bf16 v[20:23], v[212:215], v[108:111], v[20:23]
  ds_read_b64_tr_b16 v[204:205], v244 offset:8192
  ds_read_b64_tr_b16 v[206:207], v244 offset:9216
  v_mfma_f32_16x16x32_bf16 v[52:55], v[212:215], v[112:115], v[52:55]
  ds_read_b64_tr_b16 v[208:209], v244 offset:8200
  ds_read_b64_tr_b16 v[210:211], v244 offset:9224
  v_mfma_f32_16x16x32_bf16 v[84:87], v[212:215], v[116:119], v[84:87]
  v_mfma_f32_16x16x32_bf16 v[24:27], v[216:219], v[108:111], v[24:27]
  ds_read_b64_tr_b16 v[212:213], v245 offset:8192
  ds_read_b64_tr_b16 v[214:215], v245 offset:9216
  v_mfma_f32_16x16x32_bf16 v[56:59], v[216:219], v[112:115], v[56:59]
  v_mfma_f32_16x16x32_bf16 v[88:91], v[216:219], v[116:119], v[88:91]
  v_mfma_f32_16x16x32_bf16 v[28:31], v[220:223], v[108:111], v[28:31]
  ds_read_b64_tr_b16 v[216:217], v245 offset:8200
  ds_read_b64_tr_b16 v[218:219], v245 offset:9224
  v_mfma_f32_16x16x32_bf16 v[60:63], v[220:223], v[112:115], v[60:63]
  v_mfma_f32_16x16x32_bf16 v[92:95], v[220:223], v[116:119], v[92:95]
  s_waitcnt lgkmcnt(4)
  v_mfma_f32_16x16x32_bf16 v[0:3], v[204:207], v[120:123], v[0:3]
  ds_read_b64_tr_b16 v[220:221], v246 offset:8192
  ds_read_b64_tr_b16 v[222:223], v246 offset:9216
  v_mfma_f32_16x16x32_bf16 v[32:35], v[204:207], v[124:127], v[32:35]
  v_mfma_f32_16x16x32_bf16 v[64:67], v[204:207], v[128:131], v[64:67]
  v_mfma_f32_16x16x32_bf16 v[4:7], v[208:211], v[120:123], v[4:7]
  ds_read_b64_tr_b16 v[224:225], v246 offset:8200
  ds_read_b64_tr_b16 v[226:227], v246 offset:9224
  v_mfma_f32_16x16x32_bf16 v[36:39], v[208:211], v[124:127], v[36:39]
  v_mfma_f32_16x16x32_bf16 v[68:71], v[208:211], v[128:131], v[68:71]
  s_waitcnt lgkmcnt(4)
  v_mfma_f32_16x16x32_bf16 v[8:11], v[212:215], v[120:123], v[8:11]
  ds_read_b64_tr_b16 v[204:205], v247 offset:8192
  ds_read_b64_tr_b16 v[206:207], v247 offset:9216
  v_mfma_f32_16x16x32_bf16 v[40:43], v[212:215], v[124:127], v[40:43]
  v_mfma_f32_16x16x32_bf16 v[72:75], v[212:215], v[128:131], v[72:75]
  v_mfma_f32_16x16x32_bf16 v[12:15], v[216:219], v[120:123], v[12:15]
  ds_read_b64_tr_b16 v[208:209], v247 offset:8200
  ds_read_b64_tr_b16 v[210:211], v247 offset:9224
  v_mfma_f32_16x16x32_bf16 v[44:47], v[216:219], v[124:127], v[44:47]
  v_mfma_f32_16x16x32_bf16 v[76:79], v[216:219], v[128:131], v[76:79]
  s_waitcnt lgkmcnt(4)
  v_mfma_f32_16x16x32_bf16 v[16:19], v[220:223], v[120:123], v[16:19]
  v_mfma_f32_16x16x32_bf16 v[48:51], v[220:223], v[124:127], v[48:51]
  v_mfma_f32_16x16x32_bf16 v[80:83], v[220:223], v[128:131], v[80:83]
  s_waitcnt lgkmcnt(0)
  s_barrier
  v_mfma_f32_16x16x32_bf16 v[20:23], v[224:227], v[120:123], v[20:23]
  ds_read_b64_tr_b16 v[212:213], v244 offset:16384
  ds_read_b64_tr_b16 v[214:215], v244 offset:17408
  v_mfma_f32_16x16x32_bf16 v[52:55], v[224:227], v[124:127], v[52:55]
  ds_read_b64_tr_b16 v[216:217], v244 offset:16392
  ds_read_b64_tr_b16 v[218:219], v244 offset:17416
  v_mfma_f32_16x16x32_bf16 v[84:87], v[224:227], v[128:131], v[84:87]
  s_waitcnt vmcnt(6)
  v_mfma_f32_16x16x32_bf16 v[24:27], v[204:207], v[120:123], v[24:27]
  ds_read_b64_tr_b16 v[220:221], v245 offset:16384
  ds_read_b64_tr_b16 v[222:223], v245 offset:17408
  v_mfma_f32_16x16x32_bf16 v[56:59], v[204:207], v[124:127], v[56:59]
  ds_write_b128 v202, v[144:147] offset:0
  ds_write_b128 v202, v[156:159] offset:1024
  v_mfma_f32_16x16x32_bf16 v[88:91], v[204:207], v[128:131], v[88:91]
  ds_read_b128 v[144:147], v200 offset:0
  ds_read_b128 v[156:159], v201 offset:0
  v_mfma_f32_16x16x32_bf16 v[28:31], v[208:211], v[120:123], v[28:31]
  ds_read_b64_tr_b16 v[204:205], v245 offset:16392
  ds_read_b64_tr_b16 v[206:207], v245 offset:17416
  v_mfma_f32_16x16x32_bf16 v[60:63], v[208:211], v[124:127], v[60:63]
  ds_write_b128 v202, v[148:151] offset:0
  ds_write_b128 v202, v[160:163] offset:1024
  v_mfma_f32_16x16x32_bf16 v[92:95], v[208:211], v[128:131], v[92:95]
  s_waitcnt lgkmcnt(10)
  v_mfma_f32_16x16x32_bf16 v[0:3], v[212:215], v[132:135], v[0:3]
  ds_read_b64_tr_b16 v[208:209], v246 offset:16384
  ds_read_b64_tr_b16 v[210:211], v246 offset:17408
  v_mfma_f32_16x16x32_bf16 v[32:35], v[212:215], v[136:139], v[32:35]
  ds_read_b128 v[148:151], v200 offset:0
  ds_read_b128 v[160:163], v201 offset:0
  v_mfma_f32_16x16x32_bf16 v[64:67], v[212:215], v[140:143], v[64:67]
  v_mfma_f32_16x16x32_bf16 v[4:7], v[216:219], v[132:135], v[4:7]
  v_mfma_f32_16x16x32_bf16 v[36:39], v[216:219], v[136:139], v[36:39]
  v_mfma_f32_16x16x32_bf16 v[68:71], v[216:219], v[140:143], v[68:71]
  s_waitcnt lgkmcnt(6)
  v_mfma_f32_16x16x32_bf16 v[8:11], v[220:223], v[132:135], v[8:11]
  ds_read_b64_tr_b16 v[212:213], v246 offset:16392
  ds_read_b64_tr_b16 v[214:215], v246 offset:17416
  v_mfma_f32_16x16x32_bf16 v[40:43], v[220:223], v[136:139], v[40:43]
  ds_read_b64_tr_b16 v[216:217], v247 offset:16384
  ds_read_b64_tr_b16 v[218:219], v247 offset:17408
  v_mfma_f32_16x16x32_bf16 v[72:75], v[220:223], v[140:143], v[72:75]
  ds_write_b128 v202, v[152:155] offset:0
  ds_write_b128 v202, v[164:167] offset:1024
  v_mfma_f32_16x16x32_bf16 v[12:15], v[204:207], v[132:135], v[12:15]
  ds_read_b64_tr_b16 v[220:221], v247 offset:16392
  ds_read_b64_tr_b16 v[222:223], v247 offset:17416
  v_mfma_f32_16x16x32_bf16 v[44:47], v[204:207], v[136:139], v[44:47]
  v_mfma_f32_16x16x32_bf16 v[76:79], v[204:207], v[140:143], v[76:79]
  s_waitcnt lgkmcnt(6)
  v_mfma_f32_16x16x32_bf16 v[16:19], v[208:211], v[132:135], v[16:19]
  ds_read_b128 v[152:155], v200 offset:0
  ds_read_b128 v[164:167], v201 offset:0
  v_mfma_f32_16x16x32_bf16 v[48:51], v[208:211], v[136:139], v[48:51]
  v_mfma_f32_16x16x32_bf16 v[80:83], v[208:211], v[140:143], v[80:83]
  s_waitcnt lgkmcnt(0)
  s_barrier
  v_mfma_f32_16x16x32_bf16 v[20:23], v[212:215], v[132:135], v[20:23]
  ds_read_b64_tr_b16 v[204:205], v244 offset:0
  ds_read_b64_tr_b16 v[206:207], v244 offset:1024
  v_mfma_f32_16x16x32_bf16 v[52:55], v[212:215], v[136:139], v[52:55]
  ds_read_b64_tr_b16 v[208:209], v244 offset:8
  ds_read_b64_tr_b16 v[210:211], v244 offset:1032
  v_mfma_f32_16x16x32_bf16 v[84:87], v[212:215], v[140:143], v[84:87]
  v_mfma_f32_16x16x32_bf16 v[24:27], v[216:219], v[132:135], v[24:27]
  ds_read_b64_tr_b16 v[212:213], v245 offset:0
  ds_read_b64_tr_b16 v[214:215], v245 offset:1024
  v_mfma_f32_16x16x32_bf16 v[56:59], v[216:219], v[136:139], v[56:59]
  v_mfma_f32_16x16x32_bf16 v[88:91], v[216:219], v[140:143], v[88:91]
  v_mfma_f32_16x16x32_bf16 v[28:31], v[220:223], v[132:135], v[28:31]
  ds_read_b64_tr_b16 v[216:217], v245 offset:8
  ds_read_b64_tr_b16 v[218:219], v245 offset:1032
  v_mfma_f32_16x16x32_bf16 v[60:63], v[220:223], v[136:139], v[60:63]
  v_mfma_f32_16x16x32_bf16 v[92:95], v[220:223], v[140:143], v[92:95]
  s_waitcnt lgkmcnt(4)
  v_mfma_f32_16x16x32_bf16 v[0:3], v[204:207], v[144:147], v[0:3]
  ds_read_b64_tr_b16 v[220:221], v246 offset:0
  ds_read_b64_tr_b16 v[222:223], v246 offset:1024
  v_mfma_f32_16x16x32_bf16 v[32:35], v[204:207], v[148:151], v[32:35]
  v_mfma_f32_16x16x32_bf16 v[64:67], v[204:207], v[152:155], v[64:67]
  v_mfma_f32_16x16x32_bf16 v[4:7], v[208:211], v[144:147], v[4:7]
  ds_read_b64_tr_b16 v[224:225], v246 offset:8
  ds_read_b64_tr_b16 v[226:227], v246 offset:1032
  v_mfma_f32_16x16x32_bf16 v[36:39], v[208:211], v[148:151], v[36:39]
  v_mfma_f32_16x16x32_bf16 v[68:71], v[208:211], v[152:155], v[68:71]
  s_waitcnt lgkmcnt(4)
  v_mfma_f32_16x16x32_bf16 v[8:11], v[212:215], v[144:147], v[8:11]
  ds_read_b64_tr_b16 v[204:205], v247 offset:0
  ds_read_b64_tr_b16 v[206:207], v247 offset:1024
  v_mfma_f32_16x16x32_bf16 v[40:43], v[212:215], v[148:151], v[40:43]
  v_mfma_f32_16x16x32_bf16 v[72:75], v[212:215], v[152:155], v[72:75]
  v_mfma_f32_16x16x32_bf16 v[12:15], v[216:219], v[144:147], v[12:15]
  ds_read_b64_tr_b16 v[208:209], v247 offset:8
  ds_read_b64_tr_b16 v[210:211], v247 offset:1032
  v_mfma_f32_16x16x32_bf16 v[44:47], v[216:219], v[148:151], v[44:47]
  v_and_b32 v195, 112, v253
  v_lshrrev_b32 v195, 1, v195
  buffer_load_dwordx2 v[196:197], v195, s[24:27], s87 offen sc1
  v_mfma_f32_16x16x32_bf16 v[76:79], v[216:219], v[152:155], v[76:79]
  s_waitcnt lgkmcnt(4)
  v_mfma_f32_16x16x32_bf16 v[16:19], v[220:223], v[144:147], v[16:19]
  v_mfma_f32_16x16x32_bf16 v[48:51], v[220:223], v[148:151], v[48:51]
  v_mfma_f32_16x16x32_bf16 v[80:83], v[220:223], v[152:155], v[80:83]
  s_waitcnt lgkmcnt(0)
  s_barrier
  v_mfma_f32_16x16x32_bf16 v[20:23], v[224:227], v[144:147], v[20:23]
  ds_read_b64_tr_b16 v[212:213], v244 offset:8192
  ds_read_b64_tr_b16 v[214:215], v244 offset:9216
  v_mfma_f32_16x16x32_bf16 v[52:55], v[224:227], v[148:151], v[52:55]
  ds_read_b64_tr_b16 v[216:217], v244 offset:8200
  ds_read_b64_tr_b16 v[218:219], v244 offset:9224
  v_mfma_f32_16x16x32_bf16 v[84:87], v[224:227], v[152:155], v[84:87]
  s_waitcnt vmcnt(1)
  v_mfma_f32_16x16x32_bf16 v[24:27], v[204:207], v[144:147], v[24:27]
  ds_read_b64_tr_b16 v[220:221], v245 offset:8192
  ds_read_b64_tr_b16 v[222:223], v245 offset:9216
  v_mfma_f32_16x16x32_bf16 v[56:59], v[204:207], v[148:151], v[56:59]
  ds_write_b128 v202, v[168:171] offset:0
  ds_write_b128 v202, v[180:183] offset:1024
  v_mfma_f32_16x16x32_bf16 v[88:91], v[204:207], v[152:155], v[88:91]
  ds_read_b128 v[168:171], v200 offset:0
  ds_read_b128 v[180:183], v201 offset:0
  v_mfma_f32_16x16x32_bf16 v[28:31], v[208:211], v[144:147], v[28:31]
  ds_read_b64_tr_b16 v[204:205], v245 offset:8200
  ds_read_b64_tr_b16 v[206:207], v245 offset:9224
  v_mfma_f32_16x16x32_bf16 v[60:63], v[208:211], v[148:151], v[60:63]
  ds_write_b128 v202, v[172:175] offset:0
  ds_write_b128 v202, v[184:187] offset:1024
  v_mfma_f32_16x16x32_bf16 v[92:95], v[208:211], v[152:155], v[92:95]
  s_waitcnt lgkmcnt(10)
  v_mfma_f32_16x16x32_bf16 v[0:3], v[212:215], v[156:159], v[0:3]
  ds_read_b64_tr_b16 v[208:209], v246 offset:8192
  ds_read_b64_tr_b16 v[210:211], v246 offset:9216
  v_mfma_f32_16x16x32_bf16 v[32:35], v[212:215], v[160:163], v[32:35]
  ds_read_b128 v[172:175], v200 offset:0
  ds_read_b128 v[184:187], v201 offset:0
  v_mfma_f32_16x16x32_bf16 v[64:67], v[212:215], v[164:167], v[64:67]
  v_mfma_f32_16x16x32_bf16 v[4:7], v[216:219], v[156:159], v[4:7]
  v_mfma_f32_16x16x32_bf16 v[36:39], v[216:219], v[160:163], v[36:39]
  v_mfma_f32_16x16x32_bf16 v[68:71], v[216:219], v[164:167], v[68:71]
  s_waitcnt lgkmcnt(6)
  v_mfma_f32_16x16x32_bf16 v[8:11], v[220:223], v[156:159], v[8:11]
  ds_read_b64_tr_b16 v[212:213], v246 offset:8200
  ds_read_b64_tr_b16 v[214:215], v246 offset:9224
  v_mfma_f32_16x16x32_bf16 v[40:43], v[220:223], v[160:163], v[40:43]
  ds_read_b64_tr_b16 v[216:217], v247 offset:8192
  ds_read_b64_tr_b16 v[218:219], v247 offset:9216
  v_mfma_f32_16x16x32_bf16 v[72:75], v[220:223], v[164:167], v[72:75]
  ds_write_b128 v202, v[176:179] offset:0
  ds_write_b128 v202, v[188:191] offset:1024
  v_mfma_f32_16x16x32_bf16 v[12:15], v[204:207], v[156:159], v[12:15]
  ds_read_b64_tr_b16 v[220:221], v247 offset:8200
  ds_read_b64_tr_b16 v[222:223], v247 offset:9224
  v_mfma_f32_16x16x32_bf16 v[44:47], v[204:207], v[160:163], v[44:47]
  v_mfma_f32_16x16x32_bf16 v[76:79], v[204:207], v[164:167], v[76:79]
  s_waitcnt lgkmcnt(6)
  v_mfma_f32_16x16x32_bf16 v[16:19], v[208:211], v[156:159], v[16:19]
  ds_read_b128 v[176:179], v200 offset:0
  ds_read_b128 v[188:191], v201 offset:0
  v_mfma_f32_16x16x32_bf16 v[48:51], v[208:211], v[160:163], v[48:51]
  v_mfma_f32_16x16x32_bf16 v[80:83], v[208:211], v[164:167], v[80:83]
  s_waitcnt lgkmcnt(0)
  s_barrier
  v_mfma_f32_16x16x32_bf16 v[20:23], v[212:215], v[156:159], v[20:23]
  ds_read_b64_tr_b16 v[204:205], v244 offset:16384
  ds_read_b64_tr_b16 v[206:207], v244 offset:17408
  v_mfma_f32_16x16x32_bf16 v[52:55], v[212:215], v[160:163], v[52:55]
  ds_read_b64_tr_b16 v[208:209], v244 offset:16392
  ds_read_b64_tr_b16 v[210:211], v244 offset:17416
  v_mfma_f32_16x16x32_bf16 v[84:87], v[212:215], v[164:167], v[84:87]
  v_mfma_f32_16x16x32_bf16 v[24:27], v[216:219], v[156:159], v[24:27]
  ds_read_b64_tr_b16 v[212:213], v245 offset:16384
  ds_read_b64_tr_b16 v[214:215], v245 offset:17408
  v_mfma_f32_16x16x32_bf16 v[56:59], v[216:219], v[160:163], v[56:59]
  v_mfma_f32_16x16x32_bf16 v[88:91], v[216:219], v[164:167], v[88:91]
  v_mfma_f32_16x16x32_bf16 v[28:31], v[220:223], v[156:159], v[28:31]
  ds_read_b64_tr_b16 v[216:217], v245 offset:16392
  ds_read_b64_tr_b16 v[218:219], v245 offset:17416
  v_mfma_f32_16x16x32_bf16 v[60:63], v[220:223], v[160:163], v[60:63]
  v_mfma_f32_16x16x32_bf16 v[92:95], v[220:223], v[164:167], v[92:95]
  s_waitcnt lgkmcnt(4)
  v_mfma_f32_16x16x32_bf16 v[0:3], v[204:207], v[168:171], v[0:3]
  ds_read_b64_tr_b16 v[220:221], v246 offset:16384
  ds_read_b64_tr_b16 v[222:223], v246 offset:17408
  v_mfma_f32_16x16x32_bf16 v[32:35], v[204:207], v[172:175], v[32:35]
  v_mfma_f32_16x16x32_bf16 v[64:67], v[204:207], v[176:179], v[64:67]
  v_mfma_f32_16x16x32_bf16 v[4:7], v[208:211], v[168:171], v[4:7]
  ds_read_b64_tr_b16 v[224:225], v246 offset:16392
  ds_read_b64_tr_b16 v[226:227], v246 offset:17416
  v_mfma_f32_16x16x32_bf16 v[36:39], v[208:211], v[172:175], v[36:39]
  v_mfma_f32_16x16x32_bf16 v[68:71], v[208:211], v[176:179], v[68:71]
  s_waitcnt lgkmcnt(4)
  v_mfma_f32_16x16x32_bf16 v[8:11], v[212:215], v[168:171], v[8:11]
  ds_read_b64_tr_b16 v[204:205], v247 offset:16384
  ds_read_b64_tr_b16 v[206:207], v247 offset:17408
  v_mfma_f32_16x16x32_bf16 v[40:43], v[212:215], v[172:175], v[40:43]
  v_mfma_f32_16x16x32_bf16 v[72:75], v[212:215], v[176:179], v[72:75]
  v_mfma_f32_16x16x32_bf16 v[12:15], v[216:219], v[168:171], v[12:15]
  ds_read_b64_tr_b16 v[208:209], v247 offset:16392
  ds_read_b64_tr_b16 v[210:211], v247 offset:17416
  v_mfma_f32_16x16x32_bf16 v[44:47], v[216:219], v[172:175], v[44:47]
  v_mfma_f32_16x16x32_bf16 v[76:79], v[216:219], v[176:179], v[76:79]
  s_waitcnt lgkmcnt(4)
  v_mfma_f32_16x16x32_bf16 v[16:19], v[220:223], v[168:171], v[16:19]
  v_mfma_f32_16x16x32_bf16 v[48:51], v[220:223], v[172:175], v[48:51]
  v_mfma_f32_16x16x32_bf16 v[80:83], v[220:223], v[176:179], v[80:83]
  s_waitcnt lgkmcnt(0)
  s_barrier
  v_mfma_f32_16x16x32_bf16 v[20:23], v[224:227], v[168:171], v[20:23]
  ds_read_b64_tr_b16 v[212:213], v244 offset:0
  ds_read_b64_tr_b16 v[214:215], v244 offset:1024
  v_mfma_f32_16x16x32_bf16 v[52:55], v[224:227], v[172:175], v[52:55]
  ds_read_b64_tr_b16 v[216:217], v244 offset:8
  ds_read_b64_tr_b16 v[218:219], v244 offset:1032
  v_mfma_f32_16x16x32_bf16 v[84:87], v[224:227], v[176:179], v[84:87]
  v_mfma_f32_16x16x32_bf16 v[24:27], v[204:207], v[168:171], v[24:27]
  ds_read_b64_tr_b16 v[220:221], v245 offset:0
  ds_read_b64_tr_b16 v[222:223], v245 offset:1024
  v_mfma_f32_16x16x32_bf16 v[56:59], v[204:207], v[172:175], v[56:59]
  v_mfma_f32_16x16x32_bf16 v[88:91], v[204:207], v[176:179], v[88:91]
  v_mfma_f32_16x16x32_bf16 v[28:31], v[208:211], v[168:171], v[28:31]
  ds_read_b64_tr_b16 v[204:205], v245 offset:8
  ds_read_b64_tr_b16 v[206:207], v245 offset:1032
  v_mfma_f32_16x16x32_bf16 v[60:63], v[208:211], v[172:175], v[60:63]
  v_mfma_f32_16x16x32_bf16 v[92:95], v[208:211], v[176:179], v[92:95]
  s_waitcnt lgkmcnt(4)
  v_mfma_f32_16x16x32_bf16 v[0:3], v[212:215], v[180:183], v[0:3]
  ds_read_b64_tr_b16 v[208:209], v246 offset:0
  ds_read_b64_tr_b16 v[210:211], v246 offset:1024
  v_mfma_f32_16x16x32_bf16 v[32:35], v[212:215], v[184:187], v[32:35]
  v_mfma_f32_16x16x32_bf16 v[64:67], v[212:215], v[188:191], v[64:67]
  v_mfma_f32_16x16x32_bf16 v[4:7], v[216:219], v[180:183], v[4:7]
  ds_read_b64_tr_b16 v[212:213], v246 offset:8
  ds_read_b64_tr_b16 v[214:215], v246 offset:1032
  v_mfma_f32_16x16x32_bf16 v[36:39], v[216:219], v[184:187], v[36:39]
  v_mfma_f32_16x16x32_bf16 v[68:71], v[216:219], v[188:191], v[68:71]
  s_waitcnt lgkmcnt(4)
  v_mfma_f32_16x16x32_bf16 v[8:11], v[220:223], v[180:183], v[8:11]
  ds_read_b64_tr_b16 v[216:217], v247 offset:0
  ds_read_b64_tr_b16 v[218:219], v247 offset:1024
  v_mfma_f32_16x16x32_bf16 v[40:43], v[220:223], v[184:187], v[40:43]
  v_mfma_f32_16x16x32_bf16 v[72:75], v[220:223], v[188:191], v[72:75]
  v_mfma_f32_16x16x32_bf16 v[12:15], v[204:207], v[180:183], v[12:15]
  ds_read_b64_tr_b16 v[220:221], v247 offset:8
  ds_read_b64_tr_b16 v[222:223], v247 offset:1032
  v_mfma_f32_16x16x32_bf16 v[44:47], v[204:207], v[184:187], v[44:47]
  v_mfma_f32_16x16x32_bf16 v[76:79], v[204:207], v[188:191], v[76:79]
  s_waitcnt lgkmcnt(4)
  v_mfma_f32_16x16x32_bf16 v[16:19], v[208:211], v[180:183], v[16:19]
  v_mfma_f32_16x16x32_bf16 v[48:51], v[208:211], v[184:187], v[48:51]
  v_mfma_f32_16x16x32_bf16 v[80:83], v[208:211], v[188:191], v[80:83]
  s_waitcnt lgkmcnt(0)
  s_barrier
  s_waitcnt vmcnt(0)
  v_cmp_eq_u32 vcc, s58, v196
  v_cmp_eq_u32 s[4:5], s83, v197
  s_nop 3
  s_and_b64 vcc, vcc, s[4:5]
  s_cmp_eq_u64 vcc, exec
  s_cselect_b32 s3, 1, 0
  s_branch L_att0
L_teamA:
  s_setprio 1
  s_mov_b32 s33, 0
  s_mov_b32 s45, s31
  s_mov_b32 s3, 0
  s_barrier
  s_lshl_b32 s6, s29, 3
  s_add_u32 s6, s6, s45
  s_lshl_b32 s6, s6, 5
  s_add_u32 s6, s6, s30
  s_mul_i32 s6, s6, 9
  s_mul_i32 s7, s32, 3
  s_add_u32 s6, s6, s7
  s_lshl_b32 s44, s6, 12
  s_mov_b32 s46, 0x3e0293ee
  s_mov_b32 s47, 0x3e0293ee
  v_and_b32 v5, 7, v4
  v_lshlrev_b32 v5, 1, v5
  v_xor_b32 v5, v5, v3
  v_lshlrev_b32 v5, 4, v5
  v_lshlrev_b32 v6, 8, v4
  v_add_u32 v232, v5, v6
  v_xor_b32 v233, 0x40, v232
  v_xor_b32 v234, 0x80, v232
  v_xor_b32 v235, 0xc0, v232
  v_lshrrev_b32 v7, 2, v4
  v_and_b32 v1, 3, v4
  v_lshlrev_b32 v5, 2, v3
  v_add_u32 v5, v5, v7
  v_and_b32 v6, 7, v5
  v_lshlrev_b32 v6, 5, v6
  v_lshlrev_b32 v5, 8, v5
  v_add_u32 v5, v5, v6
  v_lshlrev_b32 v6, 3, v1
  v_add_u32 v5, v5, v6
  v_add_u32 v236, 65536, v5
  v_xor_b32 v237, 32, v236
  v_xor_b32 v238, 64, v236
  v_xor_b32 v239, 96, v236
  v_xor_b32 v240, 128, v236
  v_xor_b32 v241, 160, v236
  v_xor_b32 v242, 192, v236
  v_xor_b32 v243, 224, v236
  v_and_b32 v5, 1, v3
  v_lshlrev_b32 v5, 2, v5
  v_or_b32 v5, v5, v7
  v_lshlrev_b32 v5, 1, v5
  v_xor_b32 v5, v5, v1
  v_lshlrev_b32 v5, 4, v5
  v_lshlrev_b32 v6, 3, v3
  v_add_u32 v6, v6, v7
  v_lshlrev_b32 v6, 8, v6
  v_add_u32 v244, v5, v6
  v_add_u32 v244, 81920, v244
  s_lshl_b32 s6, s32, 11
  s_add_u32 s6, s6, 155648
  v_add_u32 v202, s6, v253
  v_lshrrev_b32 v5, 1, v4
  v_xor_b32 v5, v5, v3
  v_lshlrev_b32 v5, 4, v5
  v_lshlrev_b32 v6, 7, v4
  v_add_u32 v200, v5, v6
  v_add_u32 v200, s6, v200
  v_xor_b32 v201, 0x40, v200
  v_xor_b32 v245, 0x40, v244
  v_xor_b32 v246, 0x80, v244
  v_xor_b32 v247, 0xc0, v244
  v_mov_b32 v228, 0x3f803f80
  v_mov_b32 v229, 0x3f803f80
  v_mov_b32 v230, 0x3f803f80
  v_mov_b32 v231, 0x3f803f80
  s_mul_i32 s6, s32, 4096
  s_add_u32 s6, s6, -139264
  v_add_u32 v200, s6, v200
  v_add_u32 v201, s6, v201
  s_cmp_eq_u32 s29, 0
  s_waitcnt lgkmcnt(0)
  s_cselect_b64 s[20:21], s[48:49], s[56:57]
  s_cselect_b64 s[8:9], s[50:51], s[58:59]
  s_cselect_b64 s[12:13], s[52:53], s[60:61]
  s_cselect_b64 s[16:17], s[54:55], s[62:63]
  s_load_dwordx4 s[52:55], s[0:1], 80
  s_and_b32 s61, s30, 7
  s_lshr_b32 s62, s30, 3
  s_mul_i32 s4, s61, 36864
  s_sub_u32 s60, s44, s4
  s_lshl_b32 s4, s33, 3
  s_and_b32 s5, s2, 7
  s_add_u32 s4, s4, s5
  s_lshl_b32 s4, s4, 2
  s_add_u32 s4, s4, s31
  s_mul_i32 s4, s4, 3
  s_add_u32 s4, s4, s32
  s_lshl_b32 s4, s4, 7
  s_add_u32 s64, s4, 48234496
  s_lshl_b32 s4, s61, 3
  s_add_u32 s65, s64, s4
  s_lshl_b32 s4, s33, 1
  s_add_u32 s4, s4, s29
  s_lshl_b32 s4, s4, 2
  s_add_u32 s4, s4, s31
  s_lshl_b32 s4, s4, 3
  s_add_u32 s4, s4, s61
  s_mul_i32 s5, s4, 3
  s_add_u32 s5, s5, s32
  s_lshl_b32 s5, s5, 7
  s_add_u32 s66, s5, 48300032
  s_lshl_b32 s5, s62, 3
  s_add_u32 s67, s66, s5
  s_lshl_b32 s4, s4, 17
  s_lshl_b32 s5, s32, 11
  s_add_u32 s4, s4, s5
  s_mov_b32 s101, 4096
  s_mov_b32 s88, 32768
  s_mul_i32 s89, s32, 48
  s_mov_b32 s90, 3
  s_add_u32 s98, s4, 20971520
  s_lshl_b32 s5, s31, 1
  s_sub_u32 s5, s61, s5
  s_add_u32 s4, s5, 0
  s_and_b32 s4, s4, 7
  s_lshl_b32 s4, s4, 2
  s_lshr_b32 s4, 0x36251098, s4
  s_and_b32 s4, s4, 15
  s_lshl_b32 s72, s4, 14
  s_add_u32 s4, s5, 1
  s_and_b32 s4, s4, 7
  s_lshl_b32 s4, s4, 2
  s_lshr_b32 s4, 0x36251098, s4
  s_and_b32 s4, s4, 15
  s_lshl_b32 s73, s4, 14
  s_add_u32 s4, s5, 2
  s_and_b32 s4, s4, 7
  s_lshl_b32 s4, s4, 2
  s_lshr_b32 s4, 0x36251098, s4
  s_and_b32 s4, s4, 15
  s_lshl_b32 s74, s4, 14
  s_add_u32 s4, s5, 3
  s_and_b32 s4, s4, 7
  s_lshl_b32 s4, s4, 2
  s_lshr_b32 s4, 0x36251098, s4
  s_and_b32 s4, s4, 15
  s_lshl_b32 s75, s4, 14
  s_add_u32 s4, s5, 4
  s_and_b32 s4, s4, 7
  s_lshl_b32 s4, s4, 2
  s_lshr_b32 s4, 0x36251098, s4
  s_and_b32 s4, s4, 15
  s_lshl_b32 s76, s4, 14
  s_add_u32 s4, s5, 5
  s_and_b32 s4, s4, 7
  s_lshl_b32 s4, s4, 2
  s_lshr_b32 s4, 0x36251098, s4
  s_and_b32 s4, s4, 15
  s_lshl_b32 s77, s4, 14
  s_add_u32 s4, s5, 6
  s_and_b32 s4, s4, 7
  s_lshl_b32 s4, s4, 2
  s_lshr_b32 s4, 0x36251098, s4
  s_and_b32 s4, s4, 15
  s_lshl_b32 s78, s4, 14
  s_add_u32 s4, s5, 7
  s_and_b32 s4, s4, 7
  s_lshl_b32 s4, s4, 2
  s_lshr_b32 s4, 0x36251098, s4
  s_and_b32 s4, s4, 15
  s_lshl_b32 s79, s4, 14
  s_waitcnt lgkmcnt(0)
  s_mov_b64 s[56:57], s[54:55]
  s_mov_b32 s54, 2359296
  s_mov_b32 s55, 0x20000
  s_barrier
  ds_read_b128 v[96:99], v200 offset:0
  ds_read_b128 v[100:103], v200 offset:2048
  ds_read_b128 v[104:107], v200 offset:4096
  ds_read_b64_tr_b16 v[204:205], v244 offset:49152
  ds_read_b64_tr_b16 v[206:207], v244 offset:50176
  ds_read_b64_tr_b16 v[208:209], v244 offset:49160
  ds_read_b64_tr_b16 v[210:211], v244 offset:50184
  s_waitcnt lgkmcnt(0)
  v_mfma_f32_16x16x32_bf16 v[0:3], v[204:207], v[96:99], 0
  ds_read_b64_tr_b16 v[212:213], v245 offset:49152
  ds_read_b64_tr_b16 v[214:215], v245 offset:50176
  v_mfma_f32_16x16x32_bf16 v[32:35], v[204:207], v[100:103], 0
  ds_read_b64_tr_b16 v[216:217], v245 offset:49160
  ds_read_b64_tr_b16 v[218:219], v245 offset:50184
  v_mfma_f32_16x16x32_bf16 v[64:67], v[204:207], v[104:107], 0
  ds_read_b64_tr_b16 v[220:221], v246 offset:49152
  ds_read_b64_tr_b16 v[222:223], v246 offset:50176
  v_mfma_f32_16x16x32_bf16 v[4:7], v[208:211], v[96:99], 0
  ds_read_b64_tr_b16 v[224:225], v246 offset:49160
  ds_read_b64_tr_b16 v[226:227], v246 offset:50184
  v_mfma_f32_16x16x32_bf16 v[36:39], v[208:211], v[100:103], 0
  ds_read_b128 v[108:111], v201 offset:0
  ds_read_b128 v[112:115], v201 offset:2048
  ds_read_b128 v[116:119], v201 offset:4096
  v_mfma_f32_16x16x32_bf16 v[68:71], v[208:211], v[104:107], 0
  s_waitcnt lgkmcnt(7)
  v_mfma_f32_16x16x32_bf16 v[8:11], v[212:215], v[96:99], 0
  ds_read_b64_tr_b16 v[204:205], v247 offset:49152
  ds_read_b64_tr_b16 v[206:207], v247 offset:50176
  v_mfma_f32_16x16x32_bf16 v[40:43], v[212:215], v[100:103], 0
  v_mfma_f32_16x16x32_bf16 v[72:75], v[212:215], v[104:107], 0
  v_mfma_f32_16x16x32_bf16 v[12:15], v[216:219], v[96:99], 0
  ds_read_b64_tr_b16 v[208:209], v247 offset:49160
  ds_read_b64_tr_b16 v[210:211], v247 offset:50184
  v_mfma_f32_16x16x32_bf16 v[44:47], v[216:219], v[100:103], 0
  v_mfma_f32_16x16x32_bf16 v[76:79], v[216:219], v[104:107], 0
  s_waitcnt lgkmcnt(7)
  v_mfma_f32_16x16x32_bf16 v[16:19], v[220:223], v[96:99], 0
  ds_read_b64_tr_b16 v[212:213], v244 offset:57344
  ds_read_b64_tr_b16 v[214:215], v244 offset:58368
  v_mfma_f32_16x16x32_bf16 v[48:51], v[220:223], v[100:103], 0
  v_mfma_f32_16x16x32_bf16 v[80:83], v[220:223], v[104:107], 0
  v_mfma_f32_16x16x32_bf16 v[20:23], v[224:227], v[96:99], 0
  ds_read_b64_tr_b16 v[216:217], v244 offset:57352
  ds_read_b64_tr_b16 v[218:219], v244 offset:58376
  v_mfma_f32_16x16x32_bf16 v[52:55], v[224:227], v[100:103], 0
  v_mfma_f32_16x16x32_bf16 v[84:87], v[224:227], v[104:107], 0
  s_waitcnt lgkmcnt(4)
  v_mfma_f32_16x16x32_bf16 v[24:27], v[204:207], v[96:99], 0
  ds_read_b64_tr_b16 v[220:221], v245 offset:57344
  ds_read_b64_tr_b16 v[222:223], v245 offset:58368
  v_mfma_f32_16x16x32_bf16 v[56:59], v[204:207], v[100:103], 0
  v_mfma_f32_16x16x32_bf16 v[88:91], v[204:207], v[104:107], 0
  v_mfma_f32_16x16x32_bf16 v[28:31], v[208:211], v[96:99], 0
  ds_read_b64_tr_b16 v[204:205], v245 offset:57352
  ds_read_b64_tr_b16 v[206:207], v245 offset:58376
  v_mfma_f32_16x16x32_bf16 v[60:63], v[208:211], v[100:103], 0
  v_mfma_f32_16x16x32_bf16 v[92:95], v[208:211], v[104:107], 0
  s_waitcnt lgkmcnt(4)
  v_mfma_f32_16x16x32_bf16 v[0:3], v[212:215], v[108:111], v[0:3]
  ds_read_b64_tr_b16 v[208:209], v246 offset:57344
  ds_read_b64_tr_b16 v[210:211], v246 offset:58368
  v_mfma_f32_16x16x32_bf16 v[32:35], v[212:215], v[112:115], v[32:35]
  v_mfma_f32_16x16x32_bf16 v[64:67], v[212:215], v[116:119], v[64:67]
  v_mfma_f32_16x16x32_bf16 v[4:7], v[216:219], v[108:111], v[4:7]
  ds_read_b64_tr_b16 v[212:213], v246 offset:57352
  ds_read_b64_tr_b16 v[214:215], v246 offset:58376
  v_mfma_f32_16x16x32_bf16 v[36:39], v[216:219], v[112:115], v[36:39]
  v_mfma_f32_16x16x32_bf16 v[68:71], v[216:219], v[116:119], v[68:71]
  s_waitcnt lgkmcnt(4)
  v_mfma_f32_16x16x32_bf16 v[8:11], v[220:223], v[108:111], v[8:11]
  ds_read_b64_tr_b16 v[216:217], v247 offset:57344
  ds_read_b64_tr_b16 v[218:219], v247 offset:58368
  v_mfma_f32_16x16x32_bf16 v[40:43], v[220:223], v[112:115], v[40:43]
  v_mfma_f32_16x16x32_bf16 v[72:75], v[220:223], v[116:119], v[72:75]
  v_mfma_f32_16x16x32_bf16 v[12:15], v[204:207], v[108:111], v[12:15]
  ds_read_b64_tr_b16 v[220:221], v247 offset:57352
  ds_read_b64_tr_b16 v[222:223], v247 offset:58376
  v_mfma_f32_16x16x32_bf16 v[44:47], v[204:207], v[112:115], v[44:47]
  v_mfma_f32_16x16x32_bf16 v[76:79], v[204:207], v[116:119], v[76:79]
  s_waitcnt lgkmcnt(4)
  v_mfma_f32_16x16x32_bf16 v[16:19], v[208:211], v[108:111], v[16:19]
  v_mfma_f32_16x16x32_bf16 v[48:51], v[208:211], v[112:115], v[48:51]
  v_mfma_f32_16x16x32_bf16 v[80:83], v[208:211], v[116:119], v[80:83]
  s_waitcnt lgkmcnt(0)
  s_barrier
  v_mfma_f32_16x16x32_bf16 v[20:23], v[212:215], v[108:111], v[20:23]
  ds_read_b64_tr_b16 v[204:205], v244 offset:0
  ds_read_b64_tr_b16 v[206:207], v244 offset:1024
  v_mfma_f32_16x16x32_bf16 v[52:55], v[212:215], v[112:115], v[52:55]
  ds_read_b64_tr_b16 v[208:209], v244 offset:8
  ds_read_b64_tr_b16 v[210:211], v244 offset:1032
  v_mfma_f32_16x16x32_bf16 v[84:87], v[212:215], v[116:119], v[84:87]
  ds_read_b128 v[120:123], v200 offset:18432
  ds_read_b128 v[124:127], v200 offset:20480
  ds_read_b128 v[128:131], v200 offset:22528
  v_mfma_f32_16x16x32_bf16 v[24:27], v[216:219], v[108:111], v[24:27]
  ds_read_b64_tr_b16 v[212:213], v245 offset:0
  ds_read_b64_tr_b16 v[214:215], v245 offset:1024
  v_mfma_f32_16x16x32_bf16 v[56:59], v[216:219], v[112:115], v[56:59]
  ds_read_b128 v[132:135], v201 offset:18432
  ds_read_b128 v[136:139], v201 offset:20480
  ds_read_b128 v[140:143], v201 offset:22528
  v_mfma_f32_16x16x32_bf16 v[88:91], v[216:219], v[116:119], v[88:91]
  v_mfma_f32_16x16x32_bf16 v[28:31], v[220:223], v[108:111], v[28:31]
  ds_read_b64_tr_b16 v[216:217], v245 offset:8
  ds_read_b64_tr_b16 v[218:219], v245 offset:1032
  v_mfma_f32_16x16x32_bf16 v[60:63], v[220:223], v[112:115], v[60:63]
  v_mfma_f32_16x16x32_bf16 v[92:95], v[220:223], v[116:119], v[92:95]
  s_waitcnt lgkmcnt(7)
  v_mfma_f32_16x16x32_bf16 v[0:3], v[204:207], v[120:123], v[0:3]
  ds_read_b64_tr_b16 v[220:221], v246 offset:0
  ds_read_b64_tr_b16 v[222:223], v246 offset:1024
  v_mfma_f32_16x16x32_bf16 v[32:35], v[204:207], v[124:127], v[32:35]
  v_mfma_f32_16x16x32_bf16 v[64:67], v[204:207], v[128:131], v[64:67]
  v_mfma_f32_16x16x32_bf16 v[4:7], v[208:211], v[120:123], v[4:7]
  ds_read_b64_tr_b16 v[224:225], v246 offset:8
  ds_read_b64_tr_b16 v[226:227], v246 offset:1032
  v_mfma_f32_16x16x32_bf16 v[36:39], v[208:211], v[124:127], v[36:39]
  v_mfma_f32_16x16x32_bf16 v[68:71], v[208:211], v[128:131], v[68:71]
  s_waitcnt lgkmcnt(4)
  v_mfma_f32_16x16x32_bf16 v[8:11], v[212:215], v[120:123], v[8:11]
  ds_read_b64_tr_b16 v[204:205], v247 offset:0
  ds_read_b64_tr_b16 v[206:207], v247 offset:1024
  v_mfma_f32_16x16x32_bf16 v[40:43], v[212:215], v[124:127], v[40:43]
  v_mfma_f32_16x16x32_bf16 v[72:75], v[212:215], v[128:131], v[72:75]
  v_mfma_f32_16x16x32_bf16 v[12:15], v[216:219], v[120:123], v[12:15]
  ds_read_b64_tr_b16 v[208:209], v247 offset:8
  ds_read_b64_tr_b16 v[210:211], v247 offset:1032
  v_mfma_f32_16x16x32_bf16 v[44:47], v[216:219], v[124:127], v[44:47]
  v_mfma_f32_16x16x32_bf16 v[76:79], v[216:219], v[128:131], v[76:79]
  s_waitcnt lgkmcnt(4)
  v_mfma_f32_16x16x32_bf16 v[16:19], v[220:223], v[120:123], v[16:19]
  ds_read_b64_tr_b16 v[212:213], v244 offset:8192
  ds_read_b64_tr_b16 v[214:215], v244 offset:9216
  v_mfma_f32_16x16x32_bf16 v[48:51], v[220:223], v[124:127], v[48:51]
  v_mfma_f32_16x16x32_bf16 v[80:83], v[220:223], v[128:131], v[80:83]
  v_mfma_f32_16x16x32_bf16 v[20:23], v[224:227], v[120:123], v[20:23]
  ds_read_b64_tr_b16 v[216:217], v244 offset:8200
  ds_read_b64_tr_b16 v[218:219], v244 offset:9224
  v_mfma_f32_16x16x32_bf16 v[52:55], v[224:227], v[124:127], v[52:55]
  v_mfma_f32_16x16x32_bf16 v[84:87], v[224:227], v[128:131], v[84:87]
  s_waitcnt lgkmcnt(4)
  v_mfma_f32_16x16x32_bf16 v[24:27], v[204:207], v[120:123], v[24:27]
  ds_read_b64_tr_b16 v[220:221], v245 offset:8192
  ds_read_b64_tr_b16 v[222:223], v245 offset:9216
  v_mfma_f32_16x16x32_bf16 v[56:59], v[204:207], v[124:127], v[56:59]
  v_mfma_f32_16x16x32_bf16 v[88:91], v[204:207], v[128:131], v[88:91]
  v_mfma_f32_16x16x32_bf16 v[28:31], v[208:211], v[120:123], v[28:31]
  ds_read_b64_tr_b16 v[204:205], v245 offset:8200
  ds_read_b64_tr_b16 v[206:207], v245 offset:9224
  v_mfma_f32_16x16x32_bf16 v[60:63], v[208:211], v[124:127], v[60:63]
  v_mfma_f32_16x16x32_bf16 v[92:95], v[208:211], v[128:131], v[92:95]
  s_waitcnt lgkmcnt(4)
  v_mfma_f32_16x16x32_bf16 v[0:3], v[212:215], v[132:135], v[0:3]
  ds_read_b64_tr_b16 v[208:209], v246 offset:8192
  ds_read_b64_tr_b16 v[210:211], v246 offset:9216
  v_mfma_f32_16x16x32_bf16 v[32:35], v[212:215], v[136:139], v[32:35]
  v_mfma_f32_16x16x32_bf16 v[64:67], v[212:215], v[140:143], v[64:67]
  v_mfma_f32_16x16x32_bf16 v[4:7], v[216:219], v[132:135], v[4:7]
  ds_read_b64_tr_b16 v[212:213], v246 offset:8200
  ds_read_b64_tr_b16 v[214:215], v246 offset:9224
  v_mfma_f32_16x16x32_bf16 v[36:39], v[216:219], v[136:139], v[36:39]
  v_mfma_f32_16x16x32_bf16 v[68:71], v[216:219], v[140:143], v[68:71]
  s_waitcnt lgkmcnt(4)
  v_mfma_f32_16x16x32_bf16 v[8:11], v[220:223], v[132:135], v[8:11]
  ds_read_b64_tr_b16 v[216:217], v247 offset:8192
  ds_read_b64_tr_b16 v[218:219], v247 offset:9216
  v_mfma_f32_16x16x32_bf16 v[40:43], v[220:223], v[136:139], v[40:43]
  v_mfma_f32_16x16x32_bf16 v[72:75], v[220:223], v[140:143], v[72:75]
  v_mfma_f32_16x16x32_bf16 v[12:15], v[204:207], v[132:135], v[12:15]
  ds_read_b64_tr_b16 v[220:221], v247 offset:8200
  ds_read_b64_tr_b16 v[222:223], v247 offset:9224
  v_mfma_f32_16x16x32_bf16 v[44:47], v[204:207], v[136:139], v[44:47]
  v_mfma_f32_16x16x32_bf16 v[76:79], v[204:207], v[140:143], v[76:79]
  s_waitcnt lgkmcnt(4)
  v_mfma_f32_16x16x32_bf16 v[16:19], v[208:211], v[132:135], v[16:19]
  v_mfma_f32_16x16x32_bf16 v[48:51], v[208:211], v[136:139], v[48:51]
  v_mfma_f32_16x16x32_bf16 v[80:83], v[208:211], v[140:143], v[80:83]
  s_waitcnt lgkmcnt(0)
  s_barrier
  v_mfma_f32_16x16x32_bf16 v[20:23], v[212:215], v[132:135], v[20:23]
  ds_read_b64_tr_b16 v[204:205], v244 offset:16384
  ds_read_b64_tr_b16 v[206:207], v244 offset:17408
  v_mfma_f32_16x16x32_bf16 v[52:55], v[212:215], v[136:139], v[52:55]
  ds_read_b64_tr_b16 v[208:209], v244 offset:16392
  ds_read_b64_tr_b16 v[210:211], v244 offset:17416
  v_mfma_f32_16x16x32_bf16 v[84:87], v[212:215], v[140:143], v[84:87]
  ds_read_b128 v[144:147], v200 offset:36864
  ds_read_b128 v[148:151], v200 offset:38912
  ds_read_b128 v[152:155], v200 offset:40960
  v_mfma_f32_16x16x32_bf16 v[24:27], v[216:219], v[132:135], v[24:27]
  ds_read_b64_tr_b16 v[212:213], v245 offset:16384
  ds_read_b64_tr_b16 v[214:215], v245 offset:17408
  v_mfma_f32_16x16x32_bf16 v[56:59], v[216:219], v[136:139], v[56:59]
  ds_read_b128 v[156:159], v201 offset:36864
  ds_read_b128 v[160:163], v201 offset:38912
  ds_read_b128 v[164:167], v201 offset:40960
  v_mfma_f32_16x16x32_bf16 v[88:91], v[216:219], v[140:143], v[88:91]
  v_mfma_f32_16x16x32_bf16 v[28:31], v[220:223], v[132:135], v[28:31]
  ds_read_b64_tr_b16 v[216:217], v245 offset:16392
  ds_read_b64_tr_b16 v[218:219], v245 offset:17416
  v_mfma_f32_16x16x32_bf16 v[60:63], v[220:223], v[136:139], v[60:63]
  v_mfma_f32_16x16x32_bf16 v[92:95], v[220:223], v[140:143], v[92:95]
  s_waitcnt lgkmcnt(7)
  v_mfma_f32_16x16x32_bf16 v[0:3], v[204:207], v[144:147], v[0:3]
  ds_read_b64_tr_b16 v[220:221], v246 offset:16384
  ds_read_b64_tr_b16 v[222:223], v246 offset:17408
  v_mfma_f32_16x16x32_bf16 v[32:35], v[204:207], v[148:151], v[32:35]
  v_mfma_f32_16x16x32_bf16 v[64:67], v[204:207], v[152:155], v[64:67]
  v_mfma_f32_16x16x32_bf16 v[4:7], v[208:211], v[144:147], v[4:7]
  ds_read_b64_tr_b16 v[224:225], v246 offset:16392
  ds_read_b64_tr_b16 v[226:227], v246 offset:17416
  v_mfma_f32_16x16x32_bf16 v[36:39], v[208:211], v[148:151], v[36:39]
  v_mfma_f32_16x16x32_bf16 v[68:71], v[208:211], v[152:155], v[68:71]
  s_waitcnt lgkmcnt(4)
  v_mfma_f32_16x16x32_bf16 v[8:11], v[212:215], v[144:147], v[8:11]
  ds_read_b64_tr_b16 v[204:205], v247 offset:16384
  ds_read_b64_tr_b16 v[206:207], v247 offset:17408
  v_mfma_f32_16x16x32_bf16 v[40:43], v[212:215], v[148:151], v[40:43]
  v_mfma_f32_16x16x32_bf16 v[72:75], v[212:215], v[152:155], v[72:75]
  v_mfma_f32_16x16x32_bf16 v[12:15], v[216:219], v[144:147], v[12:15]
  ds_read_b64_tr_b16 v[208:209], v247 offset:16392
  ds_read_b64_tr_b16 v[210:211], v247 offset:17416
  v_mfma_f32_16x16x32_bf16 v[44:47], v[216:219], v[148:151], v[44:47]
  v_mfma_f32_16x16x32_bf16 v[76:79], v[216:219], v[152:155], v[76:79]
  s_waitcnt lgkmcnt(4)
  v_mfma_f32_16x16x32_bf16 v[16:19], v[220:223], v[144:147], v[16:19]
  ds_read_b64_tr_b16 v[212:213], v244 offset:24576
  ds_read_b64_tr_b16 v[214:215], v244 offset:25600
  v_mfma_f32_16x16x32_bf16 v[48:51], v[220:223], v[148:151], v[48:51]
  v_mfma_f32_16x16x32_bf16 v[80:83], v[220:223], v[152:155], v[80:83]
  v_mfma_f32_16x16x32_bf16 v[20:23], v[224:227], v[144:147], v[20:23]
  ds_read_b64_tr_b16 v[216:217], v244 offset:24584
  ds_read_b64_tr_b16 v[218:219], v244 offset:25608
  v_mfma_f32_16x16x32_bf16 v[52:55], v[224:227], v[148:151], v[52:55]
  v_mfma_f32_16x16x32_bf16 v[84:87], v[224:227], v[152:155], v[84:87]
  s_waitcnt lgkmcnt(4)
  v_mfma_f32_16x16x32_bf16 v[24:27], v[204:207], v[144:147], v[24:27]
  ds_read_b64_tr_b16 v[220:221], v245 offset:24576
  ds_read_b64_tr_b16 v[222:223], v245 offset:25600
  v_mfma_f32_16x16x32_bf16 v[56:59], v[204:207], v[148:151], v[56:59]
  v_mfma_f32_16x16x32_bf16 v[88:91], v[204:207], v[152:155], v[88:91]
  v_mfma_f32_16x16x32_bf16 v[28:31], v[208:211], v[144:147], v[28:31]
  ds_read_b64_tr_b16 v[204:205], v245 offset:24584
  ds_read_b64_tr_b16 v[206:207], v245 offset:25608
  v_mfma_f32_16x16x32_bf16 v[60:63], v[208:211], v[148:151], v[60:63]
  v_mfma_f32_16x16x32_bf16 v[92:95], v[208:211], v[152:155], v[92:95]
  s_waitcnt lgkmcnt(4)
  v_mfma_f32_16x16x32_bf16 v[0:3], v[212:215], v[156:159], v[0:3]
  ds_read_b64_tr_b16 v[208:209], v246 offset:24576
  ds_read_b64_tr_b16 v[210:211], v246 offset:25600
  v_mfma_f32_16x16x32_bf16 v[32:35], v[212:215], v[160:163], v[32:35]
  v_mfma_f32_16x16x32_bf16 v[64:67], v[212:215], v[164:167], v[64:67]
  v_mfma_f32_16x16x32_bf16 v[4:7], v[216:219], v[156:159], v[4:7]
  ds_read_b64_tr_b16 v[212:213], v246 offset:24584
  ds_read_b64_tr_b16 v[214:215], v246 offset:25608
  v_mfma_f32_16x16x32_bf16 v[36:39], v[216:219], v[160:163], v[36:39]
  v_mfma_f32_16x16x32_bf16 v[68:71], v[216:219], v[164:167], v[68:71]
  s_waitcnt lgkmcnt(4)
  v_mfma_f32_16x16x32_bf16 v[8:11], v[220:223], v[156:159], v[8:11]
  ds_read_b64_tr_b16 v[216:217], v247 offset:24576
  ds_read_b64_tr_b16 v[218:219], v247 offset:25600
  v_mfma_f32_16x16x32_bf16 v[40:43], v[220:223], v[160:163], v[40:43]
  v_mfma_f32_16x16x32_bf16 v[72:75], v[220:223], v[164:167], v[72:75]
  v_mfma_f32_16x16x32_bf16 v[12:15], v[204:207], v[156:159], v[12:15]
  ds_read_b64_tr_b16 v[220:221], v247 offset:24584
  ds_read_b64_tr_b16 v[222:223], v247 offset:25608
  v_mfma_f32_16x16x32_bf16 v[44:47], v[204:207], v[160:163], v[44:47]
  v_mfma_f32_16x16x32_bf16 v[76:79], v[204:207], v[164:167], v[76:79]
  s_waitcnt lgkmcnt(4)
  v_mfma_f32_16x16x32_bf16 v[16:19], v[208:211], v[156:159], v[16:19]
  v_mfma_f32_16x16x32_bf16 v[48:51], v[208:211], v[160:163], v[48:51]
  v_mfma_f32_16x16x32_bf16 v[80:83], v[208:211], v[164:167], v[80:83]
  s_waitcnt lgkmcnt(0)
  s_barrier
  v_mfma_f32_16x16x32_bf16 v[20:23], v[212:215], v[156:159], v[20:23]
  ds_read_b64_tr_b16 v[204:205], v244 offset:32768
  ds_read_b64_tr_b16 v[206:207], v244 offset:33792
  v_mfma_f32_16x16x32_bf16 v[52:55], v[212:215], v[160:163], v[52:55]
  ds_read_b64_tr_b16 v[208:209], v244 offset:32776
  ds_read_b64_tr_b16 v[210:211], v244 offset:33800
  v_mfma_f32_16x16x32_bf16 v[84:87], v[212:215], v[164:167], v[84:87]
  ds_read_b128 v[168:171], v200 offset:0
  ds_read_b128 v[172:175], v200 offset:2048
  ds_read_b128 v[176:179], v200 offset:4096
  v_mfma_f32_16x16x32_bf16 v[24:27], v[216:219], v[156:159], v[24:27]
  ds_read_b64_tr_b16 v[212:213], v245 offset:32768
  ds_read_b64_tr_b16 v[214:215], v245 offset:33792
  v_mfma_f32_16x16x32_bf16 v[56:59], v[216:219], v[160:163], v[56:59]
  ds_read_b128 v[180:183], v201 offset:0
  ds_read_b128 v[184:187], v201 offset:2048
  ds_read_b128 v[188:191], v201 offset:4096
  v_mfma_f32_16x16x32_bf16 v[88:91], v[216:219], v[164:167], v[88:91]
  v_mfma_f32_16x16x32_bf16 v[28:31], v[220:223], v[156:159], v[28:31]
  ds_read_b64_tr_b16 v[216:217], v245 offset:32776
  ds_read_b64_tr_b16 v[218:219], v245 offset:33800
  v_mfma_f32_16x16x32_bf16 v[60:63], v[220:223], v[160:163], v[60:63]
  v_mfma_f32_16x16x32_bf16 v[92:95], v[220:223], v[164:167], v[92:95]
  s_waitcnt lgkmcnt(7)
  v_mfma_f32_16x16x32_bf16 v[0:3], v[204:207], v[168:171], v[0:3]
  ds_read_b64_tr_b16 v[220:221], v246 offset:32768
  ds_read_b64_tr_b16 v[222:223], v246 offset:33792
  v_mfma_f32_16x16x32_bf16 v[32:35], v[204:207], v[172:175], v[32:35]
  v_mfma_f32_16x16x32_bf16 v[64:67], v[204:207], v[176:179], v[64:67]
  v_mfma_f32_16x16x32_bf16 v[4:7], v[208:211], v[168:171], v[4:7]
  ds_read_b64_tr_b16 v[224:225], v246 offset:32776
  ds_read_b64_tr_b16 v[226:227], v246 offset:33800
  v_mfma_f32_16x16x32_bf16 v[36:39], v[208:211], v[172:175], v[36:39]
  v_mfma_f32_16x16x32_bf16 v[68:71], v[208:211], v[176:179], v[68:71]
  s_waitcnt lgkmcnt(4)
  v_mfma_f32_16x16x32_bf16 v[8:11], v[212:215], v[168:171], v[8:11]
  ds_read_b64_tr_b16 v[204:205], v247 offset:32768
  ds_read_b64_tr_b16 v[206:207], v247 offset:33792
  v_mfma_f32_16x16x32_bf16 v[40:43], v[212:215], v[172:175], v[40:43]
  v_mfma_f32_16x16x32_bf16 v[72:75], v[212:215], v[176:179], v[72:75]
  v_mfma_f32_16x16x32_bf16 v[12:15], v[216:219], v[168:171], v[12:15]
  ds_read_b64_tr_b16 v[208:209], v247 offset:32776
  ds_read_b64_tr_b16 v[210:211], v247 offset:33800
  v_mfma_f32_16x16x32_bf16 v[44:47], v[216:219], v[172:175], v[44:47]
  v_mfma_f32_16x16x32_bf16 v[76:79], v[216:219], v[176:179], v[76:79]
  s_waitcnt lgkmcnt(4)
  v_mfma_f32_16x16x32_bf16 v[16:19], v[220:223], v[168:171], v[16:19]
  ds_read_b64_tr_b16 v[212:213], v244 offset:40960
  ds_read_b64_tr_b16 v[214:215], v244 offset:41984
  v_mfma_f32_16x16x32_bf16 v[48:51], v[220:223], v[172:175], v[48:51]
  v_mfma_f32_16x16x32_bf16 v[80:83], v[220:223], v[176:179], v[80:83]
  v_mfma_f32_16x16x32_bf16 v[20:23], v[224:227], v[168:171], v[20:23]
  ds_read_b64_tr_b16 v[216:217], v244 offset:40968
  ds_read_b64_tr_b16 v[218:219], v244 offset:41992
  v_mfma_f32_16x16x32_bf16 v[52:55], v[224:227], v[172:175], v[52:55]
  v_mfma_f32_16x16x32_bf16 v[84:87], v[224:227], v[176:179], v[84:87]
  s_waitcnt lgkmcnt(4)
  v_mfma_f32_16x16x32_bf16 v[24:27], v[204:207], v[168:171], v[24:27]
  ds_read_b64_tr_b16 v[220:221], v245 offset:40960
  ds_read_b64_tr_b16 v[222:223], v245 offset:41984
  v_mfma_f32_16x16x32_bf16 v[56:59], v[204:207], v[172:175], v[56:59]
  v_mfma_f32_16x16x32_bf16 v[88:91], v[204:207], v[176:179], v[88:91]
  v_mfma_f32_16x16x32_bf16 v[28:31], v[208:211], v[168:171], v[28:31]
  ds_read_b64_tr_b16 v[204:205], v245 offset:40968
  ds_read_b64_tr_b16 v[206:207], v245 offset:41992
  v_mfma_f32_16x16x32_bf16 v[60:63], v[208:211], v[172:175], v[60:63]
  v_mfma_f32_16x16x32_bf16 v[92:95], v[208:211], v[176:179], v[92:95]
  s_waitcnt lgkmcnt(4)
  v_mfma_f32_16x16x32_bf16 v[0:3], v[212:215], v[180:183], v[0:3]
  ds_read_b64_tr_b16 v[208:209], v246 offset:40960
  ds_read_b64_tr_b16 v[210:211], v246 offset:41984
  v_mfma_f32_16x16x32_bf16 v[32:35], v[212:215], v[184:187], v[32:35]
  v_mfma_f32_16x16x32_bf16 v[64:67], v[212:215], v[188:191], v[64:67]
  v_mfma_f32_16x16x32_bf16 v[4:7], v[216:219], v[180:183], v[4:7]
  ds_read_b64_tr_b16 v[212:213], v246 offset:40968
  ds_read_b64_tr_b16 v[214:215], v246 offset:41992
  v_mfma_f32_16x16x32_bf16 v[36:39], v[216:219], v[184:187], v[36:39]
  v_mfma_f32_16x16x32_bf16 v[68:71], v[216:219], v[188:191], v[68:71]
  s_waitcnt lgkmcnt(4)
  v_mfma_f32_16x16x32_bf16 v[8:11], v[220:223], v[180:183], v[8:11]
  ds_read_b64_tr_b16 v[216:217], v247 offset:40960
  ds_read_b64_tr_b16 v[218:219], v247 offset:41984
  v_mfma_f32_16x16x32_bf16 v[40:43], v[220:223], v[184:187], v[40:43]
  v_mfma_f32_16x16x32_bf16 v[72:75], v[220:223], v[188:191], v[72:75]
  v_mfma_f32_16x16x32_bf16 v[12:15], v[204:207], v[180:183], v[12:15]
  ds_read_b64_tr_b16 v[220:221], v247 offset:40968
  ds_read_b64_tr_b16 v[222:223], v247 offset:41992
  v_mfma_f32_16x16x32_bf16 v[44:47], v[204:207], v[184:187], v[44:47]
  v_mfma_f32_16x16x32_bf16 v[76:79], v[204:207], v[188:191], v[76:79]
  s_waitcnt lgkmcnt(4)
  v_mfma_f32_16x16x32_bf16 v[16:19], v[208:211], v[180:183], v[16:19]
  v_mfma_f32_16x16x32_bf16 v[48:51], v[208:211], v[184:187], v[48:51]
  v_mfma_f32_16x16x32_bf16 v[80:83], v[208:211], v[188:191], v[80:83]
  s_waitcnt lgkmcnt(0)
  s_barrier
  v_mfma_f32_16x16x32_bf16 v[20:23], v[212:215], v[180:183], v[20:23]
  ds_read_b64_tr_b16 v[204:205], v244 offset:49152
  ds_read_b64_tr_b16 v[206:207], v244 offset:50176
  v_mfma_f32_16x16x32_bf16 v[52:55], v[212:215], v[184:187], v[52:55]
  ds_read_b64_tr_b16 v[208:209], v244 offset:49160
  ds_read_b64_tr_b16 v[210:211], v244 offset:50184
  v_mfma_f32_16x16x32_bf16 v[84:87], v[212:215], v[188:191], v[84:87]
  ds_read_b128 v[96:99], v200 offset:18432
  ds_read_b128 v[100:103], v200 offset:20480
  ds_read_b128 v[104:107], v200 offset:22528
  v_mfma_f32_16x16x32_bf16 v[24:27], v[216:219], v[180:183], v[24:27]
  ds_read_b64_tr_b16 v[212:213], v245 offset:49152
  ds_read_b64_tr_b16 v[214:215], v245 offset:50176
  v_mfma_f32_16x16x32_bf16 v[56:59], v[216:219], v[184:187], v[56:59]
  ds_read_b128 v[108:111], v201 offset:18432
  ds_read_b128 v[112:115], v201 offset:20480
  ds_read_b128 v[116:119], v201 offset:22528
  v_mfma_f32_16x16x32_bf16 v[88:91], v[216:219], v[188:191], v[88:91]
  v_mfma_f32_16x16x32_bf16 v[28:31], v[220:223], v[180:183], v[28:31]
  ds_read_b64_tr_b16 v[216:217], v245 offset:49160
  ds_read_b64_tr_b16 v[218:219], v245 offset:50184
  v_mfma_f32_16x16x32_bf16 v[60:63], v[220:223], v[184:187], v[60:63]
  v_mfma_f32_16x16x32_bf16 v[92:95], v[220:223], v[188:191], v[92:95]
  s_waitcnt lgkmcnt(7)
  v_mfma_f32_16x16x32_bf16 v[0:3], v[204:207], v[96:99], v[0:3]
  ds_read_b64_tr_b16 v[220:221], v246 offset:49152
  ds_read_b64_tr_b16 v[222:223], v246 offset:50176
  v_mfma_f32_16x16x32_bf16 v[32:35], v[204:207], v[100:103], v[32:35]
  v_mfma_f32_16x16x32_bf16 v[64:67], v[204:207], v[104:107], v[64:67]
  v_mfma_f32_16x16x32_bf16 v[4:7], v[208:211], v[96:99], v[4:7]
  ds_read_b64_tr_b16 v[224:225], v246 offset:49160
  ds_read_b64_tr_b16 v[226:227], v246 offset:50184
  v_mfma_f32_16x16x32_bf16 v[36:39], v[208:211], v[100:103], v[36:39]
  v_mfma_f32_16x16x32_bf16 v[68:71], v[208:211], v[104:107], v[68:71]
  s_waitcnt lgkmcnt(4)
  v_mfma_f32_16x16x32_bf16 v[8:11], v[212:215], v[96:99], v[8:11]
  ds_read_b64_tr_b16 v[204:205], v247 offset:49152
  ds_read_b64_tr_b16 v[206:207], v247 offset:50176
  v_mfma_f32_16x16x32_bf16 v[40:43], v[212:215], v[100:103], v[40:43]
  v_mfma_f32_16x16x32_bf16 v[72:75], v[212:215], v[104:107], v[72:75]
  v_mfma_f32_16x16x32_bf16 v[12:15], v[216:219], v[96:99], v[12:15]
  ds_read_b64_tr_b16 v[208:209], v247 offset:49160
  ds_read_b64_tr_b16 v[210:211], v247 offset:50184
  v_mfma_f32_16x16x32_bf16 v[44:47], v[216:219], v[100:103], v[44:47]
  v_mfma_f32_16x16x32_bf16 v[76:79], v[216:219], v[104:107], v[76:79]
  s_waitcnt lgkmcnt(4)
  v_mfma_f32_16x16x32_bf16 v[16:19], v[220:223], v[96:99], v[16:19]
  ds_read_b64_tr_b16 v[212:213], v244 offset:57344
  ds_read_b64_tr_b16 v[214:215], v244 offset:58368
  v_mfma_f32_16x16x32_bf16 v[48:51], v[220:223], v[100:103], v[48:51]
  v_mfma_f32_16x16x32_bf16 v[80:83], v[220:223], v[104:107], v[80:83]
  v_mfma_f32_16x16x32_bf16 v[20:23], v[224:227], v[96:99], v[20:23]
  ds_read_b64_tr_b16 v[216:217], v244 offset:57352
  ds_read_b64_tr_b16 v[218:219], v244 offset:58376
  v_mfma_f32_16x16x32_bf16 v[52:55], v[224:227], v[100:103], v[52:55]
  v_mfma_f32_16x16x32_bf16 v[84:87], v[224:227], v[104:107], v[84:87]
  s_waitcnt lgkmcnt(4)
  v_mfma_f32_16x16x32_bf16 v[24:27], v[204:207], v[96:99], v[24:27]
  ds_read_b64_tr_b16 v[220:221], v245 offset:57344
  ds_read_b64_tr_b16 v[222:223], v245 offset:58368
  v_mfma_f32_16x16x32_bf16 v[56:59], v[204:207], v[100:103], v[56:59]
  v_mfma_f32_16x16x32_bf16 v[88:91], v[204:207], v[104:107], v[88:91]
  v_mfma_f32_16x16x32_bf16 v[28:31], v[208:211], v[96:99], v[28:31]
  ds_read_b64_tr_b16 v[204:205], v245 offset:57352
  ds_read_b64_tr_b16 v[206:207], v245 offset:58376
  v_mfma_f32_16x16x32_bf16 v[60:63], v[208:211], v[100:103], v[60:63]
  v_mfma_f32_16x16x32_bf16 v[92:95], v[208:211], v[104:107], v[92:95]
  s_waitcnt lgkmcnt(4)
  v_mfma_f32_16x16x32_bf16 v[0:3], v[212:215], v[108:111], v[0:3]
  ds_read_b64_tr_b16 v[208:209], v246 offset:57344
  ds_read_b64_tr_b16 v[210:211], v246 offset:58368
  v_mfma_f32_16x16x32_bf16 v[32:35], v[212:215], v[112:115], v[32:35]
  v_mfma_f32_16x16x32_bf16 v[64:67], v[212:215], v[116:119], v[64:67]
  v_mfma_f32_16x16x32_bf16 v[4:7], v[216:219], v[108:111], v[4:7]
  ds_read_b64_tr_b16 v[212:213], v246 offset:57352
  ds_read_b64_tr_b16 v[214:215], v246 offset:58376
  v_mfma_f32_16x16x32_bf16 v[36:39], v[216:219], v[112:115], v[36:39]
  v_mfma_f32_16x16x32_bf16 v[68:71], v[216:219], v[116:119], v[68:71]
  s_waitcnt lgkmcnt(4)
  v_mfma_f32_16x16x32_bf16 v[8:11], v[220:223], v[108:111], v[8:11]
  ds_read_b64_tr_b16 v[216:217], v247 offset:57344
  ds_read_b64_tr_b16 v[218:219], v247 offset:58368
  v_mfma_f32_16x16x32_bf16 v[40:43], v[220:223], v[112:115], v[40:43]
  v_mfma_f32_16x16x32_bf16 v[72:75], v[220:223], v[116:119], v[72:75]
  v_mfma_f32_16x16x32_bf16 v[12:15], v[204:207], v[108:111], v[12:15]
  ds_read_b64_tr_b16 v[220:221], v247 offset:57352
  ds_read_b64_tr_b16 v[222:223], v247 offset:58376
  v_mfma_f32_16x16x32_bf16 v[44:47], v[204:207], v[112:115], v[44:47]
  v_mfma_f32_16x16x32_bf16 v[76:79], v[204:207], v[116:119], v[76:79]
  s_waitcnt lgkmcnt(4)
  v_mfma_f32_16x16x32_bf16 v[16:19], v[208:211], v[108:111], v[16:19]
  v_mfma_f32_16x16x32_bf16 v[48:51], v[208:211], v[112:115], v[48:51]
  v_mfma_f32_16x16x32_bf16 v[80:83], v[208:211], v[116:119], v[80:83]
  s_waitcnt lgkmcnt(0)
  s_barrier
  v_mfma_f32_16x16x32_bf16 v[20:23], v[212:215], v[108:111], v[20:23]
  ds_read_b64_tr_b16 v[204:205], v244 offset:0
  ds_read_b64_tr_b16 v[206:207], v244 offset:1024
  v_mfma_f32_16x16x32_bf16 v[52:55], v[212:215], v[112:115], v[52:55]
  ds_read_b64_tr_b16 v[208:209], v244 offset:8
  ds_read_b64_tr_b16 v[210:211], v244 offset:1032
  v_mfma_f32_16x16x32_bf16 v[84:87], v[212:215], v[116:119], v[84:87]
  ds_read_b128 v[120:123], v200 offset:36864
  ds_read_b128 v[124:127], v200 offset:38912
  ds_read_b128 v[128:131], v200 offset:40960
  v_mfma_f32_16x16x32_bf16 v[24:27], v[216:219], v[108:111], v[24:27]
  ds_read_b64_tr_b16 v[212:213], v245 offset:0
  ds_read_b64_tr_b16 v[214:215], v245 offset:1024
  v_mfma_f32_16x16x32_bf16 v[56:59], v[216:219], v[112:115], v[56:59]
  ds_read_b128 v[132:135], v201 offset:36864
  ds_read_b128 v[136:139], v201 offset:38912
  ds_read_b128 v[140:143], v201 offset:40960
  v_mfma_f32_16x16x32_bf16 v[88:91], v[216:219], v[116:119], v[88:91]
  v_mfma_f32_16x16x32_bf16 v[28:31], v[220:223], v[108:111], v[28:31]
  ds_read_b64_tr_b16 v[216:217], v245 offset:8
  ds_read_b64_tr_b16 v[218:219], v245 offset:1032
  v_mfma_f32_16x16x32_bf16 v[60:63], v[220:223], v[112:115], v[60:63]
  v_mfma_f32_16x16x32_bf16 v[92:95], v[220:223], v[116:119], v[92:95]
  s_waitcnt lgkmcnt(7)
  v_mfma_f32_16x16x32_bf16 v[0:3], v[204:207], v[120:123], v[0:3]
  ds_read_b64_tr_b16 v[220:221], v246 offset:0
  ds_read_b64_tr_b16 v[222:223], v246 offset:1024
  v_mfma_f32_16x16x32_bf16 v[32:35], v[204:207], v[124:127], v[32:35]
  v_mfma_f32_16x16x32_bf16 v[64:67], v[204:207], v[128:131], v[64:67]
  v_mfma_f32_16x16x32_bf16 v[4:7], v[208:211], v[120:123], v[4:7]
  ds_read_b64_tr_b16 v[224:225], v246 offset:8
  ds_read_b64_tr_b16 v[226:227], v246 offset:1032
  v_mfma_f32_16x16x32_bf16 v[36:39], v[208:211], v[124:127], v[36:39]
  v_mfma_f32_16x16x32_bf16 v[68:71], v[208:211], v[128:131], v[68:71]
  s_waitcnt lgkmcnt(4)
  v_mfma_f32_16x16x32_bf16 v[8:11], v[212:215], v[120:123], v[8:11]
  ds_read_b64_tr_b16 v[204:205], v247 offset:0
  ds_read_b64_tr_b16 v[206:207], v247 offset:1024
  v_mfma_f32_16x16x32_bf16 v[40:43], v[212:215], v[124:127], v[40:43]
  v_mfma_f32_16x16x32_bf16 v[72:75], v[212:215], v[128:131], v[72:75]
  v_mfma_f32_16x16x32_bf16 v[12:15], v[216:219], v[120:123], v[12:15]
  ds_read_b64_tr_b16 v[208:209], v247 offset:8
  ds_read_b64_tr_b16 v[210:211], v247 offset:1032
  v_mfma_f32_16x16x32_bf16 v[44:47], v[216:219], v[124:127], v[44:47]
  v_mfma_f32_16x16x32_bf16 v[76:79], v[216:219], v[128:131], v[76:79]
  s_waitcnt lgkmcnt(4)
  v_mfma_f32_16x16x32_bf16 v[16:19], v[220:223], v[120:123], v[16:19]
  ds_read_b64_tr_b16 v[212:213], v244 offset:8192
  ds_read_b64_tr_b16 v[214:215], v244 offset:9216
  v_mfma_f32_16x16x32_bf16 v[48:51], v[220:223], v[124:127], v[48:51]
  v_mfma_f32_16x16x32_bf16 v[80:83], v[220:223], v[128:131], v[80:83]
  v_mfma_f32_16x16x32_bf16 v[20:23], v[224:227], v[120:123], v[20:23]
  ds_read_b64_tr_b16 v[216:217], v244 offset:8200
  ds_read_b64_tr_b16 v[218:219], v244 offset:9224
  v_mfma_f32_16x16x32_bf16 v[52:55], v[224:227], v[124:127], v[52:55]
  v_mfma_f32_16x16x32_bf16 v[84:87], v[224:227], v[128:131], v[84:87]
  s_waitcnt lgkmcnt(4)
  v_mfma_f32_16x16x32_bf16 v[24:27], v[204:207], v[120:123], v[24:27]
  ds_read_b64_tr_b16 v[220:221], v245 offset:8192
  ds_read_b64_tr_b16 v[222:223], v245 offset:9216
  v_mfma_f32_16x16x32_bf16 v[56:59], v[204:207], v[124:127], v[56:59]
  v_mfma_f32_16x16x32_bf16 v[88:91], v[204:207], v[128:131], v[88:91]
  v_mfma_f32_16x16x32_bf16 v[28:31], v[208:211], v[120:123], v[28:31]
  ds_read_b64_tr_b16 v[204:205], v245 offset:8200
  ds_read_b64_tr_b16 v[206:207], v245 offset:9224
  v_mfma_f32_16x16x32_bf16 v[60:63], v[208:211], v[124:127], v[60:63]
  v_mfma_f32_16x16x32_bf16 v[92:95], v[208:211], v[128:131], v[92:95]
  s_waitcnt lgkmcnt(4)
  v_mfma_f32_16x16x32_bf16 v[0:3], v[212:215], v[132:135], v[0:3]
  ds_read_b64_tr_b16 v[208:209], v246 offset:8192
  ds_read_b64_tr_b16 v[210:211], v246 offset:9216
  v_mfma_f32_16x16x32_bf16 v[32:35], v[212:215], v[136:139], v[32:35]
  v_mfma_f32_16x16x32_bf16 v[64:67], v[212:215], v[140:143], v[64:67]
  v_mfma_f32_16x16x32_bf16 v[4:7], v[216:219], v[132:135], v[4:7]
  ds_read_b64_tr_b16 v[212:213], v246 offset:8200
  ds_read_b64_tr_b16 v[214:215], v246 offset:9224
  v_mfma_f32_16x16x32_bf16 v[36:39], v[216:219], v[136:139], v[36:39]
  v_mfma_f32_16x16x32_bf16 v[68:71], v[216:219], v[140:143], v[68:71]
  s_waitcnt lgkmcnt(4)
  v_mfma_f32_16x16x32_bf16 v[8:11], v[220:223], v[132:135], v[8:11]
  ds_read_b64_tr_b16 v[216:217], v247 offset:8192
  ds_read_b64_tr_b16 v[218:219], v247 offset:9216
  v_mfma_f32_16x16x32_bf16 v[40:43], v[220:223], v[136:139], v[40:43]
  v_mfma_f32_16x16x32_bf16 v[72:75], v[220:223], v[140:143], v[72:75]
  v_mfma_f32_16x16x32_bf16 v[12:15], v[204:207], v[132:135], v[12:15]
  ds_read_b64_tr_b16 v[220:221], v247 offset:8200
  ds_read_b64_tr_b16 v[222:223], v247 offset:9224
  v_mfma_f32_16x16x32_bf16 v[44:47], v[204:207], v[136:139], v[44:47]
  v_mfma_f32_16x16x32_bf16 v[76:79], v[204:207], v[140:143], v[76:79]
  s_waitcnt lgkmcnt(4)
  v_mfma_f32_16x16x32_bf16 v[16:19], v[208:211], v[132:135], v[16:19]
  v_mfma_f32_16x16x32_bf16 v[48:51], v[208:211], v[136:139], v[48:51]
  v_mfma_f32_16x16x32_bf16 v[80:83], v[208:211], v[140:143], v[80:83]
  s_waitcnt lgkmcnt(0)
  s_barrier
  v_mfma_f32_16x16x32_bf16 v[20:23], v[212:215], v[132:135], v[20:23]
  ds_read_b64_tr_b16 v[204:205], v244 offset:16384
  ds_read_b64_tr_b16 v[206:207], v244 offset:17408
  v_mfma_f32_16x16x32_bf16 v[52:55], v[212:215], v[136:139], v[52:55]
  ds_read_b64_tr_b16 v[208:209], v244 offset:16392
  ds_read_b64_tr_b16 v[210:211], v244 offset:17416
  v_mfma_f32_16x16x32_bf16 v[84:87], v[212:215], v[140:143], v[84:87]
  ds_read_b128 v[144:147], v200 offset:0
  ds_read_b128 v[148:151], v200 offset:2048
  ds_read_b128 v[152:155], v200 offset:4096
  v_mfma_f32_16x16x32_bf16 v[24:27], v[216:219], v[132:135], v[24:27]
  ds_read_b64_tr_b16 v[212:213], v245 offset:16384
  ds_read_b64_tr_b16 v[214:215], v245 offset:17408
  v_mfma_f32_16x16x32_bf16 v[56:59], v[216:219], v[136:139], v[56:59]
  ds_read_b128 v[156:159], v201 offset:0
  ds_read_b128 v[160:163], v201 offset:2048
  ds_read_b128 v[164:167], v201 offset:4096
  v_mfma_f32_16x16x32_bf16 v[88:91], v[216:219], v[140:143], v[88:91]
  v_mfma_f32_16x16x32_bf16 v[28:31], v[220:223], v[132:135], v[28:31]
  ds_read_b64_tr_b16 v[216:217], v245 offset:16392
  ds_read_b64_tr_b16 v[218:219], v245 offset:17416
  v_mfma_f32_16x16x32_bf16 v[60:63], v[220:223], v[136:139], v[60:63]
  v_mfma_f32_16x16x32_bf16 v[92:95], v[220:223], v[140:143], v[92:95]
  s_waitcnt lgkmcnt(7)
  v_mfma_f32_16x16x32_bf16 v[0:3], v[204:207], v[144:147], v[0:3]
  ds_read_b64_tr_b16 v[220:221], v246 offset:16384
  ds_read_b64_tr_b16 v[222:223], v246 offset:17408
  v_mfma_f32_16x16x32_bf16 v[32:35], v[204:207], v[148:151], v[32:35]
  v_mfma_f32_16x16x32_bf16 v[64:67], v[204:207], v[152:155], v[64:67]
  v_mfma_f32_16x16x32_bf16 v[4:7], v[208:211], v[144:147], v[4:7]
  ds_read_b64_tr_b16 v[224:225], v246 offset:16392
  ds_read_b64_tr_b16 v[226:227], v246 offset:17416
  v_mfma_f32_16x16x32_bf16 v[36:39], v[208:211], v[148:151], v[36:39]
  v_mfma_f32_16x16x32_bf16 v[68:71], v[208:211], v[152:155], v[68:71]
  s_waitcnt lgkmcnt(4)
  v_mfma_f32_16x16x32_bf16 v[8:11], v[212:215], v[144:147], v[8:11]
  ds_read_b64_tr_b16 v[204:205], v247 offset:16384
  ds_read_b64_tr_b16 v[206:207], v247 offset:17408
  v_mfma_f32_16x16x32_bf16 v[40:43], v[212:215], v[148:151], v[40:43]
  v_mfma_f32_16x16x32_bf16 v[72:75], v[212:215], v[152:155], v[72:75]
  v_mfma_f32_16x16x32_bf16 v[12:15], v[216:219], v[144:147], v[12:15]
  ds_read_b64_tr_b16 v[208:209], v247 offset:16392
  ds_read_b64_tr_b16 v[210:211], v247 offset:17416
  v_mfma_f32_16x16x32_bf16 v[44:47], v[216:219], v[148:151], v[44:47]
  v_mfma_f32_16x16x32_bf16 v[76:79], v[216:219], v[152:155], v[76:79]
  s_waitcnt lgkmcnt(4)
  v_mfma_f32_16x16x32_bf16 v[16:19], v[220:223], v[144:147], v[16:19]
  ds_read_b64_tr_b16 v[212:213], v244 offset:24576
  ds_read_b64_tr_b16 v[214:215], v244 offset:25600
  v_mfma_f32_16x16x32_bf16 v[48:51], v[220:223], v[148:151], v[48:51]
  v_mfma_f32_16x16x32_bf16 v[80:83], v[220:223], v[152:155], v[80:83]
  v_mfma_f32_16x16x32_bf16 v[20:23], v[224:227], v[144:147], v[20:23]
  ds_read_b64_tr_b16 v[216:217], v244 offset:24584
  ds_read_b64_tr_b16 v[218:219], v244 offset:25608
  v_mfma_f32_16x16x32_bf16 v[52:55], v[224:227], v[148:151], v[52:55]
  v_mfma_f32_16x16x32_bf16 v[84:87], v[224:227], v[152:155], v[84:87]
  s_waitcnt lgkmcnt(4)
  v_mfma_f32_16x16x32_bf16 v[24:27], v[204:207], v[144:147], v[24:27]
  ds_read_b64_tr_b16 v[220:221], v245 offset:24576
  ds_read_b64_tr_b16 v[222:223], v245 offset:25600
  v_mfma_f32_16x16x32_bf16 v[56:59], v[204:207], v[148:151], v[56:59]
  v_mfma_f32_16x16x32_bf16 v[88:91], v[204:207], v[152:155], v[88:91]
  v_mfma_f32_16x16x32_bf16 v[28:31], v[208:211], v[144:147], v[28:31]
  ds_read_b64_tr_b16 v[204:205], v245 offset:24584
  ds_read_b64_tr_b16 v[206:207], v245 offset:25608
  v_mfma_f32_16x16x32_bf16 v[60:63], v[208:211], v[148:151], v[60:63]
  v_mfma_f32_16x16x32_bf16 v[92:95], v[208:211], v[152:155], v[92:95]
  s_waitcnt lgkmcnt(4)
  v_mfma_f32_16x16x32_bf16 v[0:3], v[212:215], v[156:159], v[0:3]
  ds_read_b64_tr_b16 v[208:209], v246 offset:24576
  ds_read_b64_tr_b16 v[210:211], v246 offset:25600
  v_mfma_f32_16x16x32_bf16 v[32:35], v[212:215], v[160:163], v[32:35]
  v_mfma_f32_16x16x32_bf16 v[64:67], v[212:215], v[164:167], v[64:67]
  v_mfma_f32_16x16x32_bf16 v[4:7], v[216:219], v[156:159], v[4:7]
  ds_read_b64_tr_b16 v[212:213], v246 offset:24584
  ds_read_b64_tr_b16 v[214:215], v246 offset:25608
  v_mfma_f32_16x16x32_bf16 v[36:39], v[216:219], v[160:163], v[36:39]
  v_mfma_f32_16x16x32_bf16 v[68:71], v[216:219], v[164:167], v[68:71]
  s_waitcnt lgkmcnt(4)
  v_mfma_f32_16x16x32_bf16 v[8:11], v[220:223], v[156:159], v[8:11]
  ds_read_b64_tr_b16 v[216:217], v247 offset:24576
  ds_read_b64_tr_b16 v[218:219], v247 offset:25600
  v_mfma_f32_16x16x32_bf16 v[40:43], v[220:223], v[160:163], v[40:43]
  v_mfma_f32_16x16x32_bf16 v[72:75], v[220:223], v[164:167], v[72:75]
  v_mfma_f32_16x16x32_bf16 v[12:15], v[204:207], v[156:159], v[12:15]
  ds_read_b64_tr_b16 v[220:221], v247 offset:24584
  ds_read_b64_tr_b16 v[222:223], v247 offset:25608
  v_mfma_f32_16x16x32_bf16 v[44:47], v[204:207], v[160:163], v[44:47]
  v_mfma_f32_16x16x32_bf16 v[76:79], v[204:207], v[164:167], v[76:79]
  s_waitcnt lgkmcnt(4)
  v_mfma_f32_16x16x32_bf16 v[16:19], v[208:211], v[156:159], v[16:19]
  v_mfma_f32_16x16x32_bf16 v[48:51], v[208:211], v[160:163], v[48:51]
  v_mfma_f32_16x16x32_bf16 v[80:83], v[208:211], v[164:167], v[80:83]
  s_waitcnt lgkmcnt(0)
  s_barrier
  v_mfma_f32_16x16x32_bf16 v[20:23], v[212:215], v[156:159], v[20:23]
  ds_read_b64_tr_b16 v[204:205], v244 offset:32768
  ds_read_b64_tr_b16 v[206:207], v244 offset:33792
  v_mfma_f32_16x16x32_bf16 v[52:55], v[212:215], v[160:163], v[52:55]
  ds_read_b64_tr_b16 v[208:209], v244 offset:32776
  ds_read_b64_tr_b16 v[210:211], v244 offset:33800
  v_mfma_f32_16x16x32_bf16 v[84:87], v[212:215], v[164:167], v[84:87]
  ds_read_b128 v[168:171], v200 offset:18432
  ds_read_b128 v[172:175], v200 offset:20480
  ds_read_b128 v[176:179], v200 offset:22528
  v_mfma_f32_16x16x32_bf16 v[24:27], v[216:219], v[156:159], v[24:27]
  ds_read_b64_tr_b16 v[212:213], v245 offset:32768
  ds_read_b64_tr_b16 v[214:215], v245 offset:33792
  v_mfma_f32_16x16x32_bf16 v[56:59], v[216:219], v[160:163], v[56:59]
  ds_read_b128 v[180:183], v201 offset:18432
  ds_read_b128 v[184:187], v201 offset:20480
  ds_read_b128 v[188:191], v201 offset:22528
  v_mfma_f32_16x16x32_bf16 v[88:91], v[216:219], v[164:167], v[88:91]
  v_mfma_f32_16x16x32_bf16 v[28:31], v[220:223], v[156:159], v[28:31]
  ds_read_b64_tr_b16 v[216:217], v245 offset:32776
  ds_read_b64_tr_b16 v[218:219], v245 offset:33800
  v_mfma_f32_16x16x32_bf16 v[60:63], v[220:223], v[160:163], v[60:63]
  v_mfma_f32_16x16x32_bf16 v[92:95], v[220:223], v[164:167], v[92:95]
  s_waitcnt lgkmcnt(7)
  v_mfma_f32_16x16x32_bf16 v[0:3], v[204:207], v[168:171], v[0:3]
  ds_read_b64_tr_b16 v[220:221], v246 offset:32768
  ds_read_b64_tr_b16 v[222:223], v246 offset:33792
  v_mfma_f32_16x16x32_bf16 v[32:35], v[204:207], v[172:175], v[32:35]
  v_mfma_f32_16x16x32_bf16 v[64:67], v[204:207], v[176:179], v[64:67]
  v_mfma_f32_16x16x32_bf16 v[4:7], v[208:211], v[168:171], v[4:7]
  ds_read_b64_tr_b16 v[224:225], v246 offset:32776
  ds_read_b64_tr_b16 v[226:227], v246 offset:33800
  v_mfma_f32_16x16x32_bf16 v[36:39], v[208:211], v[172:175], v[36:39]
  v_mfma_f32_16x16x32_bf16 v[68:71], v[208:211], v[176:179], v[68:71]
  s_waitcnt lgkmcnt(4)
  v_mfma_f32_16x16x32_bf16 v[8:11], v[212:215], v[168:171], v[8:11]
  ds_read_b64_tr_b16 v[204:205], v247 offset:32768
  ds_read_b64_tr_b16 v[206:207], v247 offset:33792
  v_mfma_f32_16x16x32_bf16 v[40:43], v[212:215], v[172:175], v[40:43]
  v_mfma_f32_16x16x32_bf16 v[72:75], v[212:215], v[176:179], v[72:75]
  v_mfma_f32_16x16x32_bf16 v[12:15], v[216:219], v[168:171], v[12:15]
  ds_read_b64_tr_b16 v[208:209], v247 offset:32776
  ds_read_b64_tr_b16 v[210:211], v247 offset:33800
  v_mfma_f32_16x16x32_bf16 v[44:47], v[216:219], v[172:175], v[44:47]
  v_mfma_f32_16x16x32_bf16 v[76:79], v[216:219], v[176:179], v[76:79]
  s_waitcnt lgkmcnt(4)
  v_mfma_f32_16x16x32_bf16 v[16:19], v[220:223], v[168:171], v[16:19]
  ds_read_b64_tr_b16 v[212:213], v244 offset:40960
  ds_read_b64_tr_b16 v[214:215], v244 offset:41984
  v_mfma_f32_16x16x32_bf16 v[48:51], v[220:223], v[172:175], v[48:51]
  v_mfma_f32_16x16x32_bf16 v[80:83], v[220:223], v[176:179], v[80:83]
  v_mfma_f32_16x16x32_bf16 v[20:23], v[224:227], v[168:171], v[20:23]
  ds_read_b64_tr_b16 v[216:217], v244 offset:40968
  ds_read_b64_tr_b16 v[218:219], v244 offset:41992
  v_mfma_f32_16x16x32_bf16 v[52:55], v[224:227], v[172:175], v[52:55]
  v_mfma_f32_16x16x32_bf16 v[84:87], v[224:227], v[176:179], v[84:87]
  s_waitcnt lgkmcnt(4)
  v_mfma_f32_16x16x32_bf16 v[24:27], v[204:207], v[168:171], v[24:27]
  ds_read_b64_tr_b16 v[220:221], v245 offset:40960
  ds_read_b64_tr_b16 v[222:223], v245 offset:41984
  v_mfma_f32_16x16x32_bf16 v[56:59], v[204:207], v[172:175], v[56:59]
  v_mfma_f32_16x16x32_bf16 v[88:91], v[204:207], v[176:179], v[88:91]
  v_mfma_f32_16x16x32_bf16 v[28:31], v[208:211], v[168:171], v[28:31]
  ds_read_b64_tr_b16 v[204:205], v245 offset:40968
  ds_read_b64_tr_b16 v[206:207], v245 offset:41992
  v_mfma_f32_16x16x32_bf16 v[60:63], v[208:211], v[172:175], v[60:63]
  v_mfma_f32_16x16x32_bf16 v[92:95], v[208:211], v[176:179], v[92:95]
  s_waitcnt lgkmcnt(4)
  v_mfma_f32_16x16x32_bf16 v[0:3], v[212:215], v[180:183], v[0:3]
  ds_read_b64_tr_b16 v[208:209], v246 offset:40960
  ds_read_b64_tr_b16 v[210:211], v246 offset:41984
  v_mfma_f32_16x16x32_bf16 v[32:35], v[212:215], v[184:187], v[32:35]
  v_mfma_f32_16x16x32_bf16 v[64:67], v[212:215], v[188:191], v[64:67]
  v_mfma_f32_16x16x32_bf16 v[4:7], v[216:219], v[180:183], v[4:7]
  ds_read_b64_tr_b16 v[212:213], v246 offset:40968
  ds_read_b64_tr_b16 v[214:215], v246 offset:41992
  v_mfma_f32_16x16x32_bf16 v[36:39], v[216:219], v[184:187], v[36:39]
  v_mfma_f32_16x16x32_bf16 v[68:71], v[216:219], v[188:191], v[68:71]
  s_waitcnt lgkmcnt(4)
  v_mfma_f32_16x16x32_bf16 v[8:11], v[220:223], v[180:183], v[8:11]
  ds_read_b64_tr_b16 v[216:217], v247 offset:40960
  ds_read_b64_tr_b16 v[218:219], v247 offset:41984
  v_mfma_f32_16x16x32_bf16 v[40:43], v[220:223], v[184:187], v[40:43]
  v_mfma_f32_16x16x32_bf16 v[72:75], v[220:223], v[188:191], v[72:75]
  v_mfma_f32_16x16x32_bf16 v[12:15], v[204:207], v[180:183], v[12:15]
  ds_read_b64_tr_b16 v[220:221], v247 offset:40968
  ds_read_b64_tr_b16 v[222:223], v247 offset:41992
  v_mfma_f32_16x16x32_bf16 v[44:47], v[204:207], v[184:187], v[44:47]
  v_mfma_f32_16x16x32_bf16 v[76:79], v[204:207], v[188:191], v[76:79]
  s_waitcnt lgkmcnt(4)
  v_mfma_f32_16x16x32_bf16 v[16:19], v[208:211], v[180:183], v[16:19]
  v_mfma_f32_16x16x32_bf16 v[48:51], v[208:211], v[184:187], v[48:51]
  v_mfma_f32_16x16x32_bf16 v[80:83], v[208:211], v[188:191], v[80:83]
  s_waitcnt lgkmcnt(0)
  s_barrier
L_att0:
  s_setprio 1
  s_mov_b32 s34, 0
  v_mfma_f32_16x16x32_bf16 v[20:23], v[212:215], v[180:183], v[20:23]
  ds_read_b128 v[224:227], v232 offset:0
  ds_read_b128 v[204:207], v233 offset:0
  v_mfma_f32_16x16x32_bf16 v[52:55], v[212:215], v[184:187], v[52:55]
  v_pk_mul_f32 v[0:1], v[0:1], s[46:47]
  v_pk_mul_f32 v[2:3], v[2:3], s[46:47]
  v_mfma_f32_16x16x32_bf16 v[84:87], v[212:215], v[188:191], v[84:87]
  v_cvt_pk_bf16_f32 v120, v0, v1
  v_mfma_f32_16x16x32_bf16 v[24:27], v[216:219], v[180:183], v[24:27]
  ds_read_b128 v[208:211], v234 offset:0
  v_cvt_pk_bf16_f32 v121, v2, v3
  v_mfma_f32_16x16x32_bf16 v[56:59], v[216:219], v[184:187], v[56:59]
  v_pk_mul_f32 v[4:5], v[4:5], s[46:47]
  v_pk_mul_f32 v[6:7], v[6:7], s[46:47]
  v_mfma_f32_16x16x32_bf16 v[88:91], v[216:219], v[188:191], v[88:91]
  v_cvt_pk_bf16_f32 v122, v4, v5
  v_cvt_pk_bf16_f32 v123, v6, v7
  v_mfma_f32_16x16x32_bf16 v[28:31], v[220:223], v[180:183], v[28:31]
  ds_read_b128 v[212:215], v235 offset:0
  v_pk_mul_f32 v[32:33], v[32:33], s[46:47]
  v_mfma_f32_16x16x32_bf16 v[60:63], v[220:223], v[184:187], v[60:63]
  v_pk_mul_f32 v[34:35], v[34:35], s[46:47]
  v_cvt_pk_bf16_f32 v136, v32, v33
  v_mfma_f32_16x16x32_bf16 v[92:95], v[220:223], v[188:191], v[92:95]
  v_cvt_pk_bf16_f32 v137, v34, v35
  s_waitcnt lgkmcnt(2)
  v_mfma_f32_16x16x32_bf16 v[168:171], v[224:227], v[120:123], 0
  v_pk_mul_f32 v[36:37], v[36:37], s[46:47]
  v_pk_mul_f32 v[38:39], v[38:39], s[46:47]
  v_cvt_pk_bf16_f32 v138, v36, v37
  v_cvt_pk_bf16_f32 v139, v38, v39
  s_nop 1
  v_mfma_f32_16x16x32_bf16 v[172:175], v[224:227], v[136:139], 0
  v_pk_mul_f32 v[64:65], v[64:65], s[46:47]
  v_pk_mul_f32 v[66:67], v[66:67], s[46:47]
  v_cvt_pk_bf16_f32 v152, v64, v65
  v_cvt_pk_bf16_f32 v153, v66, v67
  v_pk_mul_f32 v[68:69], v[68:69], s[46:47]
  v_pk_mul_f32 v[70:71], v[70:71], s[46:47]
  v_cvt_pk_bf16_f32 v154, v68, v69
  v_cvt_pk_bf16_f32 v155, v70, v71
  s_nop 1
  v_mfma_f32_16x16x32_bf16 v[176:179], v[224:227], v[152:155], 0
  v_pk_mul_f32 v[8:9], v[8:9], s[46:47]
  v_pk_mul_f32 v[10:11], v[10:11], s[46:47]
  v_cvt_pk_bf16_f32 v124, v8, v9
  v_cvt_pk_bf16_f32 v125, v10, v11
  v_pk_mul_f32 v[12:13], v[12:13], s[46:47]
  v_pk_mul_f32 v[14:15], v[14:15], s[46:47]
  v_cvt_pk_bf16_f32 v126, v12, v13
  v_cvt_pk_bf16_f32 v127, v14, v15
  s_nop 1
  v_mfma_f32_16x16x32_bf16 v[168:171], v[204:207], v[124:127], v[168:171]
  ds_read_b128 v[216:219], v232 offset:4096
  v_pk_mul_f32 v[40:41], v[40:41], s[46:47]
  v_pk_mul_f32 v[42:43], v[42:43], s[46:47]
  v_cvt_pk_bf16_f32 v140, v40, v41
  v_cvt_pk_bf16_f32 v141, v42, v43
  v_pk_mul_f32 v[44:45], v[44:45], s[46:47]
  v_pk_mul_f32 v[46:47], v[46:47], s[46:47]
  v_cvt_pk_bf16_f32 v142, v44, v45
  v_cvt_pk_bf16_f32 v143, v46, v47
  s_nop 1
  v_mfma_f32_16x16x32_bf16 v[172:175], v[204:207], v[140:143], v[172:175]
  v_pk_mul_f32 v[72:73], v[72:73], s[46:47]
  v_pk_mul_f32 v[74:75], v[74:75], s[46:47]
  v_cvt_pk_bf16_f32 v156, v72, v73
  v_cvt_pk_bf16_f32 v157, v74, v75
  v_pk_mul_f32 v[76:77], v[76:77], s[46:47]
  v_pk_mul_f32 v[78:79], v[78:79], s[46:47]
  v_cvt_pk_bf16_f32 v158, v76, v77
  v_cvt_pk_bf16_f32 v159, v78, v79
  s_nop 1
  v_mfma_f32_16x16x32_bf16 v[176:179], v[204:207], v[156:159], v[176:179]
  v_pk_mul_f32 v[16:17], v[16:17], s[46:47]
  v_pk_mul_f32 v[18:19], v[18:19], s[46:47]
  v_cvt_pk_bf16_f32 v128, v16, v17
  v_cvt_pk_bf16_f32 v129, v18, v19
  v_pk_mul_f32 v[20:21], v[20:21], s[46:47]
  v_pk_mul_f32 v[22:23], v[22:23], s[46:47]
  v_cvt_pk_bf16_f32 v130, v20, v21
  v_cvt_pk_bf16_f32 v131, v22, v23
  s_waitcnt lgkmcnt(1)
  s_nop 0
  v_mfma_f32_16x16x32_bf16 v[168:171], v[208:211], v[128:131], v[168:171]
  ds_read_b128 v[220:223], v233 offset:4096
  v_pk_mul_f32 v[48:49], v[48:49], s[46:47]
  v_pk_mul_f32 v[50:51], v[50:51], s[46:47]
  v_cvt_pk_bf16_f32 v144, v48, v49
  v_cvt_pk_bf16_f32 v145, v50, v51
  v_pk_mul_f32 v[52:53], v[52:53], s[46:47]
  v_pk_mul_f32 v[54:55], v[54:55], s[46:47]
  v_cvt_pk_bf16_f32 v146, v52, v53
  v_cvt_pk_bf16_f32 v147, v54, v55
  s_nop 1
  v_mfma_f32_16x16x32_bf16 v[172:175], v[208:211], v[144:147], v[172:175]
  v_pk_mul_f32 v[80:81], v[80:81], s[46:47]
  v_pk_mul_f32 v[82:83], v[82:83], s[46:47]
  v_cvt_pk_bf16_f32 v160, v80, v81
  v_cvt_pk_bf16_f32 v161, v82, v83
  v_pk_mul_f32 v[84:85], v[84:85], s[46:47]
  v_pk_mul_f32 v[86:87], v[86:87], s[46:47]
  v_cvt_pk_bf16_f32 v162, v84, v85
  v_cvt_pk_bf16_f32 v163, v86, v87
  s_nop 1
  v_mfma_f32_16x16x32_bf16 v[176:179], v[208:211], v[160:163], v[176:179]
  v_pk_mul_f32 v[24:25], v[24:25], s[46:47]
  v_pk_mul_f32 v[26:27], v[26:27], s[46:47]
  v_cvt_pk_bf16_f32 v132, v24, v25
  v_cvt_pk_bf16_f32 v133, v26, v27
  v_pk_mul_f32 v[28:29], v[28:29], s[46:47]
  v_pk_mul_f32 v[30:31], v[30:31], s[46:47]
  v_cvt_pk_bf16_f32 v134, v28, v29
  v_cvt_pk_bf16_f32 v135, v30, v31
  s_nop 1
  v_mfma_f32_16x16x32_bf16 v[168:171], v[212:215], v[132:135], v[168:171]
  ds_read_b128 v[224:227], v234 offset:4096
  v_pk_mul_f32 v[56:57], v[56:57], s[46:47]
  v_pk_mul_f32 v[58:59], v[58:59], s[46:47]
  v_cvt_pk_bf16_f32 v148, v56, v57
  v_cvt_pk_bf16_f32 v149, v58, v59
  v_pk_mul_f32 v[60:61], v[60:61], s[46:47]
  v_pk_mul_f32 v[62:63], v[62:63], s[46:47]
  v_cvt_pk_bf16_f32 v150, v60, v61
  v_cvt_pk_bf16_f32 v151, v62, v63
  s_nop 1
  v_mfma_f32_16x16x32_bf16 v[172:175], v[212:215], v[148:151], v[172:175]
  v_pk_mul_f32 v[88:89], v[88:89], s[46:47]
  v_pk_mul_f32 v[90:91], v[90:91], s[46:47]
  v_cvt_pk_bf16_f32 v164, v88, v89
  v_cvt_pk_bf16_f32 v165, v90, v91
  v_pk_mul_f32 v[92:93], v[92:93], s[46:47]
  v_pk_mul_f32 v[94:95], v[94:95], s[46:47]
  v_cvt_pk_bf16_f32 v166, v92, v93
  v_cvt_pk_bf16_f32 v167, v94, v95
  s_nop 1
  v_mfma_f32_16x16x32_bf16 v[176:179], v[212:215], v[164:167], v[176:179]
  ds_read_b128 v[192:195], v235 offset:4096
  s_waitcnt lgkmcnt(2)
  v_mfma_f32_16x16x32_bf16 v[180:183], v[216:219], v[120:123], 0
  ds_read_b128 v[204:207], v232 offset:8192
  v_mov_b32 v20, 0
  v_mfma_f32_16x16x32_bf16 v[184:187], v[216:219], v[136:139], 0
  v_mov_b32 v21, 0
  v_mov_b32 v22, 0
  v_mfma_f32_16x16x32_bf16 v[188:191], v[216:219], v[152:155], 0
  s_call_b64 s[42:43], L_init
  v_mov_b32 v23, 0
  v_mfma_f32_16x16x32_bf16 v[180:183], v[220:223], v[124:127], v[180:183]
  ds_read_b128 v[208:211], v233 offset:8192
  v_mov_b32 v24, 0
  v_mfma_f32_16x16x32_bf16 v[184:187], v[220:223], v[140:143], v[184:187]
  v_exp_f32 v168, v168
  v_mfma_f32_16x16x32_bf16 v[188:191], v[220:223], v[156:159], v[188:191]
  v_mov_b32 v25, 0
  s_waitcnt lgkmcnt(2)
  v_mfma_f32_16x16x32_bf16 v[180:183], v[224:227], v[128:131], v[180:183]
  ds_read_b128 v[212:215], v234 offset:8192
  v_mov_b32 v26, 0
  v_mfma_f32_16x16x32_bf16 v[184:187], v[224:227], v[144:147], v[184:187]
  v_exp_f32 v169, v169
  v_mfma_f32_16x16x32_bf16 v[188:191], v[224:227], v[160:163], v[188:191]
  v_exp_f32 v170, v170
  v_mfma_f32_16x16x32_bf16 v[180:183], v[192:195], v[132:135], v[180:183]
  v_exp_f32 v171, v171
  v_mfma_f32_16x16x32_bf16 v[184:187], v[192:195], v[148:151], v[184:187]
  v_exp_f32 v172, v172
  v_mfma_f32_16x16x32_bf16 v[188:191], v[192:195], v[164:167], v[188:191]
  v_exp_f32 v173, v173
  v_exp_f32 v174, v174
  v_exp_f32 v175, v175
  v_exp_f32 v176, v176
  v_exp_f32 v177, v177
  v_exp_f32 v178, v178
  v_exp_f32 v179, v179
  v_max3_f32 v252, v180, v181, v182
  v_max3_f32 v252, v252, v183, v184
  v_max3_f32 v252, v252, v185, v186
  v_max3_f32 v252, v252, v187, v188
  v_max3_f32 v252, v252, v189, v190
  v_max_f32 v252, v252, v191
  v_cmp_lt_f32 vcc, 0x41200000, v252
  s_cbranch_vccnz L_stubB_a0_0
L_retB_a0_0:
  v_cvt_pk_bf16_f32 v192, v168, v169
  v_cvt_pk_bf16_f32 v193, v170, v171
  s_waitcnt lgkmcnt(1)
  v_mfma_f32_16x16x32_bf16 v[168:171], v[204:207], v[120:123], v[108:111]
  ds_read_b128 v[216:219], v235 offset:8192
  v_cvt_pk_bf16_f32 v196, v172, v173
  v_cvt_pk_bf16_f32 v197, v174, v175
  v_mfma_f32_16x16x32_bf16 v[172:175], v[204:207], v[136:139], v[112:115]
  v_cvt_pk_bf16_f32 v200, v176, v177
  v_cvt_pk_bf16_f32 v201, v178, v179
  v_mfma_f32_16x16x32_bf16 v[176:179], v[204:207], v[152:155], v[116:119]
  ds_read_b128 v[220:223], v232 offset:12288
  v_mov_b32 v27, 0
  v_mfma_f32_16x16x32_bf16 v[168:171], v[208:211], v[124:127], v[168:171]
  ds_read_b128 v[224:227], v233 offset:12288
  v_mov_b32 v28, 0
  v_mfma_f32_16x16x32_bf16 v[172:175], v[208:211], v[140:143], v[172:175]
  v_exp_f32 v180, v180
  v_mfma_f32_16x16x32_bf16 v[176:179], v[208:211], v[156:159], v[176:179]
  v_mov_b32 v29, 0
  s_waitcnt lgkmcnt(2)
  v_mfma_f32_16x16x32_bf16 v[168:171], v[212:215], v[128:131], v[168:171]
  ds_read_b128 v[204:207], v234 offset:12288
  v_mov_b32 v30, 0
  v_mfma_f32_16x16x32_bf16 v[172:175], v[212:215], v[144:147], v[172:175]
  v_exp_f32 v181, v181
  v_mfma_f32_16x16x32_bf16 v[176:179], v[212:215], v[160:163], v[176:179]
  v_exp_f32 v182, v182
  v_mfma_f32_16x16x32_bf16 v[168:171], v[216:219], v[132:135], v[168:171]
  v_exp_f32 v183, v183
  v_mfma_f32_16x16x32_bf16 v[172:175], v[216:219], v[148:151], v[172:175]
  ds_read_b128 v[208:211], v235 offset:12288
  v_mov_b32 v31, 0
  v_mfma_f32_16x16x32_bf16 v[176:179], v[216:219], v[164:167], v[176:179]
  v_exp_f32 v184, v184
  v_exp_f32 v185, v185
  v_exp_f32 v186, v186
  v_exp_f32 v187, v187
  v_exp_f32 v188, v188
  v_exp_f32 v189, v189
  v_exp_f32 v190, v190
  v_exp_f32 v191, v191
  v_cvt_pk_bf16_f32 v194, v180, v181
  v_cvt_pk_bf16_f32 v195, v182, v183
  s_waitcnt lgkmcnt(2)
  v_mfma_f32_16x16x32_bf16 v[180:183], v[220:223], v[120:123], v[108:111]
  v_cvt_pk_bf16_f32 v198, v184, v185
  v_cvt_pk_bf16_f32 v199, v186, v187
  v_mfma_f32_16x16x32_bf16 v[184:187], v[220:223], v[136:139], v[112:115]
  v_cvt_pk_bf16_f32 v202, v188, v189
  v_cvt_pk_bf16_f32 v203, v190, v191
  v_mfma_f32_16x16x32_bf16 v[188:191], v[220:223], v[152:155], v[116:119]
  ds_read_b64_tr_b16 v[212:213], v236 offset:8192
  ds_read_b64_tr_b16 v[214:215], v236 offset:12288
  v_mfma_f32_16x16x32_bf16 v[180:183], v[224:227], v[124:127], v[180:183]
  v_max3_f32 v252, v168, v169, v170
  v_max3_f32 v252, v252, v171, v172
  v_mfma_f32_16x16x32_bf16 v[184:187], v[224:227], v[140:143], v[184:187]
  v_max3_f32 v252, v252, v173, v174
  v_max3_f32 v252, v252, v175, v176
  v_mfma_f32_16x16x32_bf16 v[188:191], v[224:227], v[156:159], v[188:191]
  v_max3_f32 v252, v252, v177, v178
  v_max_f32 v252, v252, v179
  s_waitcnt lgkmcnt(2)
  v_mfma_f32_16x16x32_bf16 v[180:183], v[204:207], v[128:131], v[180:183]
  ds_read_b64_tr_b16 v[216:217], v237 offset:8192
  ds_read_b64_tr_b16 v[218:219], v237 offset:12288
  v_cmp_lt_f32 vcc, 0x41200000, v252
  v_mfma_f32_16x16x32_bf16 v[184:187], v[204:207], v[144:147], v[184:187]
  ds_read_b64_tr_b16 v[220:221], v238 offset:8192
  ds_read_b64_tr_b16 v[222:223], v238 offset:12288
  v_mfma_f32_16x16x32_bf16 v[188:191], v[204:207], v[160:163], v[188:191]
  s_cbranch_vccnz L_stubA_a0_1
L_retA_a0_1:
  v_mov_b32 v52, 0
  v_mfma_f32_16x16x32_bf16 v[180:183], v[208:211], v[132:135], v[180:183]
  ds_read_b64_tr_b16 v[204:205], v239 offset:8192
  ds_read_b64_tr_b16 v[206:207], v239 offset:12288
  v_mfma_f32_16x16x32_bf16 v[184:187], v[208:211], v[148:151], v[184:187]
  v_mov_b32 v53, 0
  v_mov_b32 v54, 0
  v_mfma_f32_16x16x32_bf16 v[188:191], v[208:211], v[164:167], v[188:191]
  v_mov_b32 v55, 0
  v_mov_b32 v56, 0
  v_mfma_f32_16x16x32_bf16 v[96:99], v[228:231], v[192:195], 0
  v_mov_b32 v57, 0
  v_mov_b32 v58, 0
  v_mfma_f32_16x16x32_bf16 v[100:103], v[228:231], v[196:199], 0
  v_mov_b32 v59, 0
  v_mov_b32 v60, 0
  v_mfma_f32_16x16x32_bf16 v[104:107], v[228:231], v[200:203], 0
  v_mov_b32 v61, 0
  s_waitcnt lgkmcnt(4)
  v_mfma_f32_16x16x32_bf16 v[0:3], v[212:215], v[192:195], 0
  ds_read_b64_tr_b16 v[208:209], v240 offset:8192
  ds_read_b64_tr_b16 v[210:211], v240 offset:12288
  v_mfma_f32_16x16x32_bf16 v[32:35], v[212:215], v[196:199], 0
  v_mov_b32 v62, 0
  v_mov_b32 v63, 0
  v_mfma_f32_16x16x32_bf16 v[64:67], v[212:215], v[200:203], 0
  v_mov_b32 v84, 0
  v_mov_b32 v85, 0
  v_mfma_f32_16x16x32_bf16 v[4:7], v[216:219], v[192:195], 0
  ds_read_b64_tr_b16 v[212:213], v241 offset:8192
  ds_read_b64_tr_b16 v[214:215], v241 offset:12288
  v_mfma_f32_16x16x32_bf16 v[36:39], v[216:219], v[196:199], 0
  v_mov_b32 v86, 0
  v_mov_b32 v87, 0
  v_mfma_f32_16x16x32_bf16 v[68:71], v[216:219], v[200:203], 0
  v_mov_b32 v88, 0
  s_waitcnt lgkmcnt(4)
  v_mfma_f32_16x16x32_bf16 v[8:11], v[220:223], v[192:195], 0
  v_mov_b32 v89, 0
  v_mov_b32 v90, 0
  v_mov_b32 v91, 0
  v_mov_b32 v92, 0
  v_mov_b32 v93, 0
  v_mov_b32 v94, 0
  v_mov_b32 v95, 0
  v_mfma_f32_16x16x32_bf16 v[40:43], v[220:223], v[196:199], 0
  v_exp_f32 v168, v168
  v_mfma_f32_16x16x32_bf16 v[72:75], v[220:223], v[200:203], 0
  v_exp_f32 v169, v169
  v_exp_f32 v170, v170
  v_exp_f32 v171, v171
  v_exp_f32 v172, v172
  v_exp_f32 v173, v173
  v_exp_f32 v174, v174
  v_exp_f32 v175, v175
  v_exp_f32 v176, v176
  v_exp_f32 v177, v177
  v_exp_f32 v178, v178
  v_exp_f32 v179, v179
  v_mfma_f32_16x16x32_bf16 v[12:15], v[204:207], v[192:195], 0
  ds_read_b64_tr_b16 v[216:217], v242 offset:8192
  ds_read_b64_tr_b16 v[218:219], v242 offset:12288
  v_mfma_f32_16x16x32_bf16 v[44:47], v[204:207], v[196:199], 0
  ds_read_b64_tr_b16 v[220:221], v243 offset:8192
  ds_read_b64_tr_b16 v[222:223], v243 offset:12288
  v_mfma_f32_16x16x32_bf16 v[76:79], v[204:207], v[200:203], 0
  v_max3_f32 v252, v180, v181, v182
  s_waitcnt lgkmcnt(4)
  v_mfma_f32_16x16x32_bf16 v[16:19], v[208:211], v[192:195], 0
  v_max3_f32 v252, v252, v183, v184
  v_max3_f32 v252, v252, v185, v186
  v_max3_f32 v252, v252, v187, v188
  v_max3_f32 v252, v252, v189, v190
  v_max_f32 v252, v252, v191
  v_cmp_lt_f32 vcc, 0x41200000, v252
  v_mfma_f32_16x16x32_bf16 v[48:51], v[208:211], v[196:199], 0
  v_mfma_f32_16x16x32_bf16 v[80:83], v[208:211], v[200:203], 0
  s_cbranch_vccnz L_stubB_a0_1
L_retB_a0_1:
  s_waitcnt lgkmcnt(0)
L_aloop:
  s_barrier
  v_mfma_f32_16x16x32_bf16 v[20:23], v[212:215], v[192:195], v[20:23]
  ds_read_b128 v[204:207], v232 offset:16384
  ds_read_b128 v[208:211], v233 offset:16384
  v_mfma_f32_16x16x32_bf16 v[52:55], v[212:215], v[196:199], v[52:55]
  v_exp_f32 v180, v180
  v_mfma_f32_16x16x32_bf16 v[84:87], v[212:215], v[200:203], v[84:87]
  v_exp_f32 v181, v181
  v_mfma_f32_16x16x32_bf16 v[24:27], v[216:219], v[192:195], v[24:27]
  ds_read_b128 v[212:215], v234 offset:16384
  v_exp_f32 v182, v182
  v_mfma_f32_16x16x32_bf16 v[56:59], v[216:219], v[196:199], v[56:59]
  v_exp_f32 v183, v183
  v_mfma_f32_16x16x32_bf16 v[88:91], v[216:219], v[200:203], v[88:91]
  v_exp_f32 v184, v184
  v_mfma_f32_16x16x32_bf16 v[28:31], v[220:223], v[192:195], v[28:31]
  v_cvt_pk_bf16_f32 v192, v168, v169
  v_cvt_pk_bf16_f32 v193, v170, v171
  v_mfma_f32_16x16x32_bf16 v[60:63], v[220:223], v[196:199], v[60:63]
  ds_read_b128 v[216:219], v235 offset:16384
  v_cvt_pk_bf16_f32 v196, v172, v173
  v_mfma_f32_16x16x32_bf16 v[92:95], v[220:223], v[200:203], v[92:95]
  v_cvt_pk_bf16_f32 v197, v174, v175
  s_waitcnt lgkmcnt(2)
  v_mfma_f32_16x16x32_bf16 v[168:171], v[204:207], v[120:123], v[108:111]
  v_cvt_pk_bf16_f32 v200, v176, v177
  v_cvt_pk_bf16_f32 v201, v178, v179
  v_mfma_f32_16x16x32_bf16 v[172:175], v[204:207], v[136:139], v[112:115]
  ds_read_b128 v[220:223], v232 offset:20480
  v_exp_f32 v185, v185
  v_mfma_f32_16x16x32_bf16 v[176:179], v[204:207], v[152:155], v[116:119]
  v_exp_f32 v186, v186
  v_mfma_f32_16x16x32_bf16 v[168:171], v[208:211], v[124:127], v[168:171]
  ds_read_b128 v[224:227], v233 offset:20480
  v_exp_f32 v187, v187
  v_mfma_f32_16x16x32_bf16 v[172:175], v[208:211], v[140:143], v[172:175]
  v_exp_f32 v188, v188
  v_mfma_f32_16x16x32_bf16 v[176:179], v[208:211], v[156:159], v[176:179]
  v_exp_f32 v189, v189
  s_waitcnt lgkmcnt(2)
  v_mfma_f32_16x16x32_bf16 v[168:171], v[212:215], v[128:131], v[168:171]
  ds_read_b128 v[204:207], v234 offset:20480
  v_exp_f32 v190, v190
  v_mfma_f32_16x16x32_bf16 v[172:175], v[212:215], v[144:147], v[172:175]
  v_exp_f32 v191, v191
  v_mfma_f32_16x16x32_bf16 v[176:179], v[212:215], v[160:163], v[176:179]
  v_cvt_pk_bf16_f32 v194, v180, v181
  v_cvt_pk_bf16_f32 v195, v182, v183
  v_mfma_f32_16x16x32_bf16 v[168:171], v[216:219], v[132:135], v[168:171]
  ds_read_b128 v[208:211], v235 offset:20480
  v_cvt_pk_bf16_f32 v198, v184, v185
  v_mfma_f32_16x16x32_bf16 v[172:175], v[216:219], v[148:151], v[172:175]
  v_cvt_pk_bf16_f32 v199, v186, v187
  v_cvt_pk_bf16_f32 v202, v188, v189
  v_mfma_f32_16x16x32_bf16 v[176:179], v[216:219], v[164:167], v[176:179]
  v_cvt_pk_bf16_f32 v203, v190, v191
  s_waitcnt lgkmcnt(2)
  v_mfma_f32_16x16x32_bf16 v[180:183], v[220:223], v[120:123], v[108:111]
  ds_read_b64_tr_b16 v[212:213], v236 offset:16384
  ds_read_b64_tr_b16 v[214:215], v236 offset:20480
  v_mfma_f32_16x16x32_bf16 v[184:187], v[220:223], v[136:139], v[112:115]
  v_max3_f32 v252, v168, v169, v170
  v_max3_f32 v252, v252, v171, v172
  v_mfma_f32_16x16x32_bf16 v[188:191], v[220:223], v[152:155], v[116:119]
  v_max3_f32 v252, v252, v173, v174
  v_max3_f32 v252, v252, v175, v176
  v_mfma_f32_16x16x32_bf16 v[180:183], v[224:227], v[124:127], v[180:183]
  v_max3_f32 v252, v252, v177, v178
  v_max_f32 v252, v252, v179
  v_mfma_f32_16x16x32_bf16 v[184:187], v[224:227], v[140:143], v[184:187]
  ds_read_b64_tr_b16 v[216:217], v237 offset:16384
  ds_read_b64_tr_b16 v[218:219], v237 offset:20480
  v_mfma_f32_16x16x32_bf16 v[188:191], v[224:227], v[156:159], v[188:191]
  v_cmp_lt_f32 vcc, 0x41200000, v252
  s_waitcnt lgkmcnt(4)
  v_mfma_f32_16x16x32_bf16 v[180:183], v[204:207], v[128:131], v[180:183]
  ds_read_b64_tr_b16 v[220:221], v238 offset:16384
  ds_read_b64_tr_b16 v[222:223], v238 offset:20480
  v_mfma_f32_16x16x32_bf16 v[184:187], v[204:207], v[144:147], v[184:187]
  s_cbranch_vccnz L_stubA_a1_2
L_retA_a1_2:
  v_exp_f32 v168, v168
  v_mfma_f32_16x16x32_bf16 v[188:191], v[204:207], v[160:163], v[188:191]
  v_exp_f32 v169, v169
  v_mfma_f32_16x16x32_bf16 v[180:183], v[208:211], v[132:135], v[180:183]
  ds_read_b64_tr_b16 v[204:205], v239 offset:16384
  ds_read_b64_tr_b16 v[206:207], v239 offset:20480
  v_mfma_f32_16x16x32_bf16 v[184:187], v[208:211], v[148:151], v[184:187]
  v_exp_f32 v170, v170
  v_mfma_f32_16x16x32_bf16 v[188:191], v[208:211], v[164:167], v[188:191]
  v_exp_f32 v171, v171
  v_mfma_f32_16x16x32_bf16 v[96:99], v[228:231], v[192:195], v[96:99]
  v_exp_f32 v172, v172
  v_mfma_f32_16x16x32_bf16 v[100:103], v[228:231], v[196:199], v[100:103]
  v_exp_f32 v173, v173
  v_mfma_f32_16x16x32_bf16 v[104:107], v[228:231], v[200:203], v[104:107]
  v_exp_f32 v174, v174
  s_waitcnt lgkmcnt(4)
  v_mfma_f32_16x16x32_bf16 v[0:3], v[212:215], v[192:195], v[0:3]
  ds_read_b64_tr_b16 v[208:209], v240 offset:16384
  ds_read_b64_tr_b16 v[210:211], v240 offset:20480
  v_mfma_f32_16x16x32_bf16 v[32:35], v[212:215], v[196:199], v[32:35]
  v_exp_f32 v175, v175
  v_mfma_f32_16x16x32_bf16 v[64:67], v[212:215], v[200:203], v[64:67]
  v_exp_f32 v176, v176
  v_mfma_f32_16x16x32_bf16 v[4:7], v[216:219], v[192:195], v[4:7]
  ds_read_b64_tr_b16 v[212:213], v241 offset:16384
  ds_read_b64_tr_b16 v[214:215], v241 offset:20480
  v_mfma_f32_16x16x32_bf16 v[36:39], v[216:219], v[196:199], v[36:39]
  v_exp_f32 v177, v177
  v_mfma_f32_16x16x32_bf16 v[68:71], v[216:219], v[200:203], v[68:71]
  v_exp_f32 v178, v178
  s_waitcnt lgkmcnt(4)
  v_mfma_f32_16x16x32_bf16 v[8:11], v[220:223], v[192:195], v[8:11]
  v_exp_f32 v179, v179
  v_mfma_f32_16x16x32_bf16 v[40:43], v[220:223], v[196:199], v[40:43]
  ds_read_b64_tr_b16 v[216:217], v242 offset:16384
  ds_read_b64_tr_b16 v[218:219], v242 offset:20480
  v_mfma_f32_16x16x32_bf16 v[72:75], v[220:223], v[200:203], v[72:75]
  v_max3_f32 v252, v180, v181, v182
  v_max3_f32 v252, v252, v183, v184
  v_mfma_f32_16x16x32_bf16 v[12:15], v[204:207], v[192:195], v[12:15]
  ds_read_b64_tr_b16 v[220:221], v243 offset:16384
  ds_read_b64_tr_b16 v[222:223], v243 offset:20480
  v_mfma_f32_16x16x32_bf16 v[44:47], v[204:207], v[196:199], v[44:47]
  v_max3_f32 v252, v252, v185, v186
  v_max3_f32 v252, v252, v187, v188
  v_mfma_f32_16x16x32_bf16 v[76:79], v[204:207], v[200:203], v[76:79]
  v_max3_f32 v252, v252, v189, v190
  s_waitcnt lgkmcnt(4)
  v_mfma_f32_16x16x32_bf16 v[16:19], v[208:211], v[192:195], v[16:19]
  v_max_f32 v252, v252, v191
  v_cmp_lt_f32 vcc, 0x41200000, v252
  v_mfma_f32_16x16x32_bf16 v[48:51], v[208:211], v[196:199], v[48:51]
  ds_read_b128 v[204:207], v232 offset:24576
  v_mfma_f32_16x16x32_bf16 v[80:83], v[208:211], v[200:203], v[80:83]
  s_cbranch_vccnz L_stubB_a1_2
L_retB_a1_2:
  v_exp_f32 v180, v180
  v_mfma_f32_16x16x32_bf16 v[20:23], v[212:215], v[192:195], v[20:23]
  ds_read_b128 v[208:211], v233 offset:24576
  v_exp_f32 v181, v181
  v_mfma_f32_16x16x32_bf16 v[52:55], v[212:215], v[196:199], v[52:55]
  v_exp_f32 v182, v182
  v_mfma_f32_16x16x32_bf16 v[84:87], v[212:215], v[200:203], v[84:87]
  v_exp_f32 v183, v183
  s_waitcnt lgkmcnt(2)
  v_mfma_f32_16x16x32_bf16 v[24:27], v[216:219], v[192:195], v[24:27]
  ds_read_b128 v[212:215], v234 offset:24576
  v_exp_f32 v184, v184
  v_mfma_f32_16x16x32_bf16 v[56:59], v[216:219], v[196:199], v[56:59]
  v_exp_f32 v185, v185
  v_mfma_f32_16x16x32_bf16 v[88:91], v[216:219], v[200:203], v[88:91]
  v_exp_f32 v186, v186
  v_mfma_f32_16x16x32_bf16 v[28:31], v[220:223], v[192:195], v[28:31]
  v_cvt_pk_bf16_f32 v192, v168, v169
  v_cvt_pk_bf16_f32 v193, v170, v171
  v_mfma_f32_16x16x32_bf16 v[60:63], v[220:223], v[196:199], v[60:63]
  ds_read_b128 v[216:219], v235 offset:24576
  v_cvt_pk_bf16_f32 v196, v172, v173
  v_mfma_f32_16x16x32_bf16 v[92:95], v[220:223], v[200:203], v[92:95]
  v_cvt_pk_bf16_f32 v197, v174, v175
  s_waitcnt lgkmcnt(2)
  v_mfma_f32_16x16x32_bf16 v[168:171], v[204:207], v[120:123], v[108:111]
  v_cvt_pk_bf16_f32 v200, v176, v177
  v_cvt_pk_bf16_f32 v201, v178, v179
  v_mfma_f32_16x16x32_bf16 v[172:175], v[204:207], v[136:139], v[112:115]
  ds_read_b128 v[220:223], v232 offset:28672
  v_exp_f32 v187, v187
  v_mfma_f32_16x16x32_bf16 v[176:179], v[204:207], v[152:155], v[116:119]
  v_exp_f32 v188, v188
  v_mfma_f32_16x16x32_bf16 v[168:171], v[208:211], v[124:127], v[168:171]
  ds_read_b128 v[224:227], v233 offset:28672
  v_exp_f32 v189, v189
  v_mfma_f32_16x16x32_bf16 v[172:175], v[208:211], v[140:143], v[172:175]
  v_exp_f32 v190, v190
  v_mfma_f32_16x16x32_bf16 v[176:179], v[208:211], v[156:159], v[176:179]
  v_exp_f32 v191, v191
  s_waitcnt lgkmcnt(2)
  v_mfma_f32_16x16x32_bf16 v[168:171], v[212:215], v[128:131], v[168:171]
  ds_read_b128 v[204:207], v234 offset:28672
  v_cvt_pk_bf16_f32 v194, v180, v181
  v_mfma_f32_16x16x32_bf16 v[172:175], v[212:215], v[144:147], v[172:175]
  v_cvt_pk_bf16_f32 v195, v182, v183
  v_cvt_pk_bf16_f32 v198, v184, v185
  v_mfma_f32_16x16x32_bf16 v[176:179], v[212:215], v[160:163], v[176:179]
  v_cvt_pk_bf16_f32 v199, v186, v187
  v_cvt_pk_bf16_f32 v202, v188, v189
  v_mfma_f32_16x16x32_bf16 v[168:171], v[216:219], v[132:135], v[168:171]
  ds_read_b128 v[208:211], v235 offset:28672
  v_cvt_pk_bf16_f32 v203, v190, v191
  v_mfma_f32_16x16x32_bf16 v[172:175], v[216:219], v[148:151], v[172:175]
  v_mfma_f32_16x16x32_bf16 v[176:179], v[216:219], v[164:167], v[176:179]
  s_waitcnt lgkmcnt(2)
  v_mfma_f32_16x16x32_bf16 v[180:183], v[220:223], v[120:123], v[108:111]
  ds_read_b64_tr_b16 v[212:213], v236 offset:24576
  ds_read_b64_tr_b16 v[214:215], v236 offset:28672
  v_mfma_f32_16x16x32_bf16 v[184:187], v[220:223], v[136:139], v[112:115]
  v_max3_f32 v252, v168, v169, v170
  v_mfma_f32_16x16x32_bf16 v[188:191], v[220:223], v[152:155], v[116:119]
  v_max3_f32 v252, v252, v171, v172
  v_max3_f32 v252, v252, v173, v174
  v_mfma_f32_16x16x32_bf16 v[180:183], v[224:227], v[124:127], v[180:183]
  v_max3_f32 v252, v252, v175, v176
  v_max3_f32 v252, v252, v177, v178
  v_mfma_f32_16x16x32_bf16 v[184:187], v[224:227], v[140:143], v[184:187]
  v_max_f32 v252, v252, v179
  v_cmp_lt_f32 vcc, 0x41200000, v252
  v_mfma_f32_16x16x32_bf16 v[188:191], v[224:227], v[156:159], v[188:191]
  ds_read_b64_tr_b16 v[216:217], v237 offset:24576
  ds_read_b64_tr_b16 v[218:219], v237 offset:28672
  s_waitcnt lgkmcnt(4)
  v_mfma_f32_16x16x32_bf16 v[180:183], v[204:207], v[128:131], v[180:183]
  ds_read_b64_tr_b16 v[220:221], v238 offset:24576
  ds_read_b64_tr_b16 v[222:223], v238 offset:28672
  v_mfma_f32_16x16x32_bf16 v[184:187], v[204:207], v[144:147], v[184:187]
  s_cbranch_vccnz L_stubA_a1_3
L_retA_a1_3:
  v_exp_f32 v168, v168
  v_mfma_f32_16x16x32_bf16 v[188:191], v[204:207], v[160:163], v[188:191]
  v_exp_f32 v169, v169
  v_mfma_f32_16x16x32_bf16 v[180:183], v[208:211], v[132:135], v[180:183]
  ds_read_b64_tr_b16 v[204:205], v239 offset:24576
  ds_read_b64_tr_b16 v[206:207], v239 offset:28672
  v_mfma_f32_16x16x32_bf16 v[184:187], v[208:211], v[148:151], v[184:187]
  v_exp_f32 v170, v170
  v_mfma_f32_16x16x32_bf16 v[188:191], v[208:211], v[164:167], v[188:191]
  v_exp_f32 v171, v171
  v_mfma_f32_16x16x32_bf16 v[96:99], v[228:231], v[192:195], v[96:99]
  v_exp_f32 v172, v172
  v_mfma_f32_16x16x32_bf16 v[100:103], v[228:231], v[196:199], v[100:103]
  v_exp_f32 v173, v173
  v_mfma_f32_16x16x32_bf16 v[104:107], v[228:231], v[200:203], v[104:107]
  v_exp_f32 v174, v174
  s_waitcnt lgkmcnt(4)
  v_mfma_f32_16x16x32_bf16 v[0:3], v[212:215], v[192:195], v[0:3]
  ds_read_b64_tr_b16 v[208:209], v240 offset:24576
  ds_read_b64_tr_b16 v[210:211], v240 offset:28672
  v_mfma_f32_16x16x32_bf16 v[32:35], v[212:215], v[196:199], v[32:35]
  v_exp_f32 v175, v175
  v_mfma_f32_16x16x32_bf16 v[64:67], v[212:215], v[200:203], v[64:67]
  v_exp_f32 v176, v176
  v_mfma_f32_16x16x32_bf16 v[4:7], v[216:219], v[192:195], v[4:7]
  ds_read_b64_tr_b16 v[212:213], v241 offset:24576
  ds_read_b64_tr_b16 v[214:215], v241 offset:28672
  v_mfma_f32_16x16x32_bf16 v[36:39], v[216:219], v[196:199], v[36:39]
  v_exp_f32 v177, v177
  v_mfma_f32_16x16x32_bf16 v[68:71], v[216:219], v[200:203], v[68:71]
  v_exp_f32 v178, v178
  s_waitcnt lgkmcnt(4)
  v_mfma_f32_16x16x32_bf16 v[8:11], v[220:223], v[192:195], v[8:11]
  v_exp_f32 v179, v179
  v_mfma_f32_16x16x32_bf16 v[40:43], v[220:223], v[196:199], v[40:43]
  ds_read_b64_tr_b16 v[216:217], v242 offset:24576
  ds_read_b64_tr_b16 v[218:219], v242 offset:28672
  v_mfma_f32_16x16x32_bf16 v[72:75], v[220:223], v[200:203], v[72:75]
  v_max3_f32 v252, v180, v181, v182
  v_max3_f32 v252, v252, v183, v184
  v_mfma_f32_16x16x32_bf16 v[12:15], v[204:207], v[192:195], v[12:15]
  ds_read_b64_tr_b16 v[220:221], v243 offset:24576
  ds_read_b64_tr_b16 v[222:223], v243 offset:28672
  v_mfma_f32_16x16x32_bf16 v[44:47], v[204:207], v[196:199], v[44:47]
  v_max3_f32 v252, v252, v185, v186
  v_max3_f32 v252, v252, v187, v188
  v_mfma_f32_16x16x32_bf16 v[76:79], v[204:207], v[200:203], v[76:79]
  v_max3_f32 v252, v252, v189, v190
  s_waitcnt lgkmcnt(4)
  v_mfma_f32_16x16x32_bf16 v[16:19], v[208:211], v[192:195], v[16:19]
  v_max_f32 v252, v252, v191
  v_cmp_lt_f32 vcc, 0x41200000, v252
  v_mfma_f32_16x16x32_bf16 v[48:51], v[208:211], v[196:199], v[48:51]
  v_mfma_f32_16x16x32_bf16 v[80:83], v[208:211], v[200:203], v[80:83]
  s_cbranch_vccnz L_stubB_a1_3
L_retB_a1_3:
  s_waitcnt lgkmcnt(0)
  s_barrier
  v_mfma_f32_16x16x32_bf16 v[20:23], v[212:215], v[192:195], v[20:23]
  ds_read_b128 v[204:207], v232 offset:32768
  ds_read_b128 v[208:211], v233 offset:32768
  v_mfma_f32_16x16x32_bf16 v[52:55], v[212:215], v[196:199], v[52:55]
  v_exp_f32 v180, v180
  v_mfma_f32_16x16x32_bf16 v[84:87], v[212:215], v[200:203], v[84:87]
  v_exp_f32 v181, v181
  v_mfma_f32_16x16x32_bf16 v[24:27], v[216:219], v[192:195], v[24:27]
  ds_read_b128 v[212:215], v234 offset:32768
  v_exp_f32 v182, v182
  v_mfma_f32_16x16x32_bf16 v[56:59], v[216:219], v[196:199], v[56:59]
  v_exp_f32 v183, v183
  v_mfma_f32_16x16x32_bf16 v[88:91], v[216:219], v[200:203], v[88:91]
  v_exp_f32 v184, v184
  v_mfma_f32_16x16x32_bf16 v[28:31], v[220:223], v[192:195], v[28:31]
  v_cvt_pk_bf16_f32 v192, v168, v169
  v_cvt_pk_bf16_f32 v193, v170, v171
  v_mfma_f32_16x16x32_bf16 v[60:63], v[220:223], v[196:199], v[60:63]
  ds_read_b128 v[216:219], v235 offset:32768
  v_cvt_pk_bf16_f32 v196, v172, v173
  v_mfma_f32_16x16x32_bf16 v[92:95], v[220:223], v[200:203], v[92:95]
  v_cvt_pk_bf16_f32 v197, v174, v175
  s_waitcnt lgkmcnt(2)
  v_mfma_f32_16x16x32_bf16 v[168:171], v[204:207], v[120:123], v[108:111]
  v_cvt_pk_bf16_f32 v200, v176, v177
  v_cvt_pk_bf16_f32 v201, v178, v179
  v_mfma_f32_16x16x32_bf16 v[172:175], v[204:207], v[136:139], v[112:115]
  ds_read_b128 v[220:223], v232 offset:36864
  v_exp_f32 v185, v185
  v_mfma_f32_16x16x32_bf16 v[176:179], v[204:207], v[152:155], v[116:119]
  v_exp_f32 v186, v186
  v_mfma_f32_16x16x32_bf16 v[168:171], v[208:211], v[124:127], v[168:171]
  ds_read_b128 v[224:227], v233 offset:36864
  v_exp_f32 v187, v187
  v_mfma_f32_16x16x32_bf16 v[172:175], v[208:211], v[140:143], v[172:175]
  v_exp_f32 v188, v188
  v_mfma_f32_16x16x32_bf16 v[176:179], v[208:211], v[156:159], v[176:179]
  v_exp_f32 v189, v189
  s_waitcnt lgkmcnt(2)
  v_mfma_f32_16x16x32_bf16 v[168:171], v[212:215], v[128:131], v[168:171]
  ds_read_b128 v[204:207], v234 offset:36864
  v_exp_f32 v190, v190
  v_mfma_f32_16x16x32_bf16 v[172:175], v[212:215], v[144:147], v[172:175]
  v_exp_f32 v191, v191
  v_mfma_f32_16x16x32_bf16 v[176:179], v[212:215], v[160:163], v[176:179]
  v_cvt_pk_bf16_f32 v194, v180, v181
  v_cvt_pk_bf16_f32 v195, v182, v183
  v_mfma_f32_16x16x32_bf16 v[168:171], v[216:219], v[132:135], v[168:171]
  ds_read_b128 v[208:211], v235 offset:36864
  v_cvt_pk_bf16_f32 v198, v184, v185
  v_mfma_f32_16x16x32_bf16 v[172:175], v[216:219], v[148:151], v[172:175]
  v_cvt_pk_bf16_f32 v199, v186, v187
  v_cvt_pk_bf16_f32 v202, v188, v189
  v_mfma_f32_16x16x32_bf16 v[176:179], v[216:219], v[164:167], v[176:179]
  v_cvt_pk_bf16_f32 v203, v190, v191
  s_waitcnt lgkmcnt(2)
  v_mfma_f32_16x16x32_bf16 v[180:183], v[220:223], v[120:123], v[108:111]
  ds_read_b64_tr_b16 v[212:213], v236 offset:32768
  ds_read_b64_tr_b16 v[214:215], v236 offset:36864
  v_mfma_f32_16x16x32_bf16 v[184:187], v[220:223], v[136:139], v[112:115]
  v_max3_f32 v252, v168, v169, v170
  v_max3_f32 v252, v252, v171, v172
  v_mfma_f32_16x16x32_bf16 v[188:191], v[220:223], v[152:155], v[116:119]
  v_max3_f32 v252, v252, v173, v174
  v_max3_f32 v252, v252, v175, v176
  v_mfma_f32_16x16x32_bf16 v[180:183], v[224:227], v[124:127], v[180:183]
  v_max3_f32 v252, v252, v177, v178
  v_max_f32 v252, v252, v179
  v_mfma_f32_16x16x32_bf16 v[184:187], v[224:227], v[140:143], v[184:187]
  ds_read_b64_tr_b16 v[216:217], v237 offset:32768
  ds_read_b64_tr_b16 v[218:219], v237 offset:36864
  v_mfma_f32_16x16x32_bf16 v[188:191], v[224:227], v[156:159], v[188:191]
  v_cmp_lt_f32 vcc, 0x41200000, v252
  s_waitcnt lgkmcnt(4)
  v_mfma_f32_16x16x32_bf16 v[180:183], v[204:207], v[128:131], v[180:183]
  ds_read_b64_tr_b16 v[220:221], v238 offset:32768
  ds_read_b64_tr_b16 v[222:223], v238 offset:36864
  v_mfma_f32_16x16x32_bf16 v[184:187], v[204:207], v[144:147], v[184:187]
  s_cbranch_vccnz L_stubA_a2_4
L_retA_a2_4:
  v_exp_f32 v168, v168
  v_mfma_f32_16x16x32_bf16 v[188:191], v[204:207], v[160:163], v[188:191]
  v_exp_f32 v169, v169
  v_mfma_f32_16x16x32_bf16 v[180:183], v[208:211], v[132:135], v[180:183]
  ds_read_b64_tr_b16 v[204:205], v239 offset:32768
  ds_read_b64_tr_b16 v[206:207], v239 offset:36864
  v_mfma_f32_16x16x32_bf16 v[184:187], v[208:211], v[148:151], v[184:187]
  v_exp_f32 v170, v170
  v_mfma_f32_16x16x32_bf16 v[188:191], v[208:211], v[164:167], v[188:191]
  v_exp_f32 v171, v171
  v_mfma_f32_16x16x32_bf16 v[96:99], v[228:231], v[192:195], v[96:99]
  v_exp_f32 v172, v172
  v_mfma_f32_16x16x32_bf16 v[100:103], v[228:231], v[196:199], v[100:103]
  v_exp_f32 v173, v173
  v_mfma_f32_16x16x32_bf16 v[104:107], v[228:231], v[200:203], v[104:107]
  v_exp_f32 v174, v174
  s_waitcnt lgkmcnt(4)
  v_mfma_f32_16x16x32_bf16 v[0:3], v[212:215], v[192:195], v[0:3]
  ds_read_b64_tr_b16 v[208:209], v240 offset:32768
  ds_read_b64_tr_b16 v[210:211], v240 offset:36864
  v_mfma_f32_16x16x32_bf16 v[32:35], v[212:215], v[196:199], v[32:35]
  v_exp_f32 v175, v175
  v_mfma_f32_16x16x32_bf16 v[64:67], v[212:215], v[200:203], v[64:67]
  v_exp_f32 v176, v176
  v_mfma_f32_16x16x32_bf16 v[4:7], v[216:219], v[192:195], v[4:7]
  ds_read_b64_tr_b16 v[212:213], v241 offset:32768
  ds_read_b64_tr_b16 v[214:215], v241 offset:36864
  v_mfma_f32_16x16x32_bf16 v[36:39], v[216:219], v[196:199], v[36:39]
  v_exp_f32 v177, v177
  v_mfma_f32_16x16x32_bf16 v[68:71], v[216:219], v[200:203], v[68:71]
  v_exp_f32 v178, v178
  s_waitcnt lgkmcnt(4)
  v_mfma_f32_16x16x32_bf16 v[8:11], v[220:223], v[192:195], v[8:11]
  v_exp_f32 v179, v179
  v_mfma_f32_16x16x32_bf16 v[40:43], v[220:223], v[196:199], v[40:43]
  ds_read_b64_tr_b16 v[216:217], v242 offset:32768
  ds_read_b64_tr_b16 v[218:219], v242 offset:36864
  v_mfma_f32_16x16x32_bf16 v[72:75], v[220:223], v[200:203], v[72:75]
  v_max3_f32 v252, v180, v181, v182
  v_max3_f32 v252, v252, v183, v184
  v_mfma_f32_16x16x32_bf16 v[12:15], v[204:207], v[192:195], v[12:15]
  ds_read_b64_tr_b16 v[220:221], v243 offset:32768
  ds_read_b64_tr_b16 v[222:223], v243 offset:36864
  v_mfma_f32_16x16x32_bf16 v[44:47], v[204:207], v[196:199], v[44:47]
  v_max3_f32 v252, v252, v185, v186
  v_max3_f32 v252, v252, v187, v188
  v_mfma_f32_16x16x32_bf16 v[76:79], v[204:207], v[200:203], v[76:79]
  v_max3_f32 v252, v252, v189, v190
  s_waitcnt lgkmcnt(4)
  v_mfma_f32_16x16x32_bf16 v[16:19], v[208:211], v[192:195], v[16:19]
  v_max_f32 v252, v252, v191
  v_cmp_lt_f32 vcc, 0x41200000, v252
  v_mfma_f32_16x16x32_bf16 v[48:51], v[208:211], v[196:199], v[48:51]
  ds_read_b128 v[204:207], v232 offset:40960
  v_mfma_f32_16x16x32_bf16 v[80:83], v[208:211], v[200:203], v[80:83]
  s_cbranch_vccnz L_stubB_a2_4
L_retB_a2_4:
  v_exp_f32 v180, v180
  v_mfma_f32_16x16x32_bf16 v[20:23], v[212:215], v[192:195], v[20:23]
  ds_read_b128 v[208:211], v233 offset:40960
  v_exp_f32 v181, v181
  v_mfma_f32_16x16x32_bf16 v[52:55], v[212:215], v[196:199], v[52:55]
  v_exp_f32 v182, v182
  v_mfma_f32_16x16x32_bf16 v[84:87], v[212:215], v[200:203], v[84:87]
  v_exp_f32 v183, v183
  s_waitcnt lgkmcnt(2)
  v_mfma_f32_16x16x32_bf16 v[24:27], v[216:219], v[192:195], v[24:27]
  ds_read_b128 v[212:215], v234 offset:40960
  v_exp_f32 v184, v184
  v_mfma_f32_16x16x32_bf16 v[56:59], v[216:219], v[196:199], v[56:59]
  v_exp_f32 v185, v185
  v_mfma_f32_16x16x32_bf16 v[88:91], v[216:219], v[200:203], v[88:91]
  v_exp_f32 v186, v186
  v_mfma_f32_16x16x32_bf16 v[28:31], v[220:223], v[192:195], v[28:31]
  v_cvt_pk_bf16_f32 v192, v168, v169
  v_cvt_pk_bf16_f32 v193, v170, v171
  v_mfma_f32_16x16x32_bf16 v[60:63], v[220:223], v[196:199], v[60:63]
  ds_read_b128 v[216:219], v235 offset:40960
  v_cvt_pk_bf16_f32 v196, v172, v173
  v_mfma_f32_16x16x32_bf16 v[92:95], v[220:223], v[200:203], v[92:95]
  v_cvt_pk_bf16_f32 v197, v174, v175
  s_waitcnt lgkmcnt(2)
  v_mfma_f32_16x16x32_bf16 v[168:171], v[204:207], v[120:123], v[108:111]
  v_cvt_pk_bf16_f32 v200, v176, v177
  v_cvt_pk_bf16_f32 v201, v178, v179
  v_mfma_f32_16x16x32_bf16 v[172:175], v[204:207], v[136:139], v[112:115]
  ds_read_b128 v[220:223], v232 offset:45056
  v_exp_f32 v187, v187
  v_mfma_f32_16x16x32_bf16 v[176:179], v[204:207], v[152:155], v[116:119]
  v_exp_f32 v188, v188
  v_mfma_f32_16x16x32_bf16 v[168:171], v[208:211], v[124:127], v[168:171]
  ds_read_b128 v[224:227], v233 offset:45056
  v_exp_f32 v189, v189
  v_mfma_f32_16x16x32_bf16 v[172:175], v[208:211], v[140:143], v[172:175]
  v_exp_f32 v190, v190
  v_mfma_f32_16x16x32_bf16 v[176:179], v[208:211], v[156:159], v[176:179]
  v_exp_f32 v191, v191
  s_waitcnt lgkmcnt(2)
  v_mfma_f32_16x16x32_bf16 v[168:171], v[212:215], v[128:131], v[168:171]
  ds_read_b128 v[204:207], v234 offset:45056
  v_cvt_pk_bf16_f32 v194, v180, v181
  v_mfma_f32_16x16x32_bf16 v[172:175], v[212:215], v[144:147], v[172:175]
  v_cvt_pk_bf16_f32 v195, v182, v183
  v_cvt_pk_bf16_f32 v198, v184, v185
  v_mfma_f32_16x16x32_bf16 v[176:179], v[212:215], v[160:163], v[176:179]
  v_cvt_pk_bf16_f32 v199, v186, v187
  v_cvt_pk_bf16_f32 v202, v188, v189
  v_mfma_f32_16x16x32_bf16 v[168:171], v[216:219], v[132:135], v[168:171]
  ds_read_b128 v[208:211], v235 offset:45056
  v_cvt_pk_bf16_f32 v203, v190, v191
  v_mfma_f32_16x16x32_bf16 v[172:175], v[216:219], v[148:151], v[172:175]
  v_mfma_f32_16x16x32_bf16 v[176:179], v[216:219], v[164:167], v[176:179]
  s_waitcnt lgkmcnt(2)
  v_mfma_f32_16x16x32_bf16 v[180:183], v[220:223], v[120:123], v[108:111]
  ds_read_b64_tr_b16 v[212:213], v236 offset:40960
  ds_read_b64_tr_b16 v[214:215], v236 offset:45056
  v_mfma_f32_16x16x32_bf16 v[184:187], v[220:223], v[136:139], v[112:115]
  v_max3_f32 v252, v168, v169, v170
  v_mfma_f32_16x16x32_bf16 v[188:191], v[220:223], v[152:155], v[116:119]
  v_max3_f32 v252, v252, v171, v172
  v_max3_f32 v252, v252, v173, v174
  v_mfma_f32_16x16x32_bf16 v[180:183], v[224:227], v[124:127], v[180:183]
  v_max3_f32 v252, v252, v175, v176
  v_max3_f32 v252, v252, v177, v178
  v_mfma_f32_16x16x32_bf16 v[184:187], v[224:227], v[140:143], v[184:187]
  v_max_f32 v252, v252, v179
  v_cmp_lt_f32 vcc, 0x41200000, v252
  v_mfma_f32_16x16x32_bf16 v[188:191], v[224:227], v[156:159], v[188:191]
  ds_read_b64_tr_b16 v[216:217], v237 offset:40960
  ds_read_b64_tr_b16 v[218:219], v237 offset:45056
  s_waitcnt lgkmcnt(4)
  v_mfma_f32_16x16x32_bf16 v[180:183], v[204:207], v[128:131], v[180:183]
  ds_read_b64_tr_b16 v[220:221], v238 offset:40960
  ds_read_b64_tr_b16 v[222:223], v238 offset:45056
  v_mfma_f32_16x16x32_bf16 v[184:187], v[204:207], v[144:147], v[184:187]
  s_cbranch_vccnz L_stubA_a2_5
L_retA_a2_5:
  v_exp_f32 v168, v168
  v_mfma_f32_16x16x32_bf16 v[188:191], v[204:207], v[160:163], v[188:191]
  v_exp_f32 v169, v169
  v_mfma_f32_16x16x32_bf16 v[180:183], v[208:211], v[132:135], v[180:183]
  ds_read_b64_tr_b16 v[204:205], v239 offset:40960
  ds_read_b64_tr_b16 v[206:207], v239 offset:45056
  v_mfma_f32_16x16x32_bf16 v[184:187], v[208:211], v[148:151], v[184:187]
  v_exp_f32 v170, v170
  v_mfma_f32_16x16x32_bf16 v[188:191], v[208:211], v[164:167], v[188:191]
  v_exp_f32 v171, v171
  v_mfma_f32_16x16x32_bf16 v[96:99], v[228:231], v[192:195], v[96:99]
  v_exp_f32 v172, v172
  v_mfma_f32_16x16x32_bf16 v[100:103], v[228:231], v[196:199], v[100:103]
  v_exp_f32 v173, v173
  v_mfma_f32_16x16x32_bf16 v[104:107], v[228:231], v[200:203], v[104:107]
  v_exp_f32 v174, v174
  s_waitcnt lgkmcnt(4)
  v_mfma_f32_16x16x32_bf16 v[0:3], v[212:215], v[192:195], v[0:3]
  ds_read_b64_tr_b16 v[208:209], v240 offset:40960
  ds_read_b64_tr_b16 v[210:211], v240 offset:45056
  v_mfma_f32_16x16x32_bf16 v[32:35], v[212:215], v[196:199], v[32:35]
  v_exp_f32 v175, v175
  v_mfma_f32_16x16x32_bf16 v[64:67], v[212:215], v[200:203], v[64:67]
  v_exp_f32 v176, v176
  v_mfma_f32_16x16x32_bf16 v[4:7], v[216:219], v[192:195], v[4:7]
  ds_read_b64_tr_b16 v[212:213], v241 offset:40960
  ds_read_b64_tr_b16 v[214:215], v241 offset:45056
  v_mfma_f32_16x16x32_bf16 v[36:39], v[216:219], v[196:199], v[36:39]
  v_exp_f32 v177, v177
  v_mfma_f32_16x16x32_bf16 v[68:71], v[216:219], v[200:203], v[68:71]
  v_exp_f32 v178, v178
  s_waitcnt lgkmcnt(4)
  v_mfma_f32_16x16x32_bf16 v[8:11], v[220:223], v[192:195], v[8:11]
  v_exp_f32 v179, v179
  v_mfma_f32_16x16x32_bf16 v[40:43], v[220:223], v[196:199], v[40:43]
  ds_read_b64_tr_b16 v[216:217], v242 offset:40960
  ds_read_b64_tr_b16 v[218:219], v242 offset:45056
  v_mfma_f32_16x16x32_bf16 v[72:75], v[220:223], v[200:203], v[72:75]
  v_max3_f32 v252, v180, v181, v182
  v_max3_f32 v252, v252, v183, v184
  v_mfma_f32_16x16x32_bf16 v[12:15], v[204:207], v[192:195], v[12:15]
  ds_read_b64_tr_b16 v[220:221], v243 offset:40960
  ds_read_b64_tr_b16 v[222:223], v243 offset:45056
  v_mfma_f32_16x16x32_bf16 v[44:47], v[204:207], v[196:199], v[44:47]
  v_max3_f32 v252, v252, v185, v186
  v_max3_f32 v252, v252, v187, v188
  v_mfma_f32_16x16x32_bf16 v[76:79], v[204:207], v[200:203], v[76:79]
  v_max3_f32 v252, v252, v189, v190
  s_waitcnt lgkmcnt(4)
  v_mfma_f32_16x16x32_bf16 v[16:19], v[208:211], v[192:195], v[16:19]
  v_max_f32 v252, v252, v191
  v_cmp_lt_f32 vcc, 0x41200000, v252
  v_mfma_f32_16x16x32_bf16 v[48:51], v[208:211], v[196:199], v[48:51]
  v_mfma_f32_16x16x32_bf16 v[80:83], v[208:211], v[200:203], v[80:83]
  s_cbranch_vccnz L_stubB_a2_5
L_retB_a2_5:
  s_waitcnt lgkmcnt(0)
  s_barrier
  v_mfma_f32_16x16x32_bf16 v[20:23], v[212:215], v[192:195], v[20:23]
  ds_read_b128 v[204:207], v232 offset:49152
  ds_read_b128 v[208:211], v233 offset:49152
  v_mfma_f32_16x16x32_bf16 v[52:55], v[212:215], v[196:199], v[52:55]
  v_exp_f32 v180, v180
  v_mfma_f32_16x16x32_bf16 v[84:87], v[212:215], v[200:203], v[84:87]
  v_exp_f32 v181, v181
  v_mfma_f32_16x16x32_bf16 v[24:27], v[216:219], v[192:195], v[24:27]
  ds_read_b128 v[212:215], v234 offset:49152
  v_exp_f32 v182, v182
  v_mfma_f32_16x16x32_bf16 v[56:59], v[216:219], v[196:199], v[56:59]
  v_exp_f32 v183, v183
  v_mfma_f32_16x16x32_bf16 v[88:91], v[216:219], v[200:203], v[88:91]
  v_exp_f32 v184, v184
  v_mfma_f32_16x16x32_bf16 v[28:31], v[220:223], v[192:195], v[28:31]
  v_cvt_pk_bf16_f32 v192, v168, v169
  v_cvt_pk_bf16_f32 v193, v170, v171
  v_mfma_f32_16x16x32_bf16 v[60:63], v[220:223], v[196:199], v[60:63]
  ds_read_b128 v[216:219], v235 offset:49152
  v_cvt_pk_bf16_f32 v196, v172, v173
  v_mfma_f32_16x16x32_bf16 v[92:95], v[220:223], v[200:203], v[92:95]
  v_cvt_pk_bf16_f32 v197, v174, v175
  s_waitcnt lgkmcnt(2)
  v_mfma_f32_16x16x32_bf16 v[168:171], v[204:207], v[120:123], v[108:111]
  v_cvt_pk_bf16_f32 v200, v176, v177
  v_cvt_pk_bf16_f32 v201, v178, v179
  v_mfma_f32_16x16x32_bf16 v[172:175], v[204:207], v[136:139], v[112:115]
  ds_read_b128 v[220:223], v232 offset:53248
  v_exp_f32 v185, v185
  v_mfma_f32_16x16x32_bf16 v[176:179], v[204:207], v[152:155], v[116:119]
  v_exp_f32 v186, v186
  v_mfma_f32_16x16x32_bf16 v[168:171], v[208:211], v[124:127], v[168:171]
  ds_read_b128 v[224:227], v233 offset:53248
  v_exp_f32 v187, v187
  v_mfma_f32_16x16x32_bf16 v[172:175], v[208:211], v[140:143], v[172:175]
  v_exp_f32 v188, v188
  v_mfma_f32_16x16x32_bf16 v[176:179], v[208:211], v[156:159], v[176:179]
  v_exp_f32 v189, v189
  s_waitcnt lgkmcnt(2)
  v_mfma_f32_16x16x32_bf16 v[168:171], v[212:215], v[128:131], v[168:171]
  ds_read_b128 v[204:207], v234 offset:53248
  v_exp_f32 v190, v190
  v_mfma_f32_16x16x32_bf16 v[172:175], v[212:215], v[144:147], v[172:175]
  v_exp_f32 v191, v191
  v_mfma_f32_16x16x32_bf16 v[176:179], v[212:215], v[160:163], v[176:179]
  v_cvt_pk_bf16_f32 v194, v180, v181
  v_cvt_pk_bf16_f32 v195, v182, v183
  v_mfma_f32_16x16x32_bf16 v[168:171], v[216:219], v[132:135], v[168:171]
  ds_read_b128 v[208:211], v235 offset:53248
  v_cvt_pk_bf16_f32 v198, v184, v185
  v_mfma_f32_16x16x32_bf16 v[172:175], v[216:219], v[148:151], v[172:175]
  v_cvt_pk_bf16_f32 v199, v186, v187
  v_cvt_pk_bf16_f32 v202, v188, v189
  v_mfma_f32_16x16x32_bf16 v[176:179], v[216:219], v[164:167], v[176:179]
  v_cvt_pk_bf16_f32 v203, v190, v191
  s_waitcnt lgkmcnt(2)
  v_mfma_f32_16x16x32_bf16 v[180:183], v[220:223], v[120:123], v[108:111]
  ds_read_b64_tr_b16 v[212:213], v236 offset:49152
  ds_read_b64_tr_b16 v[214:215], v236 offset:53248
  v_mfma_f32_16x16x32_bf16 v[184:187], v[220:223], v[136:139], v[112:115]
  v_max3_f32 v252, v168, v169, v170
  v_max3_f32 v252, v252, v171, v172
  v_mfma_f32_16x16x32_bf16 v[188:191], v[220:223], v[152:155], v[116:119]
  v_max3_f32 v252, v252, v173, v174
  v_max3_f32 v252, v252, v175, v176
  v_mfma_f32_16x16x32_bf16 v[180:183], v[224:227], v[124:127], v[180:183]
  v_max3_f32 v252, v252, v177, v178
  v_max_f32 v252, v252, v179
  v_mfma_f32_16x16x32_bf16 v[184:187], v[224:227], v[140:143], v[184:187]
  ds_read_b64_tr_b16 v[216:217], v237 offset:49152
  ds_read_b64_tr_b16 v[218:219], v237 offset:53248
  v_mfma_f32_16x16x32_bf16 v[188:191], v[224:227], v[156:159], v[188:191]
  v_cmp_lt_f32 vcc, 0x41200000, v252
  s_waitcnt lgkmcnt(4)
  v_mfma_f32_16x16x32_bf16 v[180:183], v[204:207], v[128:131], v[180:183]
  ds_read_b64_tr_b16 v[220:221], v238 offset:49152
  ds_read_b64_tr_b16 v[222:223], v238 offset:53248
  v_mfma_f32_16x16x32_bf16 v[184:187], v[204:207], v[144:147], v[184:187]
  s_cbranch_vccnz L_stubA_a3_6
L_retA_a3_6:
  v_exp_f32 v168, v168
  v_mfma_f32_16x16x32_bf16 v[188:191], v[204:207], v[160:163], v[188:191]
  v_exp_f32 v169, v169
  v_mfma_f32_16x16x32_bf16 v[180:183], v[208:211], v[132:135], v[180:183]
  ds_read_b64_tr_b16 v[204:205], v239 offset:49152
  ds_read_b64_tr_b16 v[206:207], v239 offset:53248
  v_mfma_f32_16x16x32_bf16 v[184:187], v[208:211], v[148:151], v[184:187]
  v_exp_f32 v170, v170
  v_mfma_f32_16x16x32_bf16 v[188:191], v[208:211], v[164:167], v[188:191]
  v_exp_f32 v171, v171
  v_mfma_f32_16x16x32_bf16 v[96:99], v[228:231], v[192:195], v[96:99]
  v_exp_f32 v172, v172
  v_mfma_f32_16x16x32_bf16 v[100:103], v[228:231], v[196:199], v[100:103]
  v_exp_f32 v173, v173
  v_mfma_f32_16x16x32_bf16 v[104:107], v[228:231], v[200:203], v[104:107]
  v_exp_f32 v174, v174
  s_waitcnt lgkmcnt(4)
  v_mfma_f32_16x16x32_bf16 v[0:3], v[212:215], v[192:195], v[0:3]
  ds_read_b64_tr_b16 v[208:209], v240 offset:49152
  ds_read_b64_tr_b16 v[210:211], v240 offset:53248
  v_mfma_f32_16x16x32_bf16 v[32:35], v[212:215], v[196:199], v[32:35]
  v_exp_f32 v175, v175
  v_mfma_f32_16x16x32_bf16 v[64:67], v[212:215], v[200:203], v[64:67]
  v_exp_f32 v176, v176
  v_mfma_f32_16x16x32_bf16 v[4:7], v[216:219], v[192:195], v[4:7]
  ds_read_b64_tr_b16 v[212:213], v241 offset:49152
  ds_read_b64_tr_b16 v[214:215], v241 offset:53248
  v_mfma_f32_16x16x32_bf16 v[36:39], v[216:219], v[196:199], v[36:39]
  v_exp_f32 v177, v177
  v_mfma_f32_16x16x32_bf16 v[68:71], v[216:219], v[200:203], v[68:71]
  v_exp_f32 v178, v178
  s_waitcnt lgkmcnt(4)
  v_mfma_f32_16x16x32_bf16 v[8:11], v[220:223], v[192:195], v[8:11]
  v_exp_f32 v179, v179
  v_mfma_f32_16x16x32_bf16 v[40:43], v[220:223], v[196:199], v[40:43]
  ds_read_b64_tr_b16 v[216:217], v242 offset:49152
  ds_read_b64_tr_b16 v[218:219], v242 offset:53248
  v_mfma_f32_16x16x32_bf16 v[72:75], v[220:223], v[200:203], v[72:75]
  v_max3_f32 v252, v180, v181, v182
  v_max3_f32 v252, v252, v183, v184
  v_mfma_f32_16x16x32_bf16 v[12:15], v[204:207], v[192:195], v[12:15]
  ds_read_b64_tr_b16 v[220:221], v243 offset:49152
  ds_read_b64_tr_b16 v[222:223], v243 offset:53248
  v_mfma_f32_16x16x32_bf16 v[44:47], v[204:207], v[196:199], v[44:47]
  v_max3_f32 v252, v252, v185, v186
  v_max3_f32 v252, v252, v187, v188
  v_mfma_f32_16x16x32_bf16 v[76:79], v[204:207], v[200:203], v[76:79]
  v_max3_f32 v252, v252, v189, v190
  s_waitcnt lgkmcnt(4)
  v_mfma_f32_16x16x32_bf16 v[16:19], v[208:211], v[192:195], v[16:19]
  v_max_f32 v252, v252, v191
  v_cmp_lt_f32 vcc, 0x41200000, v252
  v_mfma_f32_16x16x32_bf16 v[48:51], v[208:211], v[196:199], v[48:51]
  ds_read_b128 v[204:207], v232 offset:57344
  v_mfma_f32_16x16x32_bf16 v[80:83], v[208:211], v[200:203], v[80:83]
  s_cbranch_vccnz L_stubB_a3_6
L_retB_a3_6:
  v_exp_f32 v180, v180
  v_mfma_f32_16x16x32_bf16 v[20:23], v[212:215], v[192:195], v[20:23]
  ds_read_b128 v[208:211], v233 offset:57344
  v_exp_f32 v181, v181
  v_mfma_f32_16x16x32_bf16 v[52:55], v[212:215], v[196:199], v[52:55]
  v_exp_f32 v182, v182
  v_mfma_f32_16x16x32_bf16 v[84:87], v[212:215], v[200:203], v[84:87]
  v_exp_f32 v183, v183
  s_waitcnt lgkmcnt(2)
  v_mfma_f32_16x16x32_bf16 v[24:27], v[216:219], v[192:195], v[24:27]
  ds_read_b128 v[212:215], v234 offset:57344
  v_exp_f32 v184, v184
  v_mfma_f32_16x16x32_bf16 v[56:59], v[216:219], v[196:199], v[56:59]
  v_exp_f32 v185, v185
  v_mfma_f32_16x16x32_bf16 v[88:91], v[216:219], v[200:203], v[88:91]
  v_exp_f32 v186, v186
  v_mfma_f32_16x16x32_bf16 v[28:31], v[220:223], v[192:195], v[28:31]
  v_cvt_pk_bf16_f32 v192, v168, v169
  v_cvt_pk_bf16_f32 v193, v170, v171
  v_mfma_f32_16x16x32_bf16 v[60:63], v[220:223], v[196:199], v[60:63]
  ds_read_b128 v[216:219], v235 offset:57344
  v_cvt_pk_bf16_f32 v196, v172, v173
  v_mfma_f32_16x16x32_bf16 v[92:95], v[220:223], v[200:203], v[92:95]
  v_cvt_pk_bf16_f32 v197, v174, v175
  s_waitcnt lgkmcnt(2)
  v_mfma_f32_16x16x32_bf16 v[168:171], v[204:207], v[120:123], v[108:111]
  v_cvt_pk_bf16_f32 v200, v176, v177
  v_cvt_pk_bf16_f32 v201, v178, v179
  v_mfma_f32_16x16x32_bf16 v[172:175], v[204:207], v[136:139], v[112:115]
  ds_read_b128 v[220:223], v232 offset:61440
  v_exp_f32 v187, v187
  v_mfma_f32_16x16x32_bf16 v[176:179], v[204:207], v[152:155], v[116:119]
  v_exp_f32 v188, v188
  v_mfma_f32_16x16x32_bf16 v[168:171], v[208:211], v[124:127], v[168:171]
  ds_read_b128 v[224:227], v233 offset:61440
  v_exp_f32 v189, v189
  v_mfma_f32_16x16x32_bf16 v[172:175], v[208:211], v[140:143], v[172:175]
  v_exp_f32 v190, v190
  v_mfma_f32_16x16x32_bf16 v[176:179], v[208:211], v[156:159], v[176:179]
  v_exp_f32 v191, v191
  s_waitcnt lgkmcnt(2)
  v_mfma_f32_16x16x32_bf16 v[168:171], v[212:215], v[128:131], v[168:171]
  ds_read_b128 v[204:207], v234 offset:61440
  v_cvt_pk_bf16_f32 v194, v180, v181
  v_mfma_f32_16x16x32_bf16 v[172:175], v[212:215], v[144:147], v[172:175]
  v_cvt_pk_bf16_f32 v195, v182, v183
  v_cvt_pk_bf16_f32 v198, v184, v185
  v_mfma_f32_16x16x32_bf16 v[176:179], v[212:215], v[160:163], v[176:179]
  v_cvt_pk_bf16_f32 v199, v186, v187
  v_cvt_pk_bf16_f32 v202, v188, v189
  v_mfma_f32_16x16x32_bf16 v[168:171], v[216:219], v[132:135], v[168:171]
  ds_read_b128 v[208:211], v235 offset:61440
  v_cvt_pk_bf16_f32 v203, v190, v191
  v_mfma_f32_16x16x32_bf16 v[172:175], v[216:219], v[148:151], v[172:175]
  v_mfma_f32_16x16x32_bf16 v[176:179], v[216:219], v[164:167], v[176:179]
  s_waitcnt lgkmcnt(2)
  v_mfma_f32_16x16x32_bf16 v[180:183], v[220:223], v[120:123], v[108:111]
  ds_read_b64_tr_b16 v[212:213], v236 offset:57344
  ds_read_b64_tr_b16 v[214:215], v236 offset:61440
  v_mfma_f32_16x16x32_bf16 v[184:187], v[220:223], v[136:139], v[112:115]
  v_max3_f32 v252, v168, v169, v170
  v_mfma_f32_16x16x32_bf16 v[188:191], v[220:223], v[152:155], v[116:119]
  v_max3_f32 v252, v252, v171, v172
  v_max3_f32 v252, v252, v173, v174
  v_mfma_f32_16x16x32_bf16 v[180:183], v[224:227], v[124:127], v[180:183]
  v_max3_f32 v252, v252, v175, v176
  v_max3_f32 v252, v252, v177, v178
  v_mfma_f32_16x16x32_bf16 v[184:187], v[224:227], v[140:143], v[184:187]
  v_max_f32 v252, v252, v179
  v_cmp_lt_f32 vcc, 0x41200000, v252
  v_mfma_f32_16x16x32_bf16 v[188:191], v[224:227], v[156:159], v[188:191]
  ds_read_b64_tr_b16 v[216:217], v237 offset:57344
  ds_read_b64_tr_b16 v[218:219], v237 offset:61440
  s_waitcnt lgkmcnt(4)
  v_mfma_f32_16x16x32_bf16 v[180:183], v[204:207], v[128:131], v[180:183]
  ds_read_b64_tr_b16 v[220:221], v238 offset:57344
  ds_read_b64_tr_b16 v[222:223], v238 offset:61440
  v_mfma_f32_16x16x32_bf16 v[184:187], v[204:207], v[144:147], v[184:187]
  s_cbranch_vccnz L_stubA_a3_7
L_retA_a3_7:
  v_exp_f32 v168, v168
  v_mfma_f32_16x16x32_bf16 v[188:191], v[204:207], v[160:163], v[188:191]
  v_exp_f32 v169, v169
  v_mfma_f32_16x16x32_bf16 v[180:183], v[208:211], v[132:135], v[180:183]
  ds_read_b64_tr_b16 v[204:205], v239 offset:57344
  ds_read_b64_tr_b16 v[206:207], v239 offset:61440
  v_mfma_f32_16x16x32_bf16 v[184:187], v[208:211], v[148:151], v[184:187]
  v_exp_f32 v170, v170
  v_mfma_f32_16x16x32_bf16 v[188:191], v[208:211], v[164:167], v[188:191]
  v_exp_f32 v171, v171
  v_mfma_f32_16x16x32_bf16 v[96:99], v[228:231], v[192:195], v[96:99]
  v_exp_f32 v172, v172
  v_mfma_f32_16x16x32_bf16 v[100:103], v[228:231], v[196:199], v[100:103]
  v_exp_f32 v173, v173
  v_mfma_f32_16x16x32_bf16 v[104:107], v[228:231], v[200:203], v[104:107]
  v_exp_f32 v174, v174
  s_waitcnt lgkmcnt(4)
  v_mfma_f32_16x16x32_bf16 v[0:3], v[212:215], v[192:195], v[0:3]
  ds_read_b64_tr_b16 v[208:209], v240 offset:57344
  ds_read_b64_tr_b16 v[210:211], v240 offset:61440
  v_mfma_f32_16x16x32_bf16 v[32:35], v[212:215], v[196:199], v[32:35]
  v_exp_f32 v175, v175
  v_mfma_f32_16x16x32_bf16 v[64:67], v[212:215], v[200:203], v[64:67]
  v_exp_f32 v176, v176
  v_mfma_f32_16x16x32_bf16 v[4:7], v[216:219], v[192:195], v[4:7]
  ds_read_b64_tr_b16 v[212:213], v241 offset:57344
  ds_read_b64_tr_b16 v[214:215], v241 offset:61440
  v_mfma_f32_16x16x32_bf16 v[36:39], v[216:219], v[196:199], v[36:39]
  v_exp_f32 v177, v177
  v_mfma_f32_16x16x32_bf16 v[68:71], v[216:219], v[200:203], v[68:71]
  v_exp_f32 v178, v178
  s_waitcnt lgkmcnt(4)
  v_mfma_f32_16x16x32_bf16 v[8:11], v[220:223], v[192:195], v[8:11]
  v_exp_f32 v179, v179
  v_mfma_f32_16x16x32_bf16 v[40:43], v[220:223], v[196:199], v[40:43]
  ds_read_b64_tr_b16 v[216:217], v242 offset:57344
  ds_read_b64_tr_b16 v[218:219], v242 offset:61440
  v_mfma_f32_16x16x32_bf16 v[72:75], v[220:223], v[200:203], v[72:75]
  v_max3_f32 v252, v180, v181, v182
  v_max3_f32 v252, v252, v183, v184
  v_mfma_f32_16x16x32_bf16 v[12:15], v[204:207], v[192:195], v[12:15]
  ds_read_b64_tr_b16 v[220:221], v243 offset:57344
  ds_read_b64_tr_b16 v[222:223], v243 offset:61440
  v_mfma_f32_16x16x32_bf16 v[44:47], v[204:207], v[196:199], v[44:47]
  v_max3_f32 v252, v252, v185, v186
  v_max3_f32 v252, v252, v187, v188
  v_mfma_f32_16x16x32_bf16 v[76:79], v[204:207], v[200:203], v[76:79]
  v_max3_f32 v252, v252, v189, v190
  s_waitcnt lgkmcnt(4)
  v_mfma_f32_16x16x32_bf16 v[16:19], v[208:211], v[192:195], v[16:19]
  v_max_f32 v252, v252, v191
  v_cmp_lt_f32 vcc, 0x41200000, v252
  v_mfma_f32_16x16x32_bf16 v[48:51], v[208:211], v[196:199], v[48:51]
  v_mfma_f32_16x16x32_bf16 v[80:83], v[208:211], v[200:203], v[80:83]
  s_cbranch_vccnz L_stubB_a3_7
L_retB_a3_7:
  s_waitcnt lgkmcnt(0)
  s_cmp_eq_u32 s34, 3
  s_cbranch_scc1 L_afin
  s_add_u32 s34, s34, 1
  s_barrier
  v_mfma_f32_16x16x32_bf16 v[20:23], v[212:215], v[192:195], v[20:23]
  ds_read_b128 v[204:207], v232 offset:0
  ds_read_b128 v[208:211], v233 offset:0
  v_mfma_f32_16x16x32_bf16 v[52:55], v[212:215], v[196:199], v[52:55]
  v_exp_f32 v180, v180
  v_mfma_f32_16x16x32_bf16 v[84:87], v[212:215], v[200:203], v[84:87]
  v_exp_f32 v181, v181
  v_mfma_f32_16x16x32_bf16 v[24:27], v[216:219], v[192:195], v[24:27]
  ds_read_b128 v[212:215], v234 offset:0
  v_exp_f32 v182, v182
  v_mfma_f32_16x16x32_bf16 v[56:59], v[216:219], v[196:199], v[56:59]
  v_exp_f32 v183, v183
  v_mfma_f32_16x16x32_bf16 v[88:91], v[216:219], v[200:203], v[88:91]
  v_exp_f32 v184, v184
  v_mfma_f32_16x16x32_bf16 v[28:31], v[220:223], v[192:195], v[28:31]
  v_cvt_pk_bf16_f32 v192, v168, v169
  v_cvt_pk_bf16_f32 v193, v170, v171
  v_mfma_f32_16x16x32_bf16 v[60:63], v[220:223], v[196:199], v[60:63]
  ds_read_b128 v[216:219], v235 offset:0
  v_cvt_pk_bf16_f32 v196, v172, v173
  v_mfma_f32_16x16x32_bf16 v[92:95], v[220:223], v[200:203], v[92:95]
  v_cvt_pk_bf16_f32 v197, v174, v175
  s_waitcnt lgkmcnt(2)
  v_mfma_f32_16x16x32_bf16 v[168:171], v[204:207], v[120:123], v[108:111]
  v_cvt_pk_bf16_f32 v200, v176, v177
  v_cvt_pk_bf16_f32 v201, v178, v179
  v_mfma_f32_16x16x32_bf16 v[172:175], v[204:207], v[136:139], v[112:115]
  ds_read_b128 v[220:223], v232 offset:4096
  v_exp_f32 v185, v185
  v_mfma_f32_16x16x32_bf16 v[176:179], v[204:207], v[152:155], v[116:119]
  v_exp_f32 v186, v186
  v_mfma_f32_16x16x32_bf16 v[168:171], v[208:211], v[124:127], v[168:171]
  ds_read_b128 v[224:227], v233 offset:4096
  v_exp_f32 v187, v187
  v_mfma_f32_16x16x32_bf16 v[172:175], v[208:211], v[140:143], v[172:175]
  v_exp_f32 v188, v188
  v_mfma_f32_16x16x32_bf16 v[176:179], v[208:211], v[156:159], v[176:179]
  v_exp_f32 v189, v189
  s_waitcnt lgkmcnt(2)
  v_mfma_f32_16x16x32_bf16 v[168:171], v[212:215], v[128:131], v[168:171]
  ds_read_b128 v[204:207], v234 offset:4096
  v_exp_f32 v190, v190
  v_mfma_f32_16x16x32_bf16 v[172:175], v[212:215], v[144:147], v[172:175]
  v_exp_f32 v191, v191
  v_mfma_f32_16x16x32_bf16 v[176:179], v[212:215], v[160:163], v[176:179]
  v_cvt_pk_bf16_f32 v194, v180, v181
  v_cvt_pk_bf16_f32 v195, v182, v183
  v_mfma_f32_16x16x32_bf16 v[168:171], v[216:219], v[132:135], v[168:171]
  ds_read_b128 v[208:211], v235 offset:4096
  v_cvt_pk_bf16_f32 v198, v184, v185
  v_mfma_f32_16x16x32_bf16 v[172:175], v[216:219], v[148:151], v[172:175]
  v_cvt_pk_bf16_f32 v199, v186, v187
  v_cvt_pk_bf16_f32 v202, v188, v189
  v_mfma_f32_16x16x32_bf16 v[176:179], v[216:219], v[164:167], v[176:179]
  v_cvt_pk_bf16_f32 v203, v190, v191
  s_waitcnt lgkmcnt(2)
  v_mfma_f32_16x16x32_bf16 v[180:183], v[220:223], v[120:123], v[108:111]
  ds_read_b64_tr_b16 v[212:213], v236 offset:0
  ds_read_b64_tr_b16 v[214:215], v236 offset:4096
  v_mfma_f32_16x16x32_bf16 v[184:187], v[220:223], v[136:139], v[112:115]
  v_max3_f32 v252, v168, v169, v170
  v_max3_f32 v252, v252, v171, v172
  v_mfma_f32_16x16x32_bf16 v[188:191], v[220:223], v[152:155], v[116:119]
  v_max3_f32 v252, v252, v173, v174
  v_max3_f32 v252, v252, v175, v176
  v_mfma_f32_16x16x32_bf16 v[180:183], v[224:227], v[124:127], v[180:183]
  v_max3_f32 v252, v252, v177, v178
  v_max_f32 v252, v252, v179
  v_mfma_f32_16x16x32_bf16 v[184:187], v[224:227], v[140:143], v[184:187]
  ds_read_b64_tr_b16 v[216:217], v237 offset:0
  ds_read_b64_tr_b16 v[218:219], v237 offset:4096
  v_mfma_f32_16x16x32_bf16 v[188:191], v[224:227], v[156:159], v[188:191]
  v_cmp_lt_f32 vcc, 0x41200000, v252
  s_waitcnt lgkmcnt(4)
  v_mfma_f32_16x16x32_bf16 v[180:183], v[204:207], v[128:131], v[180:183]
  ds_read_b64_tr_b16 v[220:221], v238 offset:0
  ds_read_b64_tr_b16 v[222:223], v238 offset:4096
  v_mfma_f32_16x16x32_bf16 v[184:187], v[204:207], v[144:147], v[184:187]
  s_cbranch_vccnz L_stubA_a4_0
L_retA_a4_0:
  v_exp_f32 v168, v168
  v_mfma_f32_16x16x32_bf16 v[188:191], v[204:207], v[160:163], v[188:191]
  v_exp_f32 v169, v169
  v_mfma_f32_16x16x32_bf16 v[180:183], v[208:211], v[132:135], v[180:183]
  ds_read_b64_tr_b16 v[204:205], v239 offset:0
  ds_read_b64_tr_b16 v[206:207], v239 offset:4096
  v_mfma_f32_16x16x32_bf16 v[184:187], v[208:211], v[148:151], v[184:187]
  v_exp_f32 v170, v170
  v_mfma_f32_16x16x32_bf16 v[188:191], v[208:211], v[164:167], v[188:191]
  v_exp_f32 v171, v171
  v_mfma_f32_16x16x32_bf16 v[96:99], v[228:231], v[192:195], v[96:99]
  v_exp_f32 v172, v172
  v_mfma_f32_16x16x32_bf16 v[100:103], v[228:231], v[196:199], v[100:103]
  v_exp_f32 v173, v173
  v_mfma_f32_16x16x32_bf16 v[104:107], v[228:231], v[200:203], v[104:107]
  v_exp_f32 v174, v174
  s_waitcnt lgkmcnt(4)
  v_mfma_f32_16x16x32_bf16 v[0:3], v[212:215], v[192:195], v[0:3]
  ds_read_b64_tr_b16 v[208:209], v240 offset:0
  ds_read_b64_tr_b16 v[210:211], v240 offset:4096
  v_mfma_f32_16x16x32_bf16 v[32:35], v[212:215], v[196:199], v[32:35]
  v_exp_f32 v175, v175
  v_mfma_f32_16x16x32_bf16 v[64:67], v[212:215], v[200:203], v[64:67]
  v_exp_f32 v176, v176
  v_mfma_f32_16x16x32_bf16 v[4:7], v[216:219], v[192:195], v[4:7]
  ds_read_b64_tr_b16 v[212:213], v241 offset:0
  ds_read_b64_tr_b16 v[214:215], v241 offset:4096
  v_mfma_f32_16x16x32_bf16 v[36:39], v[216:219], v[196:199], v[36:39]
  v_exp_f32 v177, v177
  v_mfma_f32_16x16x32_bf16 v[68:71], v[216:219], v[200:203], v[68:71]
  v_exp_f32 v178, v178
  s_waitcnt lgkmcnt(4)
  v_mfma_f32_16x16x32_bf16 v[8:11], v[220:223], v[192:195], v[8:11]
  v_exp_f32 v179, v179
  v_mfma_f32_16x16x32_bf16 v[40:43], v[220:223], v[196:199], v[40:43]
  ds_read_b64_tr_b16 v[216:217], v242 offset:0
  ds_read_b64_tr_b16 v[218:219], v242 offset:4096
  v_mfma_f32_16x16x32_bf16 v[72:75], v[220:223], v[200:203], v[72:75]
  v_max3_f32 v252, v180, v181, v182
  v_max3_f32 v252, v252, v183, v184
  v_mfma_f32_16x16x32_bf16 v[12:15], v[204:207], v[192:195], v[12:15]
  ds_read_b64_tr_b16 v[220:221], v243 offset:0
  ds_read_b64_tr_b16 v[222:223], v243 offset:4096
  v_mfma_f32_16x16x32_bf16 v[44:47], v[204:207], v[196:199], v[44:47]
  v_max3_f32 v252, v252, v185, v186
  v_max3_f32 v252, v252, v187, v188
  v_mfma_f32_16x16x32_bf16 v[76:79], v[204:207], v[200:203], v[76:79]
  v_max3_f32 v252, v252, v189, v190
  s_waitcnt lgkmcnt(4)
  v_mfma_f32_16x16x32_bf16 v[16:19], v[208:211], v[192:195], v[16:19]
  v_max_f32 v252, v252, v191
  v_cmp_lt_f32 vcc, 0x41200000, v252
  v_mfma_f32_16x16x32_bf16 v[48:51], v[208:211], v[196:199], v[48:51]
  ds_read_b128 v[204:207], v232 offset:8192
  v_mfma_f32_16x16x32_bf16 v[80:83], v[208:211], v[200:203], v[80:83]
  s_cbranch_vccnz L_stubB_a4_0
L_retB_a4_0:
  v_exp_f32 v180, v180
  v_mfma_f32_16x16x32_bf16 v[20:23], v[212:215], v[192:195], v[20:23]
  ds_read_b128 v[208:211], v233 offset:8192
  v_exp_f32 v181, v181
  v_mfma_f32_16x16x32_bf16 v[52:55], v[212:215], v[196:199], v[52:55]
  v_exp_f32 v182, v182
  v_mfma_f32_16x16x32_bf16 v[84:87], v[212:215], v[200:203], v[84:87]
  v_exp_f32 v183, v183
  s_waitcnt lgkmcnt(2)
  v_mfma_f32_16x16x32_bf16 v[24:27], v[216:219], v[192:195], v[24:27]
  ds_read_b128 v[212:215], v234 offset:8192
  v_exp_f32 v184, v184
  v_mfma_f32_16x16x32_bf16 v[56:59], v[216:219], v[196:199], v[56:59]
  v_exp_f32 v185, v185
  v_mfma_f32_16x16x32_bf16 v[88:91], v[216:219], v[200:203], v[88:91]
  v_exp_f32 v186, v186
  v_mfma_f32_16x16x32_bf16 v[28:31], v[220:223], v[192:195], v[28:31]
  v_cvt_pk_bf16_f32 v192, v168, v169
  v_cvt_pk_bf16_f32 v193, v170, v171
  v_mfma_f32_16x16x32_bf16 v[60:63], v[220:223], v[196:199], v[60:63]
  ds_read_b128 v[216:219], v235 offset:8192
  v_cvt_pk_bf16_f32 v196, v172, v173
  v_mfma_f32_16x16x32_bf16 v[92:95], v[220:223], v[200:203], v[92:95]
  v_cvt_pk_bf16_f32 v197, v174, v175
  s_waitcnt lgkmcnt(2)
  v_mfma_f32_16x16x32_bf16 v[168:171], v[204:207], v[120:123], v[108:111]
  v_cvt_pk_bf16_f32 v200, v176, v177
  v_cvt_pk_bf16_f32 v201, v178, v179
  v_mfma_f32_16x16x32_bf16 v[172:175], v[204:207], v[136:139], v[112:115]
  ds_read_b128 v[220:223], v232 offset:12288
  v_exp_f32 v187, v187
  v_mfma_f32_16x16x32_bf16 v[176:179], v[204:207], v[152:155], v[116:119]
  v_exp_f32 v188, v188
  v_mfma_f32_16x16x32_bf16 v[168:171], v[208:211], v[124:127], v[168:171]
  ds_read_b128 v[224:227], v233 offset:12288
  v_exp_f32 v189, v189
  v_mfma_f32_16x16x32_bf16 v[172:175], v[208:211], v[140:143], v[172:175]
  v_exp_f32 v190, v190
  v_mfma_f32_16x16x32_bf16 v[176:179], v[208:211], v[156:159], v[176:179]
  v_exp_f32 v191, v191
  s_waitcnt lgkmcnt(2)
  v_mfma_f32_16x16x32_bf16 v[168:171], v[212:215], v[128:131], v[168:171]
  ds_read_b128 v[204:207], v234 offset:12288
  v_cvt_pk_bf16_f32 v194, v180, v181
  v_mfma_f32_16x16x32_bf16 v[172:175], v[212:215], v[144:147], v[172:175]
  v_cvt_pk_bf16_f32 v195, v182, v183
  v_cvt_pk_bf16_f32 v198, v184, v185
  v_mfma_f32_16x16x32_bf16 v[176:179], v[212:215], v[160:163], v[176:179]
  v_cvt_pk_bf16_f32 v199, v186, v187
  v_cvt_pk_bf16_f32 v202, v188, v189
  v_mfma_f32_16x16x32_bf16 v[168:171], v[216:219], v[132:135], v[168:171]
  ds_read_b128 v[208:211], v235 offset:12288
  v_cvt_pk_bf16_f32 v203, v190, v191
  v_mfma_f32_16x16x32_bf16 v[172:175], v[216:219], v[148:151], v[172:175]
  v_mfma_f32_16x16x32_bf16 v[176:179], v[216:219], v[164:167], v[176:179]
  s_waitcnt lgkmcnt(2)
  v_mfma_f32_16x16x32_bf16 v[180:183], v[220:223], v[120:123], v[108:111]
  ds_read_b64_tr_b16 v[212:213], v236 offset:8192
  ds_read_b64_tr_b16 v[214:215], v236 offset:12288
  v_mfma_f32_16x16x32_bf16 v[184:187], v[220:223], v[136:139], v[112:115]
  v_max3_f32 v252, v168, v169, v170
  v_mfma_f32_16x16x32_bf16 v[188:191], v[220:223], v[152:155], v[116:119]
  v_max3_f32 v252, v252, v171, v172
  v_max3_f32 v252, v252, v173, v174
  v_mfma_f32_16x16x32_bf16 v[180:183], v[224:227], v[124:127], v[180:183]
  v_max3_f32 v252, v252, v175, v176
  v_max3_f32 v252, v252, v177, v178
  v_mfma_f32_16x16x32_bf16 v[184:187], v[224:227], v[140:143], v[184:187]
  v_max_f32 v252, v252, v179
  v_cmp_lt_f32 vcc, 0x41200000, v252
  v_mfma_f32_16x16x32_bf16 v[188:191], v[224:227], v[156:159], v[188:191]
  ds_read_b64_tr_b16 v[216:217], v237 offset:8192
  ds_read_b64_tr_b16 v[218:219], v237 offset:12288
  s_waitcnt lgkmcnt(4)
  v_mfma_f32_16x16x32_bf16 v[180:183], v[204:207], v[128:131], v[180:183]
  ds_read_b64_tr_b16 v[220:221], v238 offset:8192
  ds_read_b64_tr_b16 v[222:223], v238 offset:12288
  v_mfma_f32_16x16x32_bf16 v[184:187], v[204:207], v[144:147], v[184:187]
  s_cbranch_vccnz L_stubA_a4_1
L_retA_a4_1:
  v_exp_f32 v168, v168
  v_mfma_f32_16x16x32_bf16 v[188:191], v[204:207], v[160:163], v[188:191]
  v_exp_f32 v169, v169
  v_mfma_f32_16x16x32_bf16 v[180:183], v[208:211], v[132:135], v[180:183]
  ds_read_b64_tr_b16 v[204:205], v239 offset:8192
  ds_read_b64_tr_b16 v[206:207], v239 offset:12288
  v_mfma_f32_16x16x32_bf16 v[184:187], v[208:211], v[148:151], v[184:187]
  v_exp_f32 v170, v170
  v_mfma_f32_16x16x32_bf16 v[188:191], v[208:211], v[164:167], v[188:191]
  v_exp_f32 v171, v171
  v_mfma_f32_16x16x32_bf16 v[96:99], v[228:231], v[192:195], v[96:99]
  v_exp_f32 v172, v172
  v_mfma_f32_16x16x32_bf16 v[100:103], v[228:231], v[196:199], v[100:103]
  v_exp_f32 v173, v173
  v_mfma_f32_16x16x32_bf16 v[104:107], v[228:231], v[200:203], v[104:107]
  v_exp_f32 v174, v174
  s_waitcnt lgkmcnt(4)
  v_mfma_f32_16x16x32_bf16 v[0:3], v[212:215], v[192:195], v[0:3]
  ds_read_b64_tr_b16 v[208:209], v240 offset:8192
  ds_read_b64_tr_b16 v[210:211], v240 offset:12288
  v_mfma_f32_16x16x32_bf16 v[32:35], v[212:215], v[196:199], v[32:35]
  v_exp_f32 v175, v175
  v_mfma_f32_16x16x32_bf16 v[64:67], v[212:215], v[200:203], v[64:67]
  v_exp_f32 v176, v176
  v_mfma_f32_16x16x32_bf16 v[4:7], v[216:219], v[192:195], v[4:7]
  ds_read_b64_tr_b16 v[212:213], v241 offset:8192
  ds_read_b64_tr_b16 v[214:215], v241 offset:12288
  v_mfma_f32_16x16x32_bf16 v[36:39], v[216:219], v[196:199], v[36:39]
  v_exp_f32 v177, v177
  v_mfma_f32_16x16x32_bf16 v[68:71], v[216:219], v[200:203], v[68:71]
  v_exp_f32 v178, v178
  s_waitcnt lgkmcnt(4)
  v_mfma_f32_16x16x32_bf16 v[8:11], v[220:223], v[192:195], v[8:11]
  v_exp_f32 v179, v179
  v_mfma_f32_16x16x32_bf16 v[40:43], v[220:223], v[196:199], v[40:43]
  ds_read_b64_tr_b16 v[216:217], v242 offset:8192
  ds_read_b64_tr_b16 v[218:219], v242 offset:12288
  v_mfma_f32_16x16x32_bf16 v[72:75], v[220:223], v[200:203], v[72:75]
  v_max3_f32 v252, v180, v181, v182
  v_max3_f32 v252, v252, v183, v184
  v_mfma_f32_16x16x32_bf16 v[12:15], v[204:207], v[192:195], v[12:15]
  ds_read_b64_tr_b16 v[220:221], v243 offset:8192
  ds_read_b64_tr_b16 v[222:223], v243 offset:12288
  v_mfma_f32_16x16x32_bf16 v[44:47], v[204:207], v[196:199], v[44:47]
  v_max3_f32 v252, v252, v185, v186
  v_max3_f32 v252, v252, v187, v188
  v_mfma_f32_16x16x32_bf16 v[76:79], v[204:207], v[200:203], v[76:79]
  v_max3_f32 v252, v252, v189, v190
  s_waitcnt lgkmcnt(4)
  v_mfma_f32_16x16x32_bf16 v[16:19], v[208:211], v[192:195], v[16:19]
  v_max_f32 v252, v252, v191
  v_cmp_lt_f32 vcc, 0x41200000, v252
  v_mfma_f32_16x16x32_bf16 v[48:51], v[208:211], v[196:199], v[48:51]
  v_mfma_f32_16x16x32_bf16 v[80:83], v[208:211], v[200:203], v[80:83]
  s_cbranch_vccnz L_stubB_a4_1
L_retB_a4_1:
  s_waitcnt lgkmcnt(0)
  s_branch L_aloop
L_afin:
  s_cmp_eq_u32 s33, 0
  s_cbranch_scc0 L_afin1
  s_setprio 0
L_afin1:
  s_barrier
  v_mfma_f32_16x16x32_bf16 v[20:23], v[212:215], v[192:195], v[20:23]
  ds_read_b64_tr_b16 v[204:205], v236 offset:0
  ds_read_b64_tr_b16 v[206:207], v236 offset:4096
  v_mfma_f32_16x16x32_bf16 v[52:55], v[212:215], v[196:199], v[52:55]
  ds_read_b64_tr_b16 v[208:209], v237 offset:0
  ds_read_b64_tr_b16 v[210:211], v237 offset:4096
  v_mfma_f32_16x16x32_bf16 v[84:87], v[212:215], v[200:203], v[84:87]
  v_exp_f32 v180, v180
  v_mfma_f32_16x16x32_bf16 v[24:27], v[216:219], v[192:195], v[24:27]
  ds_read_b64_tr_b16 v[212:213], v238 offset:0
  ds_read_b64_tr_b16 v[214:215], v238 offset:4096
  v_mfma_f32_16x16x32_bf16 v[56:59], v[216:219], v[196:199], v[56:59]
  v_exp_f32 v181, v181
  v_mfma_f32_16x16x32_bf16 v[88:91], v[216:219], v[200:203], v[88:91]
  v_exp_f32 v182, v182
  v_mfma_f32_16x16x32_bf16 v[28:31], v[220:223], v[192:195], v[28:31]
  v_cvt_pk_bf16_f32 v192, v168, v169
  v_cvt_pk_bf16_f32 v193, v170, v171
  v_mfma_f32_16x16x32_bf16 v[60:63], v[220:223], v[196:199], v[60:63]
  v_cvt_pk_bf16_f32 v196, v172, v173
  v_cvt_pk_bf16_f32 v197, v174, v175
  v_mfma_f32_16x16x32_bf16 v[92:95], v[220:223], v[200:203], v[92:95]
  v_cvt_pk_bf16_f32 v200, v176, v177
  v_cvt_pk_bf16_f32 v201, v178, v179
  v_exp_f32 v183, v183
  v_exp_f32 v184, v184
  v_exp_f32 v185, v185
  v_exp_f32 v186, v186
  v_exp_f32 v187, v187
  v_exp_f32 v188, v188
  v_exp_f32 v189, v189
  v_exp_f32 v190, v190
  v_exp_f32 v191, v191
  v_cvt_pk_bf16_f32 v194, v180, v181
  v_cvt_pk_bf16_f32 v195, v182, v183
  v_cvt_pk_bf16_f32 v198, v184, v185
  v_cvt_pk_bf16_f32 v199, v186, v187
  v_cvt_pk_bf16_f32 v202, v188, v189
  v_cvt_pk_bf16_f32 v203, v190, v191
  v_mfma_f32_16x16x32_bf16 v[96:99], v[228:231], v[192:195], v[96:99]
  ds_read_b64_tr_b16 v[216:217], v239 offset:0
  ds_read_b64_tr_b16 v[218:219], v239 offset:4096
  v_mfma_f32_16x16x32_bf16 v[100:103], v[228:231], v[196:199], v[100:103]
  v_mfma_f32_16x16x32_bf16 v[104:107], v[228:231], v[200:203], v[104:107]
  s_waitcnt lgkmcnt(4)
  v_mfma_f32_16x16x32_bf16 v[0:3], v[204:207], v[192:195], v[0:3]
  ds_read_b64_tr_b16 v[220:221], v240 offset:0
  ds_read_b64_tr_b16 v[222:223], v240 offset:4096
  v_mfma_f32_16x16x32_bf16 v[32:35], v[204:207], v[196:199], v[32:35]
  v_mfma_f32_16x16x32_bf16 v[64:67], v[204:207], v[200:203], v[64:67]
  v_mfma_f32_16x16x32_bf16 v[4:7], v[208:211], v[192:195], v[4:7]
  ds_read_b64_tr_b16 v[224:225], v241 offset:0
  ds_read_b64_tr_b16 v[226:227], v241 offset:4096
  v_mfma_f32_16x16x32_bf16 v[36:39], v[208:211], v[196:199], v[36:39]
  v_mfma_f32_16x16x32_bf16 v[68:71], v[208:211], v[200:203], v[68:71]
  s_waitcnt lgkmcnt(4)
  v_mfma_f32_16x16x32_bf16 v[8:11], v[212:215], v[192:195], v[8:11]
  ds_read_b64_tr_b16 v[204:205], v242 offset:0
  ds_read_b64_tr_b16 v[206:207], v242 offset:4096
  v_mfma_f32_16x16x32_bf16 v[40:43], v[212:215], v[196:199], v[40:43]
  v_mfma_f32_16x16x32_bf16 v[72:75], v[212:215], v[200:203], v[72:75]
  v_mfma_f32_16x16x32_bf16 v[12:15], v[216:219], v[192:195], v[12:15]
  ds_read_b64_tr_b16 v[208:209], v243 offset:0
  ds_read_b64_tr_b16 v[210:211], v243 offset:4096
  v_mfma_f32_16x16x32_bf16 v[44:47], v[216:219], v[196:199], v[44:47]
  v_mfma_f32_16x16x32_bf16 v[76:79], v[216:219], v[200:203], v[76:79]
  s_waitcnt lgkmcnt(4)
  v_mfma_f32_16x16x32_bf16 v[16:19], v[220:223], v[192:195], v[16:19]
  v_mfma_f32_16x16x32_bf16 v[48:51], v[220:223], v[196:199], v[48:51]
  v_mfma_f32_16x16x32_bf16 v[80:83], v[220:223], v[200:203], v[80:83]
  s_waitcnt lgkmcnt(0)
  s_barrier
  v_mfma_f32_16x16x32_bf16 v[20:23], v[224:227], v[192:195], v[20:23]
  v_mfma_f32_16x16x32_bf16 v[52:55], v[224:227], v[196:199], v[52:55]
  v_mfma_f32_16x16x32_bf16 v[84:87], v[224:227], v[200:203], v[84:87]
  v_mfma_f32_16x16x32_bf16 v[24:27], v[204:207], v[192:195], v[24:27]
  v_mfma_f32_16x16x32_bf16 v[56:59], v[204:207], v[196:199], v[56:59]
  v_mfma_f32_16x16x32_bf16 v[88:91], v[204:207], v[200:203], v[88:91]
  v_mfma_f32_16x16x32_bf16 v[28:31], v[208:211], v[192:195], v[28:31]
  v_mfma_f32_16x16x32_bf16 v[60:63], v[208:211], v[196:199], v[60:63]
  v_mfma_f32_16x16x32_bf16 v[92:95], v[208:211], v[200:203], v[92:95]
  s_cmp_lg_u32 s33, 0
  s_cbranch_scc1 L_epi0
  s_barrier
  v_rcp_f32 v244, v96
  v_rcp_f32 v245, v96
  v_rcp_f32 v246, v100
  v_rcp_f32 v247, v100
  v_rcp_f32 v248, v104
  v_rcp_f32 v249, v104
  s_add_u32 s41, s44, 4096
  s_add_u32 s69, s44, 8192
  v_pk_mul_f32 v[0:1], v[0:1], v[244:245]
  v_pk_mul_f32 v[2:3], v[2:3], v[244:245]
  v_pk_mul_f32 v[4:5], v[4:5], v[244:245]
  v_pk_mul_f32 v[6:7], v[6:7], v[244:245]
  v_cvt_pk_bf16_f32 v120, v0, v1
  v_cvt_pk_bf16_f32 v121, v2, v3
  v_cvt_pk_bf16_f32 v122, v4, v5
  v_cvt_pk_bf16_f32 v123, v6, v7
  v_pk_mul_f32 v[8:9], v[8:9], v[244:245]
  v_pk_mul_f32 v[10:11], v[10:11], v[244:245]
  v_pk_mul_f32 v[12:13], v[12:13], v[244:245]
  v_pk_mul_f32 v[14:15], v[14:15], v[244:245]
  v_cvt_pk_bf16_f32 v124, v8, v9
  v_cvt_pk_bf16_f32 v125, v10, v11
  v_cvt_pk_bf16_f32 v126, v12, v13
  v_cvt_pk_bf16_f32 v127, v14, v15
  v_pk_mul_f32 v[16:17], v[16:17], v[244:245]
  v_pk_mul_f32 v[18:19], v[18:19], v[244:245]
  v_pk_mul_f32 v[20:21], v[20:21], v[244:245]
  v_pk_mul_f32 v[22:23], v[22:23], v[244:245]
  v_cvt_pk_bf16_f32 v128, v16, v17
  v_cvt_pk_bf16_f32 v129, v18, v19
  v_cvt_pk_bf16_f32 v130, v20, v21
  v_cvt_pk_bf16_f32 v131, v22, v23
  v_pk_mul_f32 v[24:25], v[24:25], v[244:245]
  v_pk_mul_f32 v[26:27], v[26:27], v[244:245]
  v_pk_mul_f32 v[28:29], v[28:29], v[244:245]
  v_pk_mul_f32 v[30:31], v[30:31], v[244:245]
  v_cvt_pk_bf16_f32 v132, v24, v25
  v_cvt_pk_bf16_f32 v133, v26, v27
  v_cvt_pk_bf16_f32 v134, v28, v29
  v_cvt_pk_bf16_f32 v135, v30, v31
  s_barrier
  v_pk_mul_f32 v[32:33], v[32:33], v[246:247]
  v_pk_mul_f32 v[34:35], v[34:35], v[246:247]
  v_pk_mul_f32 v[36:37], v[36:37], v[246:247]
  v_pk_mul_f32 v[38:39], v[38:39], v[246:247]
  v_cvt_pk_bf16_f32 v136, v32, v33
  v_cvt_pk_bf16_f32 v137, v34, v35
  v_cvt_pk_bf16_f32 v138, v36, v37
  v_cvt_pk_bf16_f32 v139, v38, v39
  v_pk_mul_f32 v[40:41], v[40:41], v[246:247]
  v_pk_mul_f32 v[42:43], v[42:43], v[246:247]
  v_pk_mul_f32 v[44:45], v[44:45], v[246:247]
  v_pk_mul_f32 v[46:47], v[46:47], v[246:247]
  v_cvt_pk_bf16_f32 v140, v40, v41
  v_cvt_pk_bf16_f32 v141, v42, v43
  v_cvt_pk_bf16_f32 v142, v44, v45
  v_cvt_pk_bf16_f32 v143, v46, v47
  v_pk_mul_f32 v[48:49], v[48:49], v[246:247]
  v_pk_mul_f32 v[50:51], v[50:51], v[246:247]
  v_pk_mul_f32 v[52:53], v[52:53], v[246:247]
  v_pk_mul_f32 v[54:55], v[54:55], v[246:247]
  v_cvt_pk_bf16_f32 v144, v48, v49
  v_cvt_pk_bf16_f32 v145, v50, v51
  v_cvt_pk_bf16_f32 v146, v52, v53
  v_cvt_pk_bf16_f32 v147, v54, v55
  v_pk_mul_f32 v[56:57], v[56:57], v[246:247]
  v_pk_mul_f32 v[58:59], v[58:59], v[246:247]
  v_pk_mul_f32 v[60:61], v[60:61], v[246:247]
  v_pk_mul_f32 v[62:63], v[62:63], v[246:247]
  v_cvt_pk_bf16_f32 v148, v56, v57
  v_cvt_pk_bf16_f32 v149, v58, v59
  v_cvt_pk_bf16_f32 v150, v60, v61
  v_cvt_pk_bf16_f32 v151, v62, v63
  s_barrier
  v_pk_mul_f32 v[64:65], v[64:65], v[248:249]
  v_pk_mul_f32 v[66:67], v[66:67], v[248:249]
  v_pk_mul_f32 v[68:69], v[68:69], v[248:249]
  v_pk_mul_f32 v[70:71], v[70:71], v[248:249]
  v_cvt_pk_bf16_f32 v152, v64, v65
  v_cvt_pk_bf16_f32 v153, v66, v67
  v_cvt_pk_bf16_f32 v154, v68, v69
  v_cvt_pk_bf16_f32 v155, v70, v71
  v_pk_mul_f32 v[72:73], v[72:73], v[248:249]
  v_pk_mul_f32 v[74:75], v[74:75], v[248:249]
  v_pk_mul_f32 v[76:77], v[76:77], v[248:249]
  v_pk_mul_f32 v[78:79], v[78:79], v[248:249]
  v_cvt_pk_bf16_f32 v156, v72, v73
  v_cvt_pk_bf16_f32 v157, v74, v75
  v_cvt_pk_bf16_f32 v158, v76, v77
  v_cvt_pk_bf16_f32 v159, v78, v79
  v_pk_mul_f32 v[80:81], v[80:81], v[248:249]
  v_pk_mul_f32 v[82:83], v[82:83], v[248:249]
  v_pk_mul_f32 v[84:85], v[84:85], v[248:249]
  v_pk_mul_f32 v[86:87], v[86:87], v[248:249]
  v_cvt_pk_bf16_f32 v160, v80, v81
  v_cvt_pk_bf16_f32 v161, v82, v83
  v_cvt_pk_bf16_f32 v162, v84, v85
  v_cvt_pk_bf16_f32 v163, v86, v87
  v_pk_mul_f32 v[88:89], v[88:89], v[248:249]
  v_pk_mul_f32 v[90:91], v[90:91], v[248:249]
  v_pk_mul_f32 v[92:93], v[92:93], v[248:249]
  v_pk_mul_f32 v[94:95], v[94:95], v[248:249]
  v_cvt_pk_bf16_f32 v164, v88, v89
  v_cvt_pk_bf16_f32 v165, v90, v91
  v_cvt_pk_bf16_f32 v166, v92, v93
  v_cvt_pk_bf16_f32 v167, v94, v95
  s_barrier
  s_branch L_epiJ
L_epi0:
  s_nop 5
  s_cmp_eq_u32 s3, 0
  s_cbranch_scc1 L_epiS
  v_rcp_f32 v244, v96
  v_rcp_f32 v245, v96
  v_rcp_f32 v246, v100
  v_rcp_f32 v247, v100
  v_rcp_f32 v248, v104
  v_rcp_f32 v249, v104
  s_add_u32 s41, s44, 4096
  s_add_u32 s69, s44, 8192
  v_pk_mul_f32 v[0:1], v[0:1], v[244:245]
  v_pk_mul_f32 v[2:3], v[2:3], v[244:245]
  v_pk_mul_f32 v[4:5], v[4:5], v[244:245]
  v_pk_mul_f32 v[6:7], v[6:7], v[244:245]
  v_cvt_pk_bf16_f32 v120, v0, v1
  v_cvt_pk_bf16_f32 v121, v2, v3
  v_cvt_pk_bf16_f32 v122, v4, v5
  v_cvt_pk_bf16_f32 v123, v6, v7
  buffer_store_dwordx4 v[120:123], v253, s[24:27], s44 offen
  v_pk_mul_f32 v[8:9], v[8:9], v[244:245]
  v_pk_mul_f32 v[10:11], v[10:11], v[244:245]
  v_pk_mul_f32 v[12:13], v[12:13], v[244:245]
  v_pk_mul_f32 v[14:15], v[14:15], v[244:245]
  v_cvt_pk_bf16_f32 v124, v8, v9
  v_cvt_pk_bf16_f32 v125, v10, v11
  v_cvt_pk_bf16_f32 v126, v12, v13
  v_cvt_pk_bf16_f32 v127, v14, v15
  buffer_store_dwordx4 v[124:127], v253, s[24:27], s44 offen offset:1024
  v_pk_mul_f32 v[16:17], v[16:17], v[244:245]
  v_pk_mul_f32 v[18:19], v[18:19], v[244:245]
  v_pk_mul_f32 v[20:21], v[20:21], v[244:245]
  v_pk_mul_f32 v[22:23], v[22:23], v[244:245]
  v_cvt_pk_bf16_f32 v128, v16, v17
  v_cvt_pk_bf16_f32 v129, v18, v19
  v_cvt_pk_bf16_f32 v130, v20, v21
  v_cvt_pk_bf16_f32 v131, v22, v23
  buffer_store_dwordx4 v[128:131], v253, s[24:27], s44 offen offset:2048
  v_pk_mul_f32 v[24:25], v[24:25], v[244:245]
  v_pk_mul_f32 v[26:27], v[26:27], v[244:245]
  v_pk_mul_f32 v[28:29], v[28:29], v[244:245]
  v_pk_mul_f32 v[30:31], v[30:31], v[244:245]
  v_cvt_pk_bf16_f32 v132, v24, v25
  v_cvt_pk_bf16_f32 v133, v26, v27
  v_cvt_pk_bf16_f32 v134, v28, v29
  v_cvt_pk_bf16_f32 v135, v30, v31
  buffer_store_dwordx4 v[132:135], v253, s[24:27], s44 offen offset:3072
  v_pk_mul_f32 v[32:33], v[32:33], v[246:247]
  v_pk_mul_f32 v[34:35], v[34:35], v[246:247]
  v_pk_mul_f32 v[36:37], v[36:37], v[246:247]
  v_pk_mul_f32 v[38:39], v[38:39], v[246:247]
  v_cvt_pk_bf16_f32 v136, v32, v33
  v_cvt_pk_bf16_f32 v137, v34, v35
  v_cvt_pk_bf16_f32 v138, v36, v37
  v_cvt_pk_bf16_f32 v139, v38, v39
  buffer_store_dwordx4 v[136:139], v253, s[24:27], s41 offen
  v_pk_mul_f32 v[40:41], v[40:41], v[246:247]
  v_pk_mul_f32 v[42:43], v[42:43], v[246:247]
  v_pk_mul_f32 v[44:45], v[44:45], v[246:247]
  v_pk_mul_f32 v[46:47], v[46:47], v[246:247]
  v_cvt_pk_bf16_f32 v140, v40, v41
  v_cvt_pk_bf16_f32 v141, v42, v43
  v_cvt_pk_bf16_f32 v142, v44, v45
  v_cvt_pk_bf16_f32 v143, v46, v47
  buffer_store_dwordx4 v[140:143], v253, s[24:27], s41 offen offset:1024
  v_pk_mul_f32 v[48:49], v[48:49], v[246:247]
  v_pk_mul_f32 v[50:51], v[50:51], v[246:247]
  v_pk_mul_f32 v[52:53], v[52:53], v[246:247]
  v_pk_mul_f32 v[54:55], v[54:55], v[246:247]
  v_cvt_pk_bf16_f32 v144, v48, v49
  v_cvt_pk_bf16_f32 v145, v50, v51
  v_cvt_pk_bf16_f32 v146, v52, v53
  v_cvt_pk_bf16_f32 v147, v54, v55
  buffer_store_dwordx4 v[144:147], v253, s[24:27], s41 offen offset:2048
  v_pk_mul_f32 v[56:57], v[56:57], v[246:247]
  v_pk_mul_f32 v[58:59], v[58:59], v[246:247]
  v_pk_mul_f32 v[60:61], v[60:61], v[246:247]
  v_pk_mul_f32 v[62:63], v[62:63], v[246:247]
  v_cvt_pk_bf16_f32 v148, v56, v57
  v_cvt_pk_bf16_f32 v149, v58, v59
  v_cvt_pk_bf16_f32 v150, v60, v61
  v_cvt_pk_bf16_f32 v151, v62, v63
  buffer_store_dwordx4 v[148:151], v253, s[24:27], s41 offen offset:3072
  v_pk_mul_f32 v[64:65], v[64:65], v[248:249]
  v_pk_mul_f32 v[66:67], v[66:67], v[248:249]
  v_pk_mul_f32 v[68:69], v[68:69], v[248:249]
  v_pk_mul_f32 v[70:71], v[70:71], v[248:249]
  v_cvt_pk_bf16_f32 v152, v64, v65
  v_cvt_pk_bf16_f32 v153, v66, v67
  v_cvt_pk_bf16_f32 v154, v68, v69
  v_cvt_pk_bf16_f32 v155, v70, v71
  buffer_store_dwordx4 v[152:155], v253, s[24:27], s69 offen
  v_pk_mul_f32 v[72:73], v[72:73], v[248:249]
  v_pk_mul_f32 v[74:75], v[74:75], v[248:249]
  v_pk_mul_f32 v[76:77], v[76:77], v[248:249]
  v_pk_mul_f32 v[78:79], v[78:79], v[248:249]
  v_cvt_pk_bf16_f32 v156, v72, v73
  v_cvt_pk_bf16_f32 v157, v74, v75
  v_cvt_pk_bf16_f32 v158, v76, v77
  v_cvt_pk_bf16_f32 v159, v78, v79
  buffer_store_dwordx4 v[156:159], v253, s[24:27], s69 offen offset:1024
  v_pk_mul_f32 v[80:81], v[80:81], v[248:249]
  v_pk_mul_f32 v[82:83], v[82:83], v[248:249]
  v_pk_mul_f32 v[84:85], v[84:85], v[248:249]
  v_pk_mul_f32 v[86:87], v[86:87], v[248:249]
  v_cvt_pk_bf16_f32 v160, v80, v81
  v_cvt_pk_bf16_f32 v161, v82, v83
  v_cvt_pk_bf16_f32 v162, v84, v85
  v_cvt_pk_bf16_f32 v163, v86, v87
  buffer_store_dwordx4 v[160:163], v253, s[24:27], s69 offen offset:2048
  v_pk_mul_f32 v[88:89], v[88:89], v[248:249]
  v_pk_mul_f32 v[90:91], v[90:91], v[248:249]
  v_pk_mul_f32 v[92:93], v[92:93], v[248:249]
  v_pk_mul_f32 v[94:95], v[94:95], v[248:249]
  v_cvt_pk_bf16_f32 v164, v88, v89
  v_cvt_pk_bf16_f32 v165, v90, v91
  v_cvt_pk_bf16_f32 v166, v92, v93
  v_cvt_pk_bf16_f32 v167, v94, v95
  buffer_store_dwordx4 v[164:167], v253, s[24:27], s69 offen offset:3072
  s_branch L_epiJ
L_epiS:
  s_nop 7
  v_rcp_f32 v244, v96
  v_rcp_f32 v245, v96
  v_rcp_f32 v246, v100
  v_rcp_f32 v247, v100
  v_rcp_f32 v248, v104
  v_rcp_f32 v249, v104
  s_add_u32 s41, s44, 4096
  s_add_u32 s69, s44, 8192
  v_pk_mul_f32 v[0:1], v[0:1], v[244:245]
  v_pk_mul_f32 v[2:3], v[2:3], v[244:245]
  v_pk_mul_f32 v[4:5], v[4:5], v[244:245]
  v_pk_mul_f32 v[6:7], v[6:7], v[244:245]
  v_cvt_pk_bf16_f32 v120, v0, v1
  v_cvt_pk_bf16_f32 v121, v2, v3
  v_cvt_pk_bf16_f32 v122, v4, v5
  v_cvt_pk_bf16_f32 v123, v6, v7
  buffer_store_dwordx4 v[120:123], v253, s[24:27], s44 offen sc1
  v_pk_mul_f32 v[8:9], v[8:9], v[244:245]
  v_pk_mul_f32 v[10:11], v[10:11], v[244:245]
  v_pk_mul_f32 v[12:13], v[12:13], v[244:245]
  v_pk_mul_f32 v[14:15], v[14:15], v[244:245]
  v_cvt_pk_bf16_f32 v124, v8, v9
  v_cvt_pk_bf16_f32 v125, v10, v11
  v_cvt_pk_bf16_f32 v126, v12, v13
  v_cvt_pk_bf16_f32 v127, v14, v15
  buffer_store_dwordx4 v[124:127], v253, s[24:27], s44 offen offset:1024 sc1
  v_pk_mul_f32 v[16:17], v[16:17], v[244:245]
  v_pk_mul_f32 v[18:19], v[18:19], v[244:245]
  v_pk_mul_f32 v[20:21], v[20:21], v[244:245]
  v_pk_mul_f32 v[22:23], v[22:23], v[244:245]
  v_cvt_pk_bf16_f32 v128, v16, v17
  v_cvt_pk_bf16_f32 v129, v18, v19
  v_cvt_pk_bf16_f32 v130, v20, v21
  v_cvt_pk_bf16_f32 v131, v22, v23
  buffer_store_dwordx4 v[128:131], v253, s[24:27], s44 offen offset:2048 sc1
  v_pk_mul_f32 v[24:25], v[24:25], v[244:245]
  v_pk_mul_f32 v[26:27], v[26:27], v[244:245]
  v_pk_mul_f32 v[28:29], v[28:29], v[244:245]
  v_pk_mul_f32 v[30:31], v[30:31], v[244:245]
  v_cvt_pk_bf16_f32 v132, v24, v25
  v_cvt_pk_bf16_f32 v133, v26, v27
  v_cvt_pk_bf16_f32 v134, v28, v29
  v_cvt_pk_bf16_f32 v135, v30, v31
  buffer_store_dwordx4 v[132:135], v253, s[24:27], s44 offen offset:3072 sc1
  v_pk_mul_f32 v[32:33], v[32:33], v[246:247]
  v_pk_mul_f32 v[34:35], v[34:35], v[246:247]
  v_pk_mul_f32 v[36:37], v[36:37], v[246:247]
  v_pk_mul_f32 v[38:39], v[38:39], v[246:247]
  v_cvt_pk_bf16_f32 v136, v32, v33
  v_cvt_pk_bf16_f32 v137, v34, v35
  v_cvt_pk_bf16_f32 v138, v36, v37
  v_cvt_pk_bf16_f32 v139, v38, v39
  buffer_store_dwordx4 v[136:139], v253, s[24:27], s41 offen sc1
  v_pk_mul_f32 v[40:41], v[40:41], v[246:247]
  v_pk_mul_f32 v[42:43], v[42:43], v[246:247]
  v_pk_mul_f32 v[44:45], v[44:45], v[246:247]
  v_pk_mul_f32 v[46:47], v[46:47], v[246:247]
  v_cvt_pk_bf16_f32 v140, v40, v41
  v_cvt_pk_bf16_f32 v141, v42, v43
  v_cvt_pk_bf16_f32 v142, v44, v45
  v_cvt_pk_bf16_f32 v143, v46, v47
  buffer_store_dwordx4 v[140:143], v253, s[24:27], s41 offen offset:1024 sc1
  v_pk_mul_f32 v[48:49], v[48:49], v[246:247]
  v_pk_mul_f32 v[50:51], v[50:51], v[246:247]
  v_pk_mul_f32 v[52:53], v[52:53], v[246:247]
  v_pk_mul_f32 v[54:55], v[54:55], v[246:247]
  v_cvt_pk_bf16_f32 v144, v48, v49
  v_cvt_pk_bf16_f32 v145, v50, v51
  v_cvt_pk_bf16_f32 v146, v52, v53
  v_cvt_pk_bf16_f32 v147, v54, v55
  buffer_store_dwordx4 v[144:147], v253, s[24:27], s41 offen offset:2048 sc1
  v_pk_mul_f32 v[56:57], v[56:57], v[246:247]
  v_pk_mul_f32 v[58:59], v[58:59], v[246:247]
  v_pk_mul_f32 v[60:61], v[60:61], v[246:247]
  v_pk_mul_f32 v[62:63], v[62:63], v[246:247]
  v_cvt_pk_bf16_f32 v148, v56, v57
  v_cvt_pk_bf16_f32 v149, v58, v59
  v_cvt_pk_bf16_f32 v150, v60, v61
  v_cvt_pk_bf16_f32 v151, v62, v63
  buffer_store_dwordx4 v[148:151], v253, s[24:27], s41 offen offset:3072 sc1
  v_pk_mul_f32 v[64:65], v[64:65], v[248:249]
  v_pk_mul_f32 v[66:67], v[66:67], v[248:249]
  v_pk_mul_f32 v[68:69], v[68:69], v[248:249]
  v_pk_mul_f32 v[70:71], v[70:71], v[248:249]
  v_cvt_pk_bf16_f32 v152, v64, v65
  v_cvt_pk_bf16_f32 v153, v66, v67
  v_cvt_pk_bf16_f32 v154, v68, v69
  v_cvt_pk_bf16_f32 v155, v70, v71
  buffer_store_dwordx4 v[152:155], v253, s[24:27], s69 offen sc1
  v_pk_mul_f32 v[72:73], v[72:73], v[248:249]
  v_pk_mul_f32 v[74:75], v[74:75], v[248:249]
  v_pk_mul_f32 v[76:77], v[76:77], v[248:249]
  v_pk_mul_f32 v[78:79], v[78:79], v[248:249]
  v_cvt_pk_bf16_f32 v156, v72, v73
  v_cvt_pk_bf16_f32 v157, v74, v75
  v_cvt_pk_bf16_f32 v158, v76, v77
  v_cvt_pk_bf16_f32 v159, v78, v79
  buffer_store_dwordx4 v[156:159], v253, s[24:27], s69 offen offset:1024 sc1
  v_pk_mul_f32 v[80:81], v[80:81], v[248:249]
  v_pk_mul_f32 v[82:83], v[82:83], v[248:249]
  v_pk_mul_f32 v[84:85], v[84:85], v[248:249]
  v_pk_mul_f32 v[86:87], v[86:87], v[248:249]
  v_cvt_pk_bf16_f32 v160, v80, v81
  v_cvt_pk_bf16_f32 v161, v82, v83
  v_cvt_pk_bf16_f32 v162, v84, v85
  v_cvt_pk_bf16_f32 v163, v86, v87
  buffer_store_dwordx4 v[160:163], v253, s[24:27], s69 offen offset:2048 sc1
  v_pk_mul_f32 v[88:89], v[88:89], v[248:249]
  v_pk_mul_f32 v[90:91], v[90:91], v[248:249]
  v_pk_mul_f32 v[92:93], v[92:93], v[248:249]
  v_pk_mul_f32 v[94:95], v[94:95], v[248:249]
  v_cvt_pk_bf16_f32 v164, v88, v89
  v_cvt_pk_bf16_f32 v165, v90, v91
  v_cvt_pk_bf16_f32 v166, v92, v93
  v_cvt_pk_bf16_f32 v167, v94, v95
  buffer_store_dwordx4 v[164:167], v253, s[24:27], s69 offen offset:3072 sc1
L_epiJ:
  v_lshrrev_b32 v244, 4, v253
  v_lshrrev_b32 v245, 4, v244
  v_and_b32 v246, 15, v244
  v_lshrrev_b32 v247, 2, v246
  v_and_b32 v246, 3, v246
  v_lshlrev_b32 v245, 2, v245
  v_add_u32 v245, v245, v247
  v_lshrrev_b32 v247, 1, v245
  v_and_b32 v247, 3, v247
  v_lshlrev_b32 v247, 5, v247
  v_lshlrev_b32 v245, 7, v245
  v_add_u32 v245, v245, v247
  v_lshlrev_b32 v246, 3, v246
  v_add_u32 v245, v245, v246
  s_add_u32 s4, s62, 0
  s_and_b32 s4, s4, 3
  s_lshl_b32 s4, s4, 5
  v_xor_b32 v232, s4, v245
  s_add_u32 s4, s62, 1
  s_and_b32 s4, s4, 3
  s_lshl_b32 s4, s4, 5
  v_xor_b32 v233, s4, v245
  s_add_u32 s4, s62, 2
  s_and_b32 s4, s4, 3
  s_lshl_b32 s4, s4, 5
  v_xor_b32 v234, s4, v245
  s_add_u32 s4, s62, 3
  s_and_b32 s4, s4, 3
  s_lshl_b32 s4, s4, 5
  v_xor_b32 v235, s4, v245
  s_mov_b32 s100, 8
  s_cmp_eq_u32 s33, 0
  s_cbranch_scc1 L_tailA
  v_lshrrev_b32 v241, 4, v253
  v_and_b32 v241, 7, v241
  v_max_u32 v241, 1, v241
  v_add_u32 v241, s61, v241
  v_and_b32 v241, 7, v241
  v_lshlrev_b32 v241, 3, v241
  s_mov_b32 s71, 1
  s_waitcnt vmcnt(0)
  s_cmp_eq_u32 s3, 0
  s_cbranch_scc1 L_bS0
  v_mov_b32 v242, s58
  v_mov_b32 v243, s59
  v_mov_b32 v240, 0
  s_nop 0
  buffer_store_dwordx2 v[242:243], v240, s[24:27], s65 offen
  s_branch L_bJ0
L_bS0:
  v_mov_b32 v242, s58
  v_mov_b32 v243, s59
  v_mov_b32 v240, 0
  s_nop 0
  buffer_store_dwordx2 v[242:243], v240, s[24:27], s65 offen sc1
L_bJ0:
  v_mov_b32 v0, 0
  v_mov_b32 v1, 0
  v_mov_b32 v2, 0
  v_mov_b32 v3, 0
  v_mov_b32 v4, 0
  v_mov_b32 v5, 0
  v_mov_b32 v6, 0
  v_mov_b32 v7, 0
  v_mov_b32 v8, 0
  v_mov_b32 v9, 0
  v_mov_b32 v10, 0
  v_mov_b32 v11, 0
  v_mov_b32 v12, 0
  v_mov_b32 v13, 0
  v_mov_b32 v14, 0
  v_mov_b32 v15, 0
  v_mov_b32 v16, 0
  v_mov_b32 v17, 0
  v_mov_b32 v18, 0
  v_mov_b32 v19, 0
  v_mov_b32 v20, 0
  v_mov_b32 v21, 0
  v_mov_b32 v22, 0
  v_mov_b32 v23, 0
  v_mov_b32 v24, 0
  v_mov_b32 v25, 0
  v_mov_b32 v26, 0
  v_mov_b32 v27, 0
  v_mov_b32 v28, 0
  v_mov_b32 v29, 0
  v_mov_b32 v30, 0
  v_mov_b32 v31, 0
  v_mov_b32 v32, 0
  v_mov_b32 v33, 0
  v_mov_b32 v34, 0
  v_mov_b32 v35, 0
  v_mov_b32 v36, 0
  v_mov_b32 v37, 0
  v_mov_b32 v38, 0
  v_mov_b32 v39, 0
  v_mov_b32 v40, 0
  v_mov_b32 v41, 0
  v_mov_b32 v42, 0
  v_mov_b32 v43, 0
  v_mov_b32 v44, 0
  v_mov_b32 v45, 0
  v_mov_b32 v46, 0
  v_mov_b32 v47, 0
L_chk3:
  buffer_load_dwordx2 v[244:245], v241, s[24:27], s64 offen sc1
  s_waitcnt vmcnt(0)
  v_cmp_eq_u32 vcc, s58, v244
  v_cmp_eq_u32 s[4:5], s59, v245
  s_nop 3
  s_and_b64 vcc, vcc, s[4:5]
  s_cmp_eq_u64 vcc, exec
  s_cbranch_scc0 L_ew3
  s_add_u32 s5, s61, s71
  s_and_b32 s5, s5, 7
  s_mul_i32 s5, s5, 36864
  s_add_u32 s5, s5, s60
  s_cmp_ge_u32 s71, s100
  s_cselect_b32 s4, 0x40000000, s5
  s_add_u32 s71, s71, 1
  s_add_u32 s5, s4, s101
  s_add_u32 s6, s5, s101
  buffer_load_dwordx4 v[48:51], v253, s[24:27], s4 offen
  buffer_load_dwordx4 v[64:67], v253, s[24:27], s5 offen
  buffer_load_dwordx4 v[80:83], v253, s[24:27], s6 offen
  buffer_load_dwordx4 v[52:55], v253, s[24:27], s4 offen offset:1024
  buffer_load_dwordx4 v[68:71], v253, s[24:27], s5 offen offset:1024
  buffer_load_dwordx4 v[84:87], v253, s[24:27], s6 offen offset:1024
  buffer_load_dwordx4 v[56:59], v253, s[24:27], s4 offen offset:2048
  buffer_load_dwordx4 v[72:75], v253, s[24:27], s5 offen offset:2048
  buffer_load_dwordx4 v[88:91], v253, s[24:27], s6 offen offset:2048
  buffer_load_dwordx4 v[60:63], v253, s[24:27], s4 offen offset:3072
  buffer_load_dwordx4 v[76:79], v253, s[24:27], s5 offen offset:3072
  buffer_load_dwordx4 v[92:95], v253, s[24:27], s6 offen offset:3072
  s_call_b64 s[92:93], L_own3
  s_branch L_entry3
L_ew3:
  s_call_b64 s[92:93], L_own3
  v_lshrrev_b32 v241, 4, v253
  v_and_b32 v241, 7, v241
  v_max_u32 v241, 1, v241
  v_add_u32 v241, s61, v241
  v_and_b32 v241, 7, v241
  v_lshlrev_b32 v241, 3, v241
  s_mov_b32 s63, 0x20000
  buffer_load_dwordx2 v[244:245], v241, s[24:27], s64 offen sc1
  s_sleep 3
  buffer_load_dwordx2 v[246:247], v241, s[24:27], s64 offen sc1
L_polle3:
  s_waitcnt vmcnt(1)
  v_cmp_eq_u32 vcc, s58, v244
  v_cmp_eq_u32 s[4:5], s59, v245
  s_nop 3
  s_and_b64 vcc, vcc, s[4:5]
  s_cmp_eq_u64 vcc, exec
  s_cbranch_scc1 L_pollxe3
  buffer_load_dwordx2 v[244:245], v241, s[24:27], s64 offen sc1
  s_waitcnt vmcnt(1)
  v_cmp_eq_u32 vcc, s58, v246
  v_cmp_eq_u32 s[4:5], s59, v247
  s_nop 3
  s_and_b64 vcc, vcc, s[4:5]
  s_cmp_eq_u64 vcc, exec
  s_cbranch_scc1 L_pollxe3
  buffer_load_dwordx2 v[246:247], v241, s[24:27], s64 offen sc1
  s_sub_u32 s63, s63, 1
  s_cmp_lg_u32 s63, 0
  s_cbranch_scc1 L_polle3
L_pollxe3:
  s_add_u32 s5, s61, s71
  s_and_b32 s5, s5, 7
  s_mul_i32 s5, s5, 36864
  s_add_u32 s5, s5, s60
  s_cmp_ge_u32 s71, s100
  s_cselect_b32 s4, 0x40000000, s5
  s_add_u32 s71, s71, 1
  s_add_u32 s5, s4, s101
  s_add_u32 s6, s5, s101
  buffer_load_dwordx4 v[48:51], v253, s[24:27], s4 offen
  buffer_load_dwordx4 v[64:67], v253, s[24:27], s5 offen
  buffer_load_dwordx4 v[80:83], v253, s[24:27], s6 offen
  buffer_load_dwordx4 v[52:55], v253, s[24:27], s4 offen offset:1024
  buffer_load_dwordx4 v[68:71], v253, s[24:27], s5 offen offset:1024
  buffer_load_dwordx4 v[84:87], v253, s[24:27], s6 offen offset:1024
  buffer_load_dwordx4 v[56:59], v253, s[24:27], s4 offen offset:2048
  buffer_load_dwordx4 v[72:75], v253, s[24:27], s5 offen offset:2048
  buffer_load_dwordx4 v[88:91], v253, s[24:27], s6 offen offset:2048
  buffer_load_dwordx4 v[60:63], v253, s[24:27], s4 offen offset:3072
  buffer_load_dwordx4 v[76:79], v253, s[24:27], s5 offen offset:3072
  buffer_load_dwordx4 v[92:95], v253, s[24:27], s6 offen offset:3072
L_entry3:
  s_mov_b32 s70, 2
  s_waitcnt vmcnt(0)
  s_waitcnt lgkmcnt(4)
  v_mfma_f32_16x16x32_bf16 v[0:3], v[204:207], v[48:51], v[0:3]
  ds_read_b64_tr_b16 v[220:221], v236 offset:4096
  ds_read_b64_tr_b16 v[222:223], v236 offset:6144
  v_mfma_f32_16x16x32_bf16 v[4:7], v[204:207], v[64:67], v[4:7]
  s_add_u32 s5, s61, s71
  s_and_b32 s5, s5, 7
  v_mfma_f32_16x16x32_bf16 v[8:11], v[204:207], v[80:83], v[8:11]
  s_mul_i32 s5, s5, 36864
  s_add_u32 s5, s5, s60
  v_mfma_f32_16x16x32_bf16 v[12:15], v[208:211], v[48:51], v[12:15]
  ds_read_b64_tr_b16 v[224:225], v237 offset:4096
  ds_read_b64_tr_b16 v[226:227], v237 offset:6144
  s_cmp_ge_u32 s71, s100
  s_cselect_b32 s4, 0x40000000, s5
  s_add_u32 s71, s71, 1
  s_add_u32 s5, s4, s101
  s_add_u32 s6, s5, s101
  v_mfma_f32_16x16x32_bf16 v[16:19], v[208:211], v[64:67], v[16:19]
  buffer_load_dwordx4 v[96:99], v253, s[24:27], s4 offen
  buffer_load_dwordx4 v[112:115], v253, s[24:27], s5 offen
  v_mfma_f32_16x16x32_bf16 v[20:23], v[208:211], v[80:83], v[20:23]
  buffer_load_dwordx4 v[176:179], v253, s[24:27], s6 offen
  s_waitcnt lgkmcnt(4)
  v_mfma_f32_16x16x32_bf16 v[24:27], v[212:215], v[48:51], v[24:27]
  ds_read_b64_tr_b16 v[204:205], v238 offset:4096
  ds_read_b64_tr_b16 v[206:207], v238 offset:6144
  v_mfma_f32_16x16x32_bf16 v[28:31], v[212:215], v[64:67], v[28:31]
  buffer_load_dwordx4 v[100:103], v253, s[24:27], s4 offen offset:1024
  buffer_load_dwordx4 v[116:119], v253, s[24:27], s5 offen offset:1024
  v_mfma_f32_16x16x32_bf16 v[32:35], v[212:215], v[80:83], v[32:35]
  buffer_load_dwordx4 v[180:183], v253, s[24:27], s6 offen offset:1024
  buffer_load_dwordx4 v[104:107], v253, s[24:27], s4 offen offset:2048
  v_mfma_f32_16x16x32_bf16 v[36:39], v[216:219], v[48:51], v[36:39]
  ds_read_b64_tr_b16 v[208:209], v239 offset:4096
  ds_read_b64_tr_b16 v[210:211], v239 offset:6144
  v_mfma_f32_16x16x32_bf16 v[40:43], v[216:219], v[64:67], v[40:43]
  buffer_load_dwordx4 v[168:171], v253, s[24:27], s5 offen offset:2048
  buffer_load_dwordx4 v[184:187], v253, s[24:27], s6 offen offset:2048
  v_mfma_f32_16x16x32_bf16 v[44:47], v[216:219], v[80:83], v[44:47]
  buffer_load_dwordx4 v[108:111], v253, s[24:27], s4 offen offset:3072
  s_waitcnt lgkmcnt(4)
  v_mfma_f32_16x16x32_bf16 v[0:3], v[220:223], v[52:55], v[0:3]
  ds_read_b64_tr_b16 v[212:213], v236 offset:8192
  ds_read_b64_tr_b16 v[214:215], v236 offset:10240
  v_mfma_f32_16x16x32_bf16 v[4:7], v[220:223], v[68:71], v[4:7]
  buffer_load_dwordx4 v[172:175], v253, s[24:27], s5 offen offset:3072
  buffer_load_dwordx4 v[188:191], v253, s[24:27], s6 offen offset:3072
  v_mfma_f32_16x16x32_bf16 v[8:11], v[220:223], v[84:87], v[8:11]
  s_mov_b32 s72, s73
  s_mov_b32 s73, s74
  v_mfma_f32_16x16x32_bf16 v[12:15], v[224:227], v[52:55], v[12:15]
  ds_read_b64_tr_b16 v[216:217], v237 offset:8192
  ds_read_b64_tr_b16 v[218:219], v237 offset:10240
  v_mfma_f32_16x16x32_bf16 v[16:19], v[224:227], v[68:71], v[16:19]
  s_mov_b32 s74, s75
  s_mov_b32 s75, s76
  v_mfma_f32_16x16x32_bf16 v[20:23], v[224:227], v[84:87], v[20:23]
  s_mov_b32 s76, s77
  s_mov_b32 s77, s78
  s_mov_b32 s78, s79
  s_add_u32 s5, s61, s71
  s_and_b32 s5, s5, 7
  s_mul_i32 s5, s5, 36864
  s_add_u32 s5, s5, s60
  s_cmp_ge_u32 s71, s100
  s_cselect_b32 s4, 0x40000000, s5
  s_add_u32 s71, s71, 1
  s_add_u32 s5, s4, s101
  s_add_u32 s6, s5, s101
  s_waitcnt lgkmcnt(4)
  v_mfma_f32_16x16x32_bf16 v[24:27], v[204:207], v[52:55], v[24:27]
  ds_read_b64_tr_b16 v[220:221], v238 offset:8192
  ds_read_b64_tr_b16 v[222:223], v238 offset:10240
  v_mfma_f32_16x16x32_bf16 v[28:31], v[204:207], v[68:71], v[28:31]
  buffer_load_dwordx4 v[120:123], v253, s[24:27], s4 offen
  buffer_load_dwordx4 v[136:139], v253, s[24:27], s5 offen
  v_mfma_f32_16x16x32_bf16 v[32:35], v[204:207], v[84:87], v[32:35]
  buffer_load_dwordx4 v[152:155], v253, s[24:27], s6 offen
  buffer_load_dwordx4 v[124:127], v253, s[24:27], s4 offen offset:1024
  v_mfma_f32_16x16x32_bf16 v[36:39], v[208:211], v[52:55], v[36:39]
  ds_read_b64_tr_b16 v[204:205], v239 offset:8192
  ds_read_b64_tr_b16 v[206:207], v239 offset:10240
  v_mfma_f32_16x16x32_bf16 v[40:43], v[208:211], v[68:71], v[40:43]
  buffer_load_dwordx4 v[140:143], v253, s[24:27], s5 offen offset:1024
  buffer_load_dwordx4 v[156:159], v253, s[24:27], s6 offen offset:1024
  v_mfma_f32_16x16x32_bf16 v[44:47], v[208:211], v[84:87], v[44:47]
  buffer_load_dwordx4 v[128:131], v253, s[24:27], s4 offen offset:2048
  s_waitcnt lgkmcnt(4)
  v_mfma_f32_16x16x32_bf16 v[0:3], v[212:215], v[56:59], v[0:3]
  ds_read_b64_tr_b16 v[208:209], v236 offset:12288
  ds_read_b64_tr_b16 v[210:211], v236 offset:14336
  v_mfma_f32_16x16x32_bf16 v[4:7], v[212:215], v[72:75], v[4:7]
  buffer_load_dwordx4 v[144:147], v253, s[24:27], s5 offen offset:2048
  buffer_load_dwordx4 v[160:163], v253, s[24:27], s6 offen offset:2048
  v_mfma_f32_16x16x32_bf16 v[8:11], v[212:215], v[88:91], v[8:11]
  buffer_load_dwordx4 v[132:135], v253, s[24:27], s4 offen offset:3072
  buffer_load_dwordx4 v[148:151], v253, s[24:27], s5 offen offset:3072
  v_mfma_f32_16x16x32_bf16 v[12:15], v[216:219], v[56:59], v[12:15]
  ds_read_b64_tr_b16 v[212:213], v237 offset:12288
  ds_read_b64_tr_b16 v[214:215], v237 offset:14336
  v_mfma_f32_16x16x32_bf16 v[16:19], v[216:219], v[72:75], v[16:19]
  buffer_load_dwordx4 v[164:167], v253, s[24:27], s6 offen offset:3072
  s_add_u32 s5, s61, s71
  v_mfma_f32_16x16x32_bf16 v[20:23], v[216:219], v[88:91], v[20:23]
  s_and_b32 s5, s5, 7
  s_waitcnt lgkmcnt(4)
  v_mfma_f32_16x16x32_bf16 v[24:27], v[220:223], v[56:59], v[24:27]
  ds_read_b64_tr_b16 v[216:217], v238 offset:12288
  ds_read_b64_tr_b16 v[218:219], v238 offset:14336
  v_mfma_f32_16x16x32_bf16 v[28:31], v[220:223], v[72:75], v[28:31]
  s_mul_i32 s5, s5, 36864
  s_add_u32 s5, s5, s60
  v_mfma_f32_16x16x32_bf16 v[32:35], v[220:223], v[88:91], v[32:35]
  s_cmp_ge_u32 s71, s100
  s_cselect_b32 s4, 0x40000000, s5
  v_mfma_f32_16x16x32_bf16 v[36:39], v[204:207], v[56:59], v[36:39]
  ds_read_b64_tr_b16 v[220:221], v239 offset:12288
  ds_read_b64_tr_b16 v[222:223], v239 offset:14336
  v_mfma_f32_16x16x32_bf16 v[40:43], v[204:207], v[72:75], v[40:43]
  s_add_u32 s71, s71, 1
  s_add_u32 s5, s4, s101
  v_mfma_f32_16x16x32_bf16 v[44:47], v[204:207], v[88:91], v[44:47]
  s_add_u32 s6, s5, s101
  s_waitcnt lgkmcnt(4)
  v_mfma_f32_16x16x32_bf16 v[0:3], v[208:211], v[60:63], v[0:3]
  v_add_u32 v236, s72, v232
  ds_read_b64_tr_b16 v[204:205], v236 offset:0
  ds_read_b64_tr_b16 v[206:207], v236 offset:2048
  v_mfma_f32_16x16x32_bf16 v[4:7], v[208:211], v[76:79], v[4:7]
  buffer_load_dwordx4 v[48:51], v253, s[24:27], s4 offen
  v_mfma_f32_16x16x32_bf16 v[8:11], v[208:211], v[92:95], v[8:11]
  v_mfma_f32_16x16x32_bf16 v[12:15], v[212:215], v[60:63], v[12:15]
  v_add_u32 v237, s72, v233
  ds_read_b64_tr_b16 v[208:209], v237 offset:0
  ds_read_b64_tr_b16 v[210:211], v237 offset:2048
  v_mfma_f32_16x16x32_bf16 v[16:19], v[212:215], v[76:79], v[16:19]
  buffer_load_dwordx4 v[64:67], v253, s[24:27], s5 offen
  v_mfma_f32_16x16x32_bf16 v[20:23], v[212:215], v[92:95], v[20:23]
  s_waitcnt lgkmcnt(4)
  v_mfma_f32_16x16x32_bf16 v[24:27], v[216:219], v[60:63], v[24:27]
  v_add_u32 v238, s72, v234
  ds_read_b64_tr_b16 v[212:213], v238 offset:0
  ds_read_b64_tr_b16 v[214:215], v238 offset:2048
  v_mfma_f32_16x16x32_bf16 v[28:31], v[216:219], v[76:79], v[28:31]
  buffer_load_dwordx4 v[80:83], v253, s[24:27], s6 offen
  v_mfma_f32_16x16x32_bf16 v[32:35], v[216:219], v[92:95], v[32:35]
  v_mfma_f32_16x16x32_bf16 v[36:39], v[220:223], v[60:63], v[36:39]
  v_add_u32 v239, s72, v235
  ds_read_b64_tr_b16 v[216:217], v239 offset:0
  ds_read_b64_tr_b16 v[218:219], v239 offset:2048
  v_mfma_f32_16x16x32_bf16 v[40:43], v[220:223], v[76:79], v[40:43]
  buffer_load_dwordx4 v[52:55], v253, s[24:27], s4 offen offset:1024
  v_mfma_f32_16x16x32_bf16 v[44:47], v[220:223], v[92:95], v[44:47]
  buffer_load_dwordx4 v[68:71], v253, s[24:27], s5 offen offset:1024
  buffer_load_dwordx4 v[84:87], v253, s[24:27], s6 offen offset:1024
  buffer_load_dwordx4 v[56:59], v253, s[24:27], s4 offen offset:2048
  buffer_load_dwordx4 v[72:75], v253, s[24:27], s5 offen offset:2048
  buffer_load_dwordx4 v[88:91], v253, s[24:27], s6 offen offset:2048
  buffer_load_dwordx4 v[60:63], v253, s[24:27], s4 offen offset:3072
  buffer_load_dwordx4 v[76:79], v253, s[24:27], s5 offen offset:3072
  buffer_load_dwordx4 v[92:95], v253, s[24:27], s6 offen offset:3072
  s_branch L_op3_2
L_own3:
  v_add_u32 v236, s72, v232
  ds_read_b64_tr_b16 v[204:205], v236 offset:0
  ds_read_b64_tr_b16 v[206:207], v236 offset:2048
  v_add_u32 v237, s72, v233
  ds_read_b64_tr_b16 v[208:209], v237 offset:0
  ds_read_b64_tr_b16 v[210:211], v237 offset:2048
  v_add_u32 v238, s72, v234
  ds_read_b64_tr_b16 v[212:213], v238 offset:0
  ds_read_b64_tr_b16 v[214:215], v238 offset:2048
  v_add_u32 v239, s72, v235
  ds_read_b64_tr_b16 v[216:217], v239 offset:0
  ds_read_b64_tr_b16 v[218:219], v239 offset:2048
  s_waitcnt lgkmcnt(4)
  v_mfma_f32_16x16x32_bf16 v[0:3], v[204:207], v[120:123], v[0:3]
  ds_read_b64_tr_b16 v[220:221], v236 offset:4096
  ds_read_b64_tr_b16 v[222:223], v236 offset:6144
  v_mfma_f32_16x16x32_bf16 v[4:7], v[204:207], v[136:139], v[4:7]
  v_mfma_f32_16x16x32_bf16 v[8:11], v[204:207], v[152:155], v[8:11]
  v_mfma_f32_16x16x32_bf16 v[12:15], v[208:211], v[120:123], v[12:15]
  ds_read_b64_tr_b16 v[224:225], v237 offset:4096
  ds_read_b64_tr_b16 v[226:227], v237 offset:6144
  v_mfma_f32_16x16x32_bf16 v[16:19], v[208:211], v[136:139], v[16:19]
  v_mfma_f32_16x16x32_bf16 v[20:23], v[208:211], v[152:155], v[20:23]
  s_waitcnt lgkmcnt(4)
  v_mfma_f32_16x16x32_bf16 v[24:27], v[212:215], v[120:123], v[24:27]
  ds_read_b64_tr_b16 v[204:205], v238 offset:4096
  ds_read_b64_tr_b16 v[206:207], v238 offset:6144
  v_mfma_f32_16x16x32_bf16 v[28:31], v[212:215], v[136:139], v[28:31]
  v_mfma_f32_16x16x32_bf16 v[32:35], v[212:215], v[152:155], v[32:35]
  s_mov_b32 s72, s73
  s_mov_b32 s73, s74
  v_mfma_f32_16x16x32_bf16 v[36:39], v[216:219], v[120:123], v[36:39]
  ds_read_b64_tr_b16 v[208:209], v239 offset:4096
  ds_read_b64_tr_b16 v[210:211], v239 offset:6144
  v_mfma_f32_16x16x32_bf16 v[40:43], v[216:219], v[136:139], v[40:43]
  s_mov_b32 s74, s75
  s_mov_b32 s75, s76
  v_mfma_f32_16x16x32_bf16 v[44:47], v[216:219], v[152:155], v[44:47]
  s_mov_b32 s76, s77
  s_waitcnt lgkmcnt(4)
  v_mfma_f32_16x16x32_bf16 v[0:3], v[220:223], v[124:127], v[0:3]
  ds_read_b64_tr_b16 v[212:213], v236 offset:8192
  ds_read_b64_tr_b16 v[214:215], v236 offset:10240
  v_mfma_f32_16x16x32_bf16 v[4:7], v[220:223], v[140:143], v[4:7]
  s_mov_b32 s77, s78
  s_mov_b32 s78, s79
  v_mfma_f32_16x16x32_bf16 v[8:11], v[220:223], v[156:159], v[8:11]
  v_mfma_f32_16x16x32_bf16 v[12:15], v[224:227], v[124:127], v[12:15]
  ds_read_b64_tr_b16 v[216:217], v237 offset:8192
  ds_read_b64_tr_b16 v[218:219], v237 offset:10240
  v_mfma_f32_16x16x32_bf16 v[16:19], v[224:227], v[140:143], v[16:19]
  v_mfma_f32_16x16x32_bf16 v[20:23], v[224:227], v[156:159], v[20:23]
  s_waitcnt lgkmcnt(4)
  v_mfma_f32_16x16x32_bf16 v[24:27], v[204:207], v[124:127], v[24:27]
  ds_read_b64_tr_b16 v[220:221], v238 offset:8192
  ds_read_b64_tr_b16 v[222:223], v238 offset:10240
  v_mfma_f32_16x16x32_bf16 v[28:31], v[204:207], v[140:143], v[28:31]
  v_mfma_f32_16x16x32_bf16 v[32:35], v[204:207], v[156:159], v[32:35]
  v_mfma_f32_16x16x32_bf16 v[36:39], v[208:211], v[124:127], v[36:39]
  ds_read_b64_tr_b16 v[204:205], v239 offset:8192
  ds_read_b64_tr_b16 v[206:207], v239 offset:10240
  v_mfma_f32_16x16x32_bf16 v[40:43], v[208:211], v[140:143], v[40:43]
  v_mfma_f32_16x16x32_bf16 v[44:47], v[208:211], v[156:159], v[44:47]
  s_waitcnt lgkmcnt(4)
  v_mfma_f32_16x16x32_bf16 v[0:3], v[212:215], v[128:131], v[0:3]
  ds_read_b64_tr_b16 v[208:209], v236 offset:12288
  ds_read_b64_tr_b16 v[210:211], v236 offset:14336
  v_mfma_f32_16x16x32_bf16 v[4:7], v[212:215], v[144:147], v[4:7]
  v_mfma_f32_16x16x32_bf16 v[8:11], v[212:215], v[160:163], v[8:11]
  v_mfma_f32_16x16x32_bf16 v[12:15], v[216:219], v[128:131], v[12:15]
  ds_read_b64_tr_b16 v[212:213], v237 offset:12288
  ds_read_b64_tr_b16 v[214:215], v237 offset:14336
  v_mfma_f32_16x16x32_bf16 v[16:19], v[216:219], v[144:147], v[16:19]
  v_mfma_f32_16x16x32_bf16 v[20:23], v[216:219], v[160:163], v[20:23]
  s_waitcnt lgkmcnt(4)
  v_mfma_f32_16x16x32_bf16 v[24:27], v[220:223], v[128:131], v[24:27]
  ds_read_b64_tr_b16 v[216:217], v238 offset:12288
  ds_read_b64_tr_b16 v[218:219], v238 offset:14336
  v_mfma_f32_16x16x32_bf16 v[28:31], v[220:223], v[144:147], v[28:31]
  v_mfma_f32_16x16x32_bf16 v[32:35], v[220:223], v[160:163], v[32:35]
  v_mfma_f32_16x16x32_bf16 v[36:39], v[204:207], v[128:131], v[36:39]
  ds_read_b64_tr_b16 v[220:221], v239 offset:12288
  ds_read_b64_tr_b16 v[222:223], v239 offset:14336
  v_mfma_f32_16x16x32_bf16 v[40:43], v[204:207], v[144:147], v[40:43]
  v_mfma_f32_16x16x32_bf16 v[44:47], v[204:207], v[160:163], v[44:47]
  s_waitcnt lgkmcnt(4)
  v_mfma_f32_16x16x32_bf16 v[0:3], v[208:211], v[132:135], v[0:3]
  v_add_u32 v236, s72, v232
  ds_read_b64_tr_b16 v[204:205], v236 offset:0
  ds_read_b64_tr_b16 v[206:207], v236 offset:2048
  v_mfma_f32_16x16x32_bf16 v[4:7], v[208:211], v[148:151], v[4:7]
  v_mfma_f32_16x16x32_bf16 v[8:11], v[208:211], v[164:167], v[8:11]
  v_mfma_f32_16x16x32_bf16 v[12:15], v[212:215], v[132:135], v[12:15]
  v_add_u32 v237, s72, v233
  ds_read_b64_tr_b16 v[208:209], v237 offset:0
  ds_read_b64_tr_b16 v[210:211], v237 offset:2048
  v_mfma_f32_16x16x32_bf16 v[16:19], v[212:215], v[148:151], v[16:19]
  v_mfma_f32_16x16x32_bf16 v[20:23], v[212:215], v[164:167], v[20:23]
  s_waitcnt lgkmcnt(4)
  v_mfma_f32_16x16x32_bf16 v[24:27], v[216:219], v[132:135], v[24:27]
  v_add_u32 v238, s72, v234
  ds_read_b64_tr_b16 v[212:213], v238 offset:0
  ds_read_b64_tr_b16 v[214:215], v238 offset:2048
  v_mfma_f32_16x16x32_bf16 v[28:31], v[216:219], v[148:151], v[28:31]
  v_mfma_f32_16x16x32_bf16 v[32:35], v[216:219], v[164:167], v[32:35]
  v_mfma_f32_16x16x32_bf16 v[36:39], v[220:223], v[132:135], v[36:39]
  v_add_u32 v239, s72, v235
  ds_read_b64_tr_b16 v[216:217], v239 offset:0
  ds_read_b64_tr_b16 v[218:219], v239 offset:2048
  v_mfma_f32_16x16x32_bf16 v[40:43], v[220:223], v[148:151], v[40:43]
  v_mfma_f32_16x16x32_bf16 v[44:47], v[220:223], v[164:167], v[44:47]
  s_setpc_b64 s[92:93]
L_op3_0:
  s_waitcnt vmcnt(24)
  s_waitcnt lgkmcnt(4)
  v_mfma_f32_16x16x32_bf16 v[0:3], v[204:207], v[120:123], v[0:3]
  ds_read_b64_tr_b16 v[220:221], v236 offset:4096
  ds_read_b64_tr_b16 v[222:223], v236 offset:6144
  v_mfma_f32_16x16x32_bf16 v[4:7], v[204:207], v[136:139], v[4:7]
  s_add_u32 s5, s61, s71
  s_and_b32 s5, s5, 7
  v_mfma_f32_16x16x32_bf16 v[8:11], v[204:207], v[152:155], v[8:11]
  s_mul_i32 s5, s5, 36864
  s_add_u32 s5, s5, s60
  v_mfma_f32_16x16x32_bf16 v[12:15], v[208:211], v[120:123], v[12:15]
  ds_read_b64_tr_b16 v[224:225], v237 offset:4096
  ds_read_b64_tr_b16 v[226:227], v237 offset:6144
  v_mfma_f32_16x16x32_bf16 v[16:19], v[208:211], v[136:139], v[16:19]
  s_cmp_ge_u32 s71, s100
  s_cselect_b32 s4, 0x40000000, s5
  v_mfma_f32_16x16x32_bf16 v[20:23], v[208:211], v[152:155], v[20:23]
  s_add_u32 s71, s71, 1
  s_waitcnt lgkmcnt(4)
  v_mfma_f32_16x16x32_bf16 v[24:27], v[212:215], v[120:123], v[24:27]
  ds_read_b64_tr_b16 v[204:205], v238 offset:4096
  ds_read_b64_tr_b16 v[206:207], v238 offset:6144
  v_mfma_f32_16x16x32_bf16 v[28:31], v[212:215], v[136:139], v[28:31]
  s_add_u32 s5, s4, s101
  s_add_u32 s6, s5, s101
  v_mfma_f32_16x16x32_bf16 v[32:35], v[212:215], v[152:155], v[32:35]
  s_mov_b32 s72, s73
  s_mov_b32 s73, s74
  v_mfma_f32_16x16x32_bf16 v[36:39], v[216:219], v[120:123], v[36:39]
  ds_read_b64_tr_b16 v[208:209], v239 offset:4096
  ds_read_b64_tr_b16 v[210:211], v239 offset:6144
  v_mfma_f32_16x16x32_bf16 v[40:43], v[216:219], v[136:139], v[40:43]
  s_mov_b32 s74, s75
  s_mov_b32 s75, s76
  v_mfma_f32_16x16x32_bf16 v[44:47], v[216:219], v[152:155], v[44:47]
  s_mov_b32 s76, s77
  s_waitcnt lgkmcnt(4)
  v_mfma_f32_16x16x32_bf16 v[0:3], v[220:223], v[124:127], v[0:3]
  ds_read_b64_tr_b16 v[212:213], v236 offset:8192
  ds_read_b64_tr_b16 v[214:215], v236 offset:10240
  v_mfma_f32_16x16x32_bf16 v[4:7], v[220:223], v[140:143], v[4:7]
  s_mov_b32 s77, s78
  s_mov_b32 s78, s79
  v_mfma_f32_16x16x32_bf16 v[8:11], v[220:223], v[156:159], v[8:11]
  buffer_load_dwordx4 v[120:123], v253, s[24:27], s4 offen
  v_mfma_f32_16x16x32_bf16 v[12:15], v[224:227], v[124:127], v[12:15]
  ds_read_b64_tr_b16 v[216:217], v237 offset:8192
  ds_read_b64_tr_b16 v[218:219], v237 offset:10240
  v_mfma_f32_16x16x32_bf16 v[16:19], v[224:227], v[140:143], v[16:19]
  buffer_load_dwordx4 v[136:139], v253, s[24:27], s5 offen
  v_mfma_f32_16x16x32_bf16 v[20:23], v[224:227], v[156:159], v[20:23]
  s_waitcnt lgkmcnt(4)
  v_mfma_f32_16x16x32_bf16 v[24:27], v[204:207], v[124:127], v[24:27]
  ds_read_b64_tr_b16 v[220:221], v238 offset:8192
  ds_read_b64_tr_b16 v[222:223], v238 offset:10240
  v_mfma_f32_16x16x32_bf16 v[28:31], v[204:207], v[140:143], v[28:31]
  buffer_load_dwordx4 v[152:155], v253, s[24:27], s6 offen
  v_mfma_f32_16x16x32_bf16 v[32:35], v[204:207], v[156:159], v[32:35]
  v_mfma_f32_16x16x32_bf16 v[36:39], v[208:211], v[124:127], v[36:39]
  ds_read_b64_tr_b16 v[204:205], v239 offset:8192
  ds_read_b64_tr_b16 v[206:207], v239 offset:10240
  v_mfma_f32_16x16x32_bf16 v[40:43], v[208:211], v[140:143], v[40:43]
  buffer_load_dwordx4 v[124:127], v253, s[24:27], s4 offen offset:1024
  v_mfma_f32_16x16x32_bf16 v[44:47], v[208:211], v[156:159], v[44:47]
  s_waitcnt lgkmcnt(4)
  v_mfma_f32_16x16x32_bf16 v[0:3], v[212:215], v[128:131], v[0:3]
  ds_read_b64_tr_b16 v[208:209], v236 offset:12288
  ds_read_b64_tr_b16 v[210:211], v236 offset:14336
  v_mfma_f32_16x16x32_bf16 v[4:7], v[212:215], v[144:147], v[4:7]
  buffer_load_dwordx4 v[140:143], v253, s[24:27], s5 offen offset:1024
  v_mfma_f32_16x16x32_bf16 v[8:11], v[212:215], v[160:163], v[8:11]
  v_mfma_f32_16x16x32_bf16 v[12:15], v[216:219], v[128:131], v[12:15]
  ds_read_b64_tr_b16 v[212:213], v237 offset:12288
  ds_read_b64_tr_b16 v[214:215], v237 offset:14336
  v_mfma_f32_16x16x32_bf16 v[16:19], v[216:219], v[144:147], v[16:19]
  buffer_load_dwordx4 v[156:159], v253, s[24:27], s6 offen offset:1024
  v_mfma_f32_16x16x32_bf16 v[20:23], v[216:219], v[160:163], v[20:23]
  s_waitcnt lgkmcnt(4)
  v_mfma_f32_16x16x32_bf16 v[24:27], v[220:223], v[128:131], v[24:27]
  ds_read_b64_tr_b16 v[216:217], v238 offset:12288
  ds_read_b64_tr_b16 v[218:219], v238 offset:14336
  v_mfma_f32_16x16x32_bf16 v[28:31], v[220:223], v[144:147], v[28:31]
  v_mfma_f32_16x16x32_bf16 v[32:35], v[220:223], v[160:163], v[32:35]
  v_mfma_f32_16x16x32_bf16 v[36:39], v[204:207], v[128:131], v[36:39]
  ds_read_b64_tr_b16 v[220:221], v239 offset:12288
  ds_read_b64_tr_b16 v[222:223], v239 offset:14336
  v_mfma_f32_16x16x32_bf16 v[40:43], v[204:207], v[144:147], v[40:43]
  buffer_load_dwordx4 v[128:131], v253, s[24:27], s4 offen offset:2048
  v_mfma_f32_16x16x32_bf16 v[44:47], v[204:207], v[160:163], v[44:47]
  s_waitcnt lgkmcnt(4)
  v_mfma_f32_16x16x32_bf16 v[0:3], v[208:211], v[132:135], v[0:3]
  v_add_u32 v236, s72, v232
  ds_read_b64_tr_b16 v[204:205], v236 offset:0
  ds_read_b64_tr_b16 v[206:207], v236 offset:2048
  v_mfma_f32_16x16x32_bf16 v[4:7], v[208:211], v[148:151], v[4:7]
  buffer_load_dwordx4 v[144:147], v253, s[24:27], s5 offen offset:2048
  v_mfma_f32_16x16x32_bf16 v[8:11], v[208:211], v[164:167], v[8:11]
  v_mfma_f32_16x16x32_bf16 v[12:15], v[212:215], v[132:135], v[12:15]
  v_add_u32 v237, s72, v233
  ds_read_b64_tr_b16 v[208:209], v237 offset:0
  ds_read_b64_tr_b16 v[210:211], v237 offset:2048
  v_mfma_f32_16x16x32_bf16 v[16:19], v[212:215], v[148:151], v[16:19]
  buffer_load_dwordx4 v[160:163], v253, s[24:27], s6 offen offset:2048
  v_mfma_f32_16x16x32_bf16 v[20:23], v[212:215], v[164:167], v[20:23]
  s_waitcnt lgkmcnt(4)
  v_mfma_f32_16x16x32_bf16 v[24:27], v[216:219], v[132:135], v[24:27]
  v_add_u32 v238, s72, v234
  ds_read_b64_tr_b16 v[212:213], v238 offset:0
  ds_read_b64_tr_b16 v[214:215], v238 offset:2048
  v_mfma_f32_16x16x32_bf16 v[28:31], v[216:219], v[148:151], v[28:31]
  v_mfma_f32_16x16x32_bf16 v[32:35], v[216:219], v[164:167], v[32:35]
  v_mfma_f32_16x16x32_bf16 v[36:39], v[220:223], v[132:135], v[36:39]
  v_add_u32 v239, s72, v235
  ds_read_b64_tr_b16 v[216:217], v239 offset:0
  ds_read_b64_tr_b16 v[218:219], v239 offset:2048
  v_mfma_f32_16x16x32_bf16 v[40:43], v[220:223], v[148:151], v[40:43]
  buffer_load_dwordx4 v[132:135], v253, s[24:27], s4 offen offset:3072
  v_mfma_f32_16x16x32_bf16 v[44:47], v[220:223], v[164:167], v[44:47]
  buffer_load_dwordx4 v[148:151], v253, s[24:27], s5 offen offset:3072
  buffer_load_dwordx4 v[164:167], v253, s[24:27], s6 offen offset:3072
  s_add_u32 s70, s70, 1
  s_cmp_eq_u32 s70, 8
  s_cbranch_scc1 L_fin2
L_op3_1:
  s_waitcnt vmcnt(24)
  s_waitcnt lgkmcnt(4)
  v_mfma_f32_16x16x32_bf16 v[0:3], v[204:207], v[48:51], v[0:3]
  ds_read_b64_tr_b16 v[220:221], v236 offset:4096
  ds_read_b64_tr_b16 v[222:223], v236 offset:6144
  v_mfma_f32_16x16x32_bf16 v[4:7], v[204:207], v[64:67], v[4:7]
  s_add_u32 s5, s61, s71
  s_and_b32 s5, s5, 7
  v_mfma_f32_16x16x32_bf16 v[8:11], v[204:207], v[80:83], v[8:11]
  s_mul_i32 s5, s5, 36864
  s_add_u32 s5, s5, s60
  v_mfma_f32_16x16x32_bf16 v[12:15], v[208:211], v[48:51], v[12:15]
  ds_read_b64_tr_b16 v[224:225], v237 offset:4096
  ds_read_b64_tr_b16 v[226:227], v237 offset:6144
  v_mfma_f32_16x16x32_bf16 v[16:19], v[208:211], v[64:67], v[16:19]
  s_cmp_ge_u32 s71, s100
  s_cselect_b32 s4, 0x40000000, s5
  v_mfma_f32_16x16x32_bf16 v[20:23], v[208:211], v[80:83], v[20:23]
  s_add_u32 s71, s71, 1
  s_waitcnt lgkmcnt(4)
  v_mfma_f32_16x16x32_bf16 v[24:27], v[212:215], v[48:51], v[24:27]
  ds_read_b64_tr_b16 v[204:205], v238 offset:4096
  ds_read_b64_tr_b16 v[206:207], v238 offset:6144
  v_mfma_f32_16x16x32_bf16 v[28:31], v[212:215], v[64:67], v[28:31]
  s_add_u32 s5, s4, s101
  s_add_u32 s6, s5, s101
  v_mfma_f32_16x16x32_bf16 v[32:35], v[212:215], v[80:83], v[32:35]
  s_mov_b32 s72, s73
  s_mov_b32 s73, s74
  v_mfma_f32_16x16x32_bf16 v[36:39], v[216:219], v[48:51], v[36:39]
  ds_read_b64_tr_b16 v[208:209], v239 offset:4096
  ds_read_b64_tr_b16 v[210:211], v239 offset:6144
  v_mfma_f32_16x16x32_bf16 v[40:43], v[216:219], v[64:67], v[40:43]
  s_mov_b32 s74, s75
  s_mov_b32 s75, s76
  v_mfma_f32_16x16x32_bf16 v[44:47], v[216:219], v[80:83], v[44:47]
  s_mov_b32 s76, s77
  s_waitcnt lgkmcnt(4)
  v_mfma_f32_16x16x32_bf16 v[0:3], v[220:223], v[52:55], v[0:3]
  ds_read_b64_tr_b16 v[212:213], v236 offset:8192
  ds_read_b64_tr_b16 v[214:215], v236 offset:10240
  v_mfma_f32_16x16x32_bf16 v[4:7], v[220:223], v[68:71], v[4:7]
  s_mov_b32 s77, s78
  s_mov_b32 s78, s79
  v_mfma_f32_16x16x32_bf16 v[8:11], v[220:223], v[84:87], v[8:11]
  buffer_load_dwordx4 v[48:51], v253, s[24:27], s4 offen
  v_mfma_f32_16x16x32_bf16 v[12:15], v[224:227], v[52:55], v[12:15]
  ds_read_b64_tr_b16 v[216:217], v237 offset:8192
  ds_read_b64_tr_b16 v[218:219], v237 offset:10240
  v_mfma_f32_16x16x32_bf16 v[16:19], v[224:227], v[68:71], v[16:19]
  buffer_load_dwordx4 v[64:67], v253, s[24:27], s5 offen
  v_mfma_f32_16x16x32_bf16 v[20:23], v[224:227], v[84:87], v[20:23]
  s_waitcnt lgkmcnt(4)
  v_mfma_f32_16x16x32_bf16 v[24:27], v[204:207], v[52:55], v[24:27]
  ds_read_b64_tr_b16 v[220:221], v238 offset:8192
  ds_read_b64_tr_b16 v[222:223], v238 offset:10240
  v_mfma_f32_16x16x32_bf16 v[28:31], v[204:207], v[68:71], v[28:31]
  buffer_load_dwordx4 v[80:83], v253, s[24:27], s6 offen
  v_mfma_f32_16x16x32_bf16 v[32:35], v[204:207], v[84:87], v[32:35]
  v_mfma_f32_16x16x32_bf16 v[36:39], v[208:211], v[52:55], v[36:39]
  ds_read_b64_tr_b16 v[204:205], v239 offset:8192
  ds_read_b64_tr_b16 v[206:207], v239 offset:10240
  v_mfma_f32_16x16x32_bf16 v[40:43], v[208:211], v[68:71], v[40:43]
  buffer_load_dwordx4 v[52:55], v253, s[24:27], s4 offen offset:1024
  v_mfma_f32_16x16x32_bf16 v[44:47], v[208:211], v[84:87], v[44:47]
  s_waitcnt lgkmcnt(4)
  v_mfma_f32_16x16x32_bf16 v[0:3], v[212:215], v[56:59], v[0:3]
  ds_read_b64_tr_b16 v[208:209], v236 offset:12288
  ds_read_b64_tr_b16 v[210:211], v236 offset:14336
  v_mfma_f32_16x16x32_bf16 v[4:7], v[212:215], v[72:75], v[4:7]
  buffer_load_dwordx4 v[68:71], v253, s[24:27], s5 offen offset:1024
  v_mfma_f32_16x16x32_bf16 v[8:11], v[212:215], v[88:91], v[8:11]
  v_mfma_f32_16x16x32_bf16 v[12:15], v[216:219], v[56:59], v[12:15]
  ds_read_b64_tr_b16 v[212:213], v237 offset:12288
  ds_read_b64_tr_b16 v[214:215], v237 offset:14336
  v_mfma_f32_16x16x32_bf16 v[16:19], v[216:219], v[72:75], v[16:19]
  buffer_load_dwordx4 v[84:87], v253, s[24:27], s6 offen offset:1024
  v_mfma_f32_16x16x32_bf16 v[20:23], v[216:219], v[88:91], v[20:23]
  s_waitcnt lgkmcnt(4)
  v_mfma_f32_16x16x32_bf16 v[24:27], v[220:223], v[56:59], v[24:27]
  ds_read_b64_tr_b16 v[216:217], v238 offset:12288
  ds_read_b64_tr_b16 v[218:219], v238 offset:14336
  v_mfma_f32_16x16x32_bf16 v[28:31], v[220:223], v[72:75], v[28:31]
  v_mfma_f32_16x16x32_bf16 v[32:35], v[220:223], v[88:91], v[32:35]
  v_mfma_f32_16x16x32_bf16 v[36:39], v[204:207], v[56:59], v[36:39]
  ds_read_b64_tr_b16 v[220:221], v239 offset:12288
  ds_read_b64_tr_b16 v[222:223], v239 offset:14336
  v_mfma_f32_16x16x32_bf16 v[40:43], v[204:207], v[72:75], v[40:43]
  buffer_load_dwordx4 v[56:59], v253, s[24:27], s4 offen offset:2048
  v_mfma_f32_16x16x32_bf16 v[44:47], v[204:207], v[88:91], v[44:47]
  s_waitcnt lgkmcnt(4)
  v_mfma_f32_16x16x32_bf16 v[0:3], v[208:211], v[60:63], v[0:3]
  v_add_u32 v236, s72, v232
  ds_read_b64_tr_b16 v[204:205], v236 offset:0
  ds_read_b64_tr_b16 v[206:207], v236 offset:2048
  v_mfma_f32_16x16x32_bf16 v[4:7], v[208:211], v[76:79], v[4:7]
  buffer_load_dwordx4 v[72:75], v253, s[24:27], s5 offen offset:2048
  v_mfma_f32_16x16x32_bf16 v[8:11], v[208:211], v[92:95], v[8:11]
  v_mfma_f32_16x16x32_bf16 v[12:15], v[212:215], v[60:63], v[12:15]
  v_add_u32 v237, s72, v233
  ds_read_b64_tr_b16 v[208:209], v237 offset:0
  ds_read_b64_tr_b16 v[210:211], v237 offset:2048
  v_mfma_f32_16x16x32_bf16 v[16:19], v[212:215], v[76:79], v[16:19]
  buffer_load_dwordx4 v[88:91], v253, s[24:27], s6 offen offset:2048
  v_mfma_f32_16x16x32_bf16 v[20:23], v[212:215], v[92:95], v[20:23]
  s_waitcnt lgkmcnt(4)
  v_mfma_f32_16x16x32_bf16 v[24:27], v[216:219], v[60:63], v[24:27]
  v_add_u32 v238, s72, v234
  ds_read_b64_tr_b16 v[212:213], v238 offset:0
  ds_read_b64_tr_b16 v[214:215], v238 offset:2048
  v_mfma_f32_16x16x32_bf16 v[28:31], v[216:219], v[76:79], v[28:31]
  v_mfma_f32_16x16x32_bf16 v[32:35], v[216:219], v[92:95], v[32:35]
  v_mfma_f32_16x16x32_bf16 v[36:39], v[220:223], v[60:63], v[36:39]
  v_add_u32 v239, s72, v235
  ds_read_b64_tr_b16 v[216:217], v239 offset:0
  ds_read_b64_tr_b16 v[218:219], v239 offset:2048
  v_mfma_f32_16x16x32_bf16 v[40:43], v[220:223], v[76:79], v[40:43]
  buffer_load_dwordx4 v[60:63], v253, s[24:27], s4 offen offset:3072
  v_mfma_f32_16x16x32_bf16 v[44:47], v[220:223], v[92:95], v[44:47]
  buffer_load_dwordx4 v[76:79], v253, s[24:27], s5 offen offset:3072
  buffer_load_dwordx4 v[92:95], v253, s[24:27], s6 offen offset:3072
  s_add_u32 s70, s70, 1
  s_cmp_eq_u32 s70, 8
  s_cbranch_scc1 L_fin2
L_op3_2:
  s_waitcnt vmcnt(24)
  s_waitcnt lgkmcnt(4)
  v_mfma_f32_16x16x32_bf16 v[0:3], v[204:207], v[96:99], v[0:3]
  ds_read_b64_tr_b16 v[220:221], v236 offset:4096
  ds_read_b64_tr_b16 v[222:223], v236 offset:6144
  v_mfma_f32_16x16x32_bf16 v[4:7], v[204:207], v[112:115], v[4:7]
  s_add_u32 s5, s61, s71
  s_and_b32 s5, s5, 7
  v_mfma_f32_16x16x32_bf16 v[8:11], v[204:207], v[176:179], v[8:11]
  s_mul_i32 s5, s5, 36864
  s_add_u32 s5, s5, s60
  v_mfma_f32_16x16x32_bf16 v[12:15], v[208:211], v[96:99], v[12:15]
  ds_read_b64_tr_b16 v[224:225], v237 offset:4096
  ds_read_b64_tr_b16 v[226:227], v237 offset:6144
  v_mfma_f32_16x16x32_bf16 v[16:19], v[208:211], v[112:115], v[16:19]
  s_cmp_ge_u32 s71, s100
  s_cselect_b32 s4, 0x40000000, s5
  v_mfma_f32_16x16x32_bf16 v[20:23], v[208:211], v[176:179], v[20:23]
  s_add_u32 s71, s71, 1
  s_waitcnt lgkmcnt(4)
  v_mfma_f32_16x16x32_bf16 v[24:27], v[212:215], v[96:99], v[24:27]
  ds_read_b64_tr_b16 v[204:205], v238 offset:4096
  ds_read_b64_tr_b16 v[206:207], v238 offset:6144
  v_mfma_f32_16x16x32_bf16 v[28:31], v[212:215], v[112:115], v[28:31]
  s_add_u32 s5, s4, s101
  s_add_u32 s6, s5, s101
  v_mfma_f32_16x16x32_bf16 v[32:35], v[212:215], v[176:179], v[32:35]
  s_mov_b32 s72, s73
  s_mov_b32 s73, s74
  v_mfma_f32_16x16x32_bf16 v[36:39], v[216:219], v[96:99], v[36:39]
  ds_read_b64_tr_b16 v[208:209], v239 offset:4096
  ds_read_b64_tr_b16 v[210:211], v239 offset:6144
  v_mfma_f32_16x16x32_bf16 v[40:43], v[216:219], v[112:115], v[40:43]
  s_mov_b32 s74, s75
  s_mov_b32 s75, s76
  v_mfma_f32_16x16x32_bf16 v[44:47], v[216:219], v[176:179], v[44:47]
  s_mov_b32 s76, s77
  s_waitcnt lgkmcnt(4)
  v_mfma_f32_16x16x32_bf16 v[0:3], v[220:223], v[100:103], v[0:3]
  ds_read_b64_tr_b16 v[212:213], v236 offset:8192
  ds_read_b64_tr_b16 v[214:215], v236 offset:10240
  v_mfma_f32_16x16x32_bf16 v[4:7], v[220:223], v[116:119], v[4:7]
  s_mov_b32 s77, s78
  s_mov_b32 s78, s79
  v_mfma_f32_16x16x32_bf16 v[8:11], v[220:223], v[180:183], v[8:11]
  buffer_load_dwordx4 v[96:99], v253, s[24:27], s4 offen
  v_mfma_f32_16x16x32_bf16 v[12:15], v[224:227], v[100:103], v[12:15]
  ds_read_b64_tr_b16 v[216:217], v237 offset:8192
  ds_read_b64_tr_b16 v[218:219], v237 offset:10240
  v_mfma_f32_16x16x32_bf16 v[16:19], v[224:227], v[116:119], v[16:19]
  buffer_load_dwordx4 v[112:115], v253, s[24:27], s5 offen
  v_mfma_f32_16x16x32_bf16 v[20:23], v[224:227], v[180:183], v[20:23]
  s_waitcnt lgkmcnt(4)
  v_mfma_f32_16x16x32_bf16 v[24:27], v[204:207], v[100:103], v[24:27]
  ds_read_b64_tr_b16 v[220:221], v238 offset:8192
  ds_read_b64_tr_b16 v[222:223], v238 offset:10240
  v_mfma_f32_16x16x32_bf16 v[28:31], v[204:207], v[116:119], v[28:31]
  buffer_load_dwordx4 v[176:179], v253, s[24:27], s6 offen
  v_mfma_f32_16x16x32_bf16 v[32:35], v[204:207], v[180:183], v[32:35]
  v_mfma_f32_16x16x32_bf16 v[36:39], v[208:211], v[100:103], v[36:39]
  ds_read_b64_tr_b16 v[204:205], v239 offset:8192
  ds_read_b64_tr_b16 v[206:207], v239 offset:10240
  v_mfma_f32_16x16x32_bf16 v[40:43], v[208:211], v[116:119], v[40:43]
  buffer_load_dwordx4 v[100:103], v253, s[24:27], s4 offen offset:1024
  v_mfma_f32_16x16x32_bf16 v[44:47], v[208:211], v[180:183], v[44:47]
  s_waitcnt lgkmcnt(4)
  v_mfma_f32_16x16x32_bf16 v[0:3], v[212:215], v[104:107], v[0:3]
  ds_read_b64_tr_b16 v[208:209], v236 offset:12288
  ds_read_b64_tr_b16 v[210:211], v236 offset:14336
  v_mfma_f32_16x16x32_bf16 v[4:7], v[212:215], v[168:171], v[4:7]
  buffer_load_dwordx4 v[116:119], v253, s[24:27], s5 offen offset:1024
  v_mfma_f32_16x16x32_bf16 v[8:11], v[212:215], v[184:187], v[8:11]
  v_mfma_f32_16x16x32_bf16 v[12:15], v[216:219], v[104:107], v[12:15]
  ds_read_b64_tr_b16 v[212:213], v237 offset:12288
  ds_read_b64_tr_b16 v[214:215], v237 offset:14336
  v_mfma_f32_16x16x32_bf16 v[16:19], v[216:219], v[168:171], v[16:19]
  buffer_load_dwordx4 v[180:183], v253, s[24:27], s6 offen offset:1024
  v_mfma_f32_16x16x32_bf16 v[20:23], v[216:219], v[184:187], v[20:23]
  s_waitcnt lgkmcnt(4)
  v_mfma_f32_16x16x32_bf16 v[24:27], v[220:223], v[104:107], v[24:27]
  ds_read_b64_tr_b16 v[216:217], v238 offset:12288
  ds_read_b64_tr_b16 v[218:219], v238 offset:14336
  v_mfma_f32_16x16x32_bf16 v[28:31], v[220:223], v[168:171], v[28:31]
  v_mfma_f32_16x16x32_bf16 v[32:35], v[220:223], v[184:187], v[32:35]
  v_mfma_f32_16x16x32_bf16 v[36:39], v[204:207], v[104:107], v[36:39]
  ds_read_b64_tr_b16 v[220:221], v239 offset:12288
  ds_read_b64_tr_b16 v[222:223], v239 offset:14336
  v_mfma_f32_16x16x32_bf16 v[40:43], v[204:207], v[168:171], v[40:43]
  buffer_load_dwordx4 v[104:107], v253, s[24:27], s4 offen offset:2048
  v_mfma_f32_16x16x32_bf16 v[44:47], v[204:207], v[184:187], v[44:47]
  s_waitcnt lgkmcnt(4)
  v_mfma_f32_16x16x32_bf16 v[0:3], v[208:211], v[108:111], v[0:3]
  v_add_u32 v236, s72, v232
  ds_read_b64_tr_b16 v[204:205], v236 offset:0
  ds_read_b64_tr_b16 v[206:207], v236 offset:2048
  v_mfma_f32_16x16x32_bf16 v[4:7], v[208:211], v[172:175], v[4:7]
  buffer_load_dwordx4 v[168:171], v253, s[24:27], s5 offen offset:2048
  v_mfma_f32_16x16x32_bf16 v[8:11], v[208:211], v[188:191], v[8:11]
  v_mfma_f32_16x16x32_bf16 v[12:15], v[212:215], v[108:111], v[12:15]
  v_add_u32 v237, s72, v233
  ds_read_b64_tr_b16 v[208:209], v237 offset:0
  ds_read_b64_tr_b16 v[210:211], v237 offset:2048
  v_mfma_f32_16x16x32_bf16 v[16:19], v[212:215], v[172:175], v[16:19]
  buffer_load_dwordx4 v[184:187], v253, s[24:27], s6 offen offset:2048
  v_mfma_f32_16x16x32_bf16 v[20:23], v[212:215], v[188:191], v[20:23]
  s_waitcnt lgkmcnt(4)
  v_mfma_f32_16x16x32_bf16 v[24:27], v[216:219], v[108:111], v[24:27]
  v_add_u32 v238, s72, v234
  ds_read_b64_tr_b16 v[212:213], v238 offset:0
  ds_read_b64_tr_b16 v[214:215], v238 offset:2048
  v_mfma_f32_16x16x32_bf16 v[28:31], v[216:219], v[172:175], v[28:31]
  v_mfma_f32_16x16x32_bf16 v[32:35], v[216:219], v[188:191], v[32:35]
  v_mfma_f32_16x16x32_bf16 v[36:39], v[220:223], v[108:111], v[36:39]
  v_add_u32 v239, s72, v235
  ds_read_b64_tr_b16 v[216:217], v239 offset:0
  ds_read_b64_tr_b16 v[218:219], v239 offset:2048
  v_mfma_f32_16x16x32_bf16 v[40:43], v[220:223], v[172:175], v[40:43]
  buffer_load_dwordx4 v[108:111], v253, s[24:27], s4 offen offset:3072
  v_mfma_f32_16x16x32_bf16 v[44:47], v[220:223], v[188:191], v[44:47]
  buffer_load_dwordx4 v[172:175], v253, s[24:27], s5 offen offset:3072
  buffer_load_dwordx4 v[188:191], v253, s[24:27], s6 offen offset:3072
  s_add_u32 s70, s70, 1
  s_cmp_eq_u32 s70, 8
  s_cbranch_scc1 L_fin2
  s_branch L_op3_0
L_tailA:
  s_barrier
  v_mov_b32 v0, 0
  v_mov_b32 v1, 0
  v_mov_b32 v2, 0
  v_mov_b32 v3, 0
  v_mov_b32 v4, 0
  v_mov_b32 v5, 0
  v_mov_b32 v6, 0
  v_mov_b32 v7, 0
  v_mov_b32 v8, 0
  v_mov_b32 v9, 0
  v_mov_b32 v10, 0
  v_mov_b32 v11, 0
  v_mov_b32 v12, 0
  v_mov_b32 v13, 0
  v_mov_b32 v14, 0
  v_mov_b32 v15, 0
  v_mov_b32 v16, 0
  v_mov_b32 v17, 0
  v_mov_b32 v18, 0
  v_mov_b32 v19, 0
  v_mov_b32 v20, 0
  v_mov_b32 v21, 0
  v_mov_b32 v22, 0
  v_mov_b32 v23, 0
  v_mov_b32 v24, 0
  v_mov_b32 v25, 0
  v_mov_b32 v26, 0
  v_mov_b32 v27, 0
  v_mov_b32 v28, 0
  v_mov_b32 v29, 0
  v_mov_b32 v30, 0
  v_mov_b32 v31, 0
  v_mov_b32 v32, 0
  v_mov_b32 v33, 0
  v_mov_b32 v34, 0
  v_mov_b32 v35, 0
  v_mov_b32 v36, 0
  v_mov_b32 v37, 0
  v_mov_b32 v38, 0
  v_mov_b32 v39, 0
  v_mov_b32 v40, 0
  v_mov_b32 v41, 0
  v_mov_b32 v42, 0
  v_mov_b32 v43, 0
  v_mov_b32 v44, 0
  v_mov_b32 v45, 0
  v_mov_b32 v46, 0
  v_mov_b32 v47, 0
  s_barrier
  s_load_dword s58, s[56:57], 0
  s_mov_b32 s63, 0x40000
  s_waitcnt lgkmcnt(0)
L_tagA:
  s_cmp_lg_u32 s58, 0
  s_cbranch_scc1 L_tagxA
  s_atomic_or s58, s[56:57], 0 glc
  s_sub_u32 s63, s63, 1
  s_cmp_lg_u32 s63, 0
  s_waitcnt lgkmcnt(0)
  s_cbranch_scc1 L_tagA
L_tagxA:
  s_not_b32 s59, s58
  s_and_b32 s4, s2, 7
  s_lshl_b32 s4, s4, 2
  s_add_u32 s4, s4, s31
  s_lshl_b32 s4, s4, 7
  s_add_u32 s87, s4, 48365568
  s_getreg_b32 s4, hwreg(HW_REG_XCC_ID, 0, 4)
  s_xor_b32 s83, s59, s4
  v_and_b32 v241, 112, v253
  v_lshrrev_b32 v241, 1, v241
  buffer_load_dwordx2 v[244:245], v241, s[24:27], s87 offen sc1
  s_barrier
  s_barrier
  s_waitcnt vmcnt(0)
  v_cmp_eq_u32 vcc, s58, v244
  v_cmp_eq_u32 s[4:5], s83, v245
  s_nop 3
  s_and_b64 vcc, vcc, s[4:5]
  s_cmp_eq_u64 vcc, exec
  s_cselect_b32 s3, 1, 0
  s_barrier
  s_barrier
  s_barrier
  s_cmp_eq_u32 s3, 0
  s_cbranch_scc1 L_bS1
  buffer_store_dwordx4 v[120:123], v253, s[24:27], s44 offen
  buffer_store_dwordx4 v[124:127], v253, s[24:27], s44 offen offset:1024
  buffer_store_dwordx4 v[128:131], v253, s[24:27], s44 offen offset:2048
  buffer_store_dwordx4 v[132:135], v253, s[24:27], s44 offen offset:3072
  buffer_store_dwordx4 v[136:139], v253, s[24:27], s41 offen
  buffer_store_dwordx4 v[140:143], v253, s[24:27], s41 offen offset:1024
  s_branch L_bJ1
L_bS1:
  buffer_store_dwordx4 v[120:123], v253, s[24:27], s44 offen sc1
  buffer_store_dwordx4 v[124:127], v253, s[24:27], s44 offen offset:1024 sc1
  buffer_store_dwordx4 v[128:131], v253, s[24:27], s44 offen offset:2048 sc1
  buffer_store_dwordx4 v[132:135], v253, s[24:27], s44 offen offset:3072 sc1
  buffer_store_dwordx4 v[136:139], v253, s[24:27], s41 offen sc1
  buffer_store_dwordx4 v[140:143], v253, s[24:27], s41 offen offset:1024 sc1
L_bJ1:
  s_barrier
  s_cmp_eq_u32 s3, 0
  s_cbranch_scc1 L_bS2
  buffer_store_dwordx4 v[144:147], v253, s[24:27], s41 offen offset:2048
  buffer_store_dwordx4 v[148:151], v253, s[24:27], s41 offen offset:3072
  buffer_store_dwordx4 v[152:155], v253, s[24:27], s69 offen
  buffer_store_dwordx4 v[156:159], v253, s[24:27], s69 offen offset:1024
  buffer_store_dwordx4 v[160:163], v253, s[24:27], s69 offen offset:2048
  buffer_store_dwordx4 v[164:167], v253, s[24:27], s69 offen offset:3072
  s_branch L_bJ2
L_bS2:
  buffer_store_dwordx4 v[144:147], v253, s[24:27], s41 offen offset:2048 sc1
  buffer_store_dwordx4 v[148:151], v253, s[24:27], s41 offen offset:3072 sc1
  buffer_store_dwordx4 v[152:155], v253, s[24:27], s69 offen sc1
  buffer_store_dwordx4 v[156:159], v253, s[24:27], s69 offen offset:1024 sc1
  buffer_store_dwordx4 v[160:163], v253, s[24:27], s69 offen offset:2048 sc1
  buffer_store_dwordx4 v[164:167], v253, s[24:27], s69 offen offset:3072 sc1
L_bJ2:
  s_barrier
  s_waitcnt vmcnt(0)
  s_cmp_eq_u32 s3, 0
  s_cbranch_scc1 L_bS3
  v_mov_b32 v242, s58
  v_mov_b32 v243, s59
  v_mov_b32 v240, 0
  s_nop 0
  buffer_store_dwordx2 v[242:243], v240, s[24:27], s65 offen
  s_branch L_bJ3
L_bS3:
  v_mov_b32 v242, s58
  v_mov_b32 v243, s59
  v_mov_b32 v240, 0
  s_nop 0
  buffer_store_dwordx2 v[242:243], v240, s[24:27], s65 offen sc1
L_bJ3:
  s_barrier
  s_barrier
  s_barrier
L_lateA:
  v_lshrrev_b32 v241, 4, v253
  v_and_b32 v241, 7, v241
  v_max_u32 v241, 1, v241
  v_add_u32 v241, s61, v241
  v_and_b32 v241, 7, v241
  v_lshlrev_b32 v241, 3, v241
  s_mov_b32 s71, 1
  s_branch L_chk3
L_fin2:
  s_lshl_b32 s7, s62, 13
  s_add_u32 s7, s7, s98
  s_waitcnt vmcnt(0)
  s_nop 4
  s_add_u32 s4, s62, 1
  s_and_b32 s4, s4, 3
  s_lshl_b32 s4, s4, 15
  s_add_u32 s4, s4, s7
  v_cvt_pk_bf16_f32 v120, v12, v13
  v_cvt_pk_bf16_f32 v121, v14, v15
  v_cvt_pk_bf16_f32 v122, v16, v17
  v_bitop3_b32 v123, v120, v121, v122 bitop3:0x96
  v_xor_b32 v123, s58, v123
  buffer_store_dwordx4 v[120:123], v253, s[24:27], s4 offen sc1
  v_cvt_pk_bf16_f32 v124, v18, v19
  v_cvt_pk_bf16_f32 v125, v20, v21
  v_cvt_pk_bf16_f32 v126, v22, v23
  v_bitop3_b32 v127, v124, v125, v126 bitop3:0x96
  v_xor_b32 v127, s58, v127
  buffer_store_dwordx4 v[124:127], v253, s[24:27], s4 offen offset:1024 sc1
  s_add_u32 s4, s62, 2
  s_and_b32 s4, s4, 3
  s_lshl_b32 s4, s4, 15
  s_add_u32 s4, s4, s7
  v_cvt_pk_bf16_f32 v128, v24, v25
  v_cvt_pk_bf16_f32 v129, v26, v27
  v_cvt_pk_bf16_f32 v130, v28, v29
  v_bitop3_b32 v131, v128, v129, v130 bitop3:0x96
  v_xor_b32 v131, s58, v131
  buffer_store_dwordx4 v[128:131], v253, s[24:27], s4 offen sc1
  v_cvt_pk_bf16_f32 v132, v30, v31
  v_cvt_pk_bf16_f32 v133, v32, v33
  v_cvt_pk_bf16_f32 v134, v34, v35
  v_bitop3_b32 v135, v132, v133, v134 bitop3:0x96
  v_xor_b32 v135, s58, v135
  buffer_store_dwordx4 v[132:135], v253, s[24:27], s4 offen offset:1024 sc1
  s_add_u32 s4, s62, 3
  s_and_b32 s4, s4, 3
  s_lshl_b32 s4, s4, 15
  s_add_u32 s4, s4, s7
  v_cvt_pk_bf16_f32 v136, v36, v37
  v_cvt_pk_bf16_f32 v137, v38, v39
  v_cvt_pk_bf16_f32 v138, v40, v41
  v_bitop3_b32 v139, v136, v137, v138 bitop3:0x96
  v_xor_b32 v139, s58, v139
  buffer_store_dwordx4 v[136:139], v253, s[24:27], s4 offen sc1
  v_cvt_pk_bf16_f32 v140, v42, v43
  v_cvt_pk_bf16_f32 v141, v44, v45
  v_cvt_pk_bf16_f32 v142, v46, v47
  v_bitop3_b32 v143, v140, v141, v142 bitop3:0x96
  v_xor_b32 v143, s58, v143
  buffer_store_dwordx4 v[140:143], v253, s[24:27], s4 offen offset:1024 sc1
  s_lshl_b32 s7, s62, 15
  s_add_u32 s7, s7, s98
  s_add_u32 s4, s62, 1
  s_and_b32 s4, s4, 3
  s_lshl_b32 s4, s4, 13
  s_add_u32 s84, s4, s7
  s_add_u32 s4, s62, 2
  s_and_b32 s4, s4, 3
  s_lshl_b32 s4, s4, 13
  s_add_u32 s85, s4, s7
  s_add_u32 s4, s62, 3
  s_and_b32 s4, s4, 3
  s_lshl_b32 s4, s4, 13
  s_add_u32 s86, s4, s7
  s_mul_i32 s4, s45, 144
  s_add_u32 s4, s4, s89
  s_lshl_b32 s4, s4, 11
  s_lshl_b32 s5, s29, 10
  s_add_u32 s4, s4, s5
  s_lshl_b32 s5, s61, 7
  s_add_u32 s4, s4, s5
  s_lshl_b32 s5, s62, 5
  s_add_u32 s4, s4, s5
  v_and_b32 v200, 0xf0, v253
  v_lshlrev_b32 v200, 7, v200
  v_lshrrev_b32 v201, 8, v253
  v_lshlrev_b32 v201, 3, v201
  v_add_u32 v200, v200, v201
  s_mov_b32 s63, 0x20000
L_get2:
  buffer_load_dwordx4 v[48:51], v253, s[24:27], s84 offen sc1
  buffer_load_dwordx4 v[52:55], v253, s[24:27], s84 offen offset:1024 sc1
  buffer_load_dwordx4 v[56:59], v253, s[24:27], s85 offen sc1
  buffer_load_dwordx4 v[60:63], v253, s[24:27], s85 offen offset:1024 sc1
  buffer_load_dwordx4 v[64:67], v253, s[24:27], s86 offen sc1
  buffer_load_dwordx4 v[68:71], v253, s[24:27], s86 offen offset:1024 sc1
  s_sub_u32 s63, s63, 1
  s_cmp_eq_u32 s63, 0
  s_waitcnt vmcnt(0)
  s_cbranch_scc1 L_got2
  v_bitop3_b32 v202, v48, v49, v50 bitop3:0x96
  v_bitop3_b32 v202, v202, v51, s58 bitop3:0x96
  v_mov_b32 v203, v202
  v_bitop3_b32 v202, v52, v53, v54 bitop3:0x96
  v_bitop3_b32 v202, v202, v55, s58 bitop3:0x96
  v_or_b32 v203, v203, v202
  v_bitop3_b32 v202, v56, v57, v58 bitop3:0x96
  v_bitop3_b32 v202, v202, v59, s58 bitop3:0x96
  v_or_b32 v203, v203, v202
  v_bitop3_b32 v202, v60, v61, v62 bitop3:0x96
  v_bitop3_b32 v202, v202, v63, s58 bitop3:0x96
  v_or_b32 v203, v203, v202
  v_bitop3_b32 v202, v64, v65, v66 bitop3:0x96
  v_bitop3_b32 v202, v202, v67, s58 bitop3:0x96
  v_or_b32 v203, v203, v202
  v_bitop3_b32 v202, v68, v69, v70 bitop3:0x96
  v_bitop3_b32 v202, v202, v71, s58 bitop3:0x96
  v_or_b32 v203, v203, v202
  v_cmp_ne_u32 vcc, 0, v203
  s_nop 1
  s_cbranch_vccz L_got2
  s_sleep 4
  s_branch L_get2
L_got2:
  v_lshlrev_b32 v202, 16, v48
  v_and_b32 v203, 0xffff0000, v48
  v_add_f32 v0, v0, v202
  v_add_f32 v1, v1, v203
  v_lshlrev_b32 v202, 16, v49
  v_and_b32 v203, 0xffff0000, v49
  v_add_f32 v2, v2, v202
  v_add_f32 v3, v3, v203
  v_lshlrev_b32 v202, 16, v50
  v_and_b32 v203, 0xffff0000, v50
  v_add_f32 v4, v4, v202
  v_add_f32 v5, v5, v203
  v_lshlrev_b32 v202, 16, v52
  v_and_b32 v203, 0xffff0000, v52
  v_add_f32 v6, v6, v202
  v_add_f32 v7, v7, v203
  v_lshlrev_b32 v202, 16, v53
  v_and_b32 v203, 0xffff0000, v53
  v_add_f32 v8, v8, v202
  v_add_f32 v9, v9, v203
  v_lshlrev_b32 v202, 16, v54
  v_and_b32 v203, 0xffff0000, v54
  v_add_f32 v10, v10, v202
  v_add_f32 v11, v11, v203
  v_lshlrev_b32 v202, 16, v56
  v_and_b32 v203, 0xffff0000, v56
  v_add_f32 v0, v0, v202
  v_add_f32 v1, v1, v203
  v_lshlrev_b32 v202, 16, v57
  v_and_b32 v203, 0xffff0000, v57
  v_add_f32 v2, v2, v202
  v_add_f32 v3, v3, v203
  v_lshlrev_b32 v202, 16, v58
  v_and_b32 v203, 0xffff0000, v58
  v_add_f32 v4, v4, v202
  v_add_f32 v5, v5, v203
  v_lshlrev_b32 v202, 16, v60
  v_and_b32 v203, 0xffff0000, v60
  v_add_f32 v6, v6, v202
  v_add_f32 v7, v7, v203
  v_lshlrev_b32 v202, 16, v61
  v_and_b32 v203, 0xffff0000, v61
  v_add_f32 v8, v8, v202
  v_add_f32 v9, v9, v203
  v_lshlrev_b32 v202, 16, v62
  v_and_b32 v203, 0xffff0000, v62
  v_add_f32 v10, v10, v202
  v_add_f32 v11, v11, v203
  v_lshlrev_b32 v202, 16, v64
  v_and_b32 v203, 0xffff0000, v64
  v_add_f32 v0, v0, v202
  v_add_f32 v1, v1, v203
  v_lshlrev_b32 v202, 16, v65
  v_and_b32 v203, 0xffff0000, v65
  v_add_f32 v2, v2, v202
  v_add_f32 v3, v3, v203
  v_lshlrev_b32 v202, 16, v66
  v_and_b32 v203, 0xffff0000, v66
  v_add_f32 v4, v4, v202
  v_add_f32 v5, v5, v203
  v_lshlrev_b32 v202, 16, v68
  v_and_b32 v203, 0xffff0000, v68
  v_add_f32 v6, v6, v202
  v_add_f32 v7, v7, v203
  v_lshlrev_b32 v202, 16, v69
  v_and_b32 v203, 0xffff0000, v69
  v_add_f32 v8, v8, v202
  v_add_f32 v9, v9, v203
  v_lshlrev_b32 v202, 16, v70
  v_and_b32 v203, 0xffff0000, v70
  v_add_f32 v10, v10, v202
  v_add_f32 v11, v11, v203
  v_cvt_pk_bf16_f32 v100, v0, v1
  v_cvt_pk_bf16_f32 v101, v2, v3
  buffer_store_dwordx2 v[100:101], v200, s[52:55], s4 offen
  s_add_u32 s4, s4, s88
  v_cvt_pk_bf16_f32 v102, v4, v5
  v_cvt_pk_bf16_f32 v103, v6, v7
  buffer_store_dwordx2 v[102:103], v200, s[52:55], s4 offen
  s_add_u32 s4, s4, s88
  v_cvt_pk_bf16_f32 v104, v8, v9
  v_cvt_pk_bf16_f32 v105, v10, v11
  s_cmp_lt_u32 s90, 3
  s_cbranch_scc1 L_done
  buffer_store_dwordx2 v[104:105], v200, s[52:55], s4 offen
L_done:
  s_endpgm
L_stubB_a0_0:
  s_call_b64 s[42:43], L_slowB
  s_branch L_retB_a0_0
L_stubA_a0_1:
  s_call_b64 s[42:43], L_slowA
  s_branch L_retA_a0_1
L_stubB_a0_1:
  s_call_b64 s[42:43], L_slowB
  s_branch L_retB_a0_1
L_stubA_a1_2:
  s_call_b64 s[42:43], L_slowA
  s_branch L_retA_a1_2
L_stubB_a1_2:
  s_call_b64 s[42:43], L_slowB
  s_branch L_retB_a1_2
L_stubA_a1_3:
  s_call_b64 s[42:43], L_slowA
  s_branch L_retA_a1_3
L_stubB_a1_3:
  s_call_b64 s[42:43], L_slowB
  s_branch L_retB_a1_3
L_stubA_a2_4:
  s_call_b64 s[42:43], L_slowA
  s_branch L_retA_a2_4
L_stubB_a2_4:
  s_call_b64 s[42:43], L_slowB
  s_branch L_retB_a2_4
L_stubA_a2_5:
  s_call_b64 s[42:43], L_slowA
  s_branch L_retA_a2_5
L_stubB_a2_5:
  s_call_b64 s[42:43], L_slowB
  s_branch L_retB_a2_5
L_stubA_a3_6:
  s_call_b64 s[42:43], L_slowA
  s_branch L_retA_a3_6
L_stubB_a3_6:
  s_call_b64 s[42:43], L_slowB
  s_branch L_retB_a3_6
L_stubA_a3_7:
  s_call_b64 s[42:43], L_slowA
  s_branch L_retA_a3_7
L_stubB_a3_7:
  s_call_b64 s[42:43], L_slowB
  s_branch L_retB_a3_7
L_stubA_a4_0:
  s_call_b64 s[42:43], L_slowA
  s_branch L_retA_a4_0
L_stubB_a4_0:
  s_call_b64 s[42:43], L_slowB
  s_branch L_retB_a4_0
L_stubA_a4_1:
  s_call_b64 s[42:43], L_slowA
  s_branch L_retA_a4_1
L_stubB_a4_1:
  s_call_b64 s[42:43], L_slowB
  s_branch L_retB_a4_1
L_init:
  s_nop 7
  v_max3_f32 v250, v168, v169, v170
  v_max3_f32 v247, v172, v173, v174
  v_max3_f32 v248, v176, v177, v178
  v_max_f32 v250, v250, v171
  v_max_f32 v247, v247, v175
  v_max_f32 v248, v248, v179
  v_mov_b32 v251, v250
  v_mov_b32 v249, v247
  v_mov_b32 v252, v248
  v_permlane16_swap_b32 v250, v251
  v_permlane16_swap_b32 v247, v249
  v_permlane16_swap_b32 v248, v252
  v_max_f32 v250, v250, v251
  v_max_f32 v247, v247, v249
  v_max_f32 v248, v248, v252
  v_mov_b32 v251, v250
  v_mov_b32 v249, v247
  v_mov_b32 v252, v248
  v_permlane32_swap_b32 v250, v251
  v_permlane32_swap_b32 v247, v249
  v_permlane32_swap_b32 v248, v252
  v_max_f32 v244, v250, v251
  v_max_f32 v245, v247, v249
  v_max_f32 v246, v248, v252
  v_sub_f32 v168, v168, v244
  v_sub_f32 v108, 0, v244
  v_sub_f32 v180, v180, v244
  v_sub_f32 v169, v169, v244
  v_sub_f32 v109, 0, v244
  v_sub_f32 v181, v181, v244
  v_sub_f32 v170, v170, v244
  v_sub_f32 v110, 0, v244
  v_sub_f32 v182, v182, v244
  v_sub_f32 v171, v171, v244
  v_sub_f32 v111, 0, v244
  v_sub_f32 v183, v183, v244
  v_sub_f32 v172, v172, v245
  v_sub_f32 v112, 0, v245
  v_sub_f32 v184, v184, v245
  v_sub_f32 v173, v173, v245
  v_sub_f32 v113, 0, v245
  v_sub_f32 v185, v185, v245
  v_sub_f32 v174, v174, v245
  v_sub_f32 v114, 0, v245
  v_sub_f32 v186, v186, v245
  v_sub_f32 v175, v175, v245
  v_sub_f32 v115, 0, v245
  v_sub_f32 v187, v187, v245
  v_sub_f32 v176, v176, v246
  v_sub_f32 v116, 0, v246
  v_sub_f32 v188, v188, v246
  v_sub_f32 v177, v177, v246
  v_sub_f32 v117, 0, v246
  v_sub_f32 v189, v189, v246
  v_sub_f32 v178, v178, v246
  v_sub_f32 v118, 0, v246
  v_sub_f32 v190, v190, v246
  v_sub_f32 v179, v179, v246
  v_sub_f32 v119, 0, v246
  v_sub_f32 v191, v191, v246
  s_nop 1
  s_setpc_b64 s[42:43]
L_slowA:
  s_nop 7
  v_max3_f32 v250, v168, v169, v170
  v_max_f32 v250, v250, v171
  v_mov_b32 v251, v250
  s_nop 1
  v_permlane16_swap_b32 v250, v251
  v_max_f32 v250, v250, v251
  v_mov_b32 v251, v250
  s_nop 1
  v_permlane32_swap_b32 v250, v251
  v_max3_f32 v244, v250, v251, 0
  v_exp_f32 v247, -v244
  v_max3_f32 v250, v172, v173, v174
  v_max_f32 v250, v250, v175
  v_mov_b32 v251, v250
  s_nop 1
  v_permlane16_swap_b32 v250, v251
  v_max_f32 v250, v250, v251
  v_mov_b32 v251, v250
  s_nop 1
  v_permlane32_swap_b32 v250, v251
  v_max3_f32 v245, v250, v251, 0
  v_exp_f32 v248, -v245
  v_max3_f32 v250, v176, v177, v178
  v_max_f32 v250, v250, v179
  v_mov_b32 v251, v250
  s_nop 1
  v_permlane16_swap_b32 v250, v251
  v_max_f32 v250, v250, v251
  v_mov_b32 v251, v250
  s_nop 1
  v_permlane32_swap_b32 v250, v251
  v_max3_f32 v246, v250, v251, 0
  v_exp_f32 v249, -v246
  v_sub_f32 v168, v168, v244
  v_sub_f32 v108, v108, v244
  v_sub_f32 v180, v180, v244
  v_sub_f32 v169, v169, v244
  v_sub_f32 v109, v109, v244
  v_sub_f32 v181, v181, v244
  v_sub_f32 v170, v170, v244
  v_sub_f32 v110, v110, v244
  v_sub_f32 v182, v182, v244
  v_sub_f32 v171, v171, v244
  v_sub_f32 v111, v111, v244
  v_sub_f32 v183, v183, v244
  v_mul_f32 v96, v96, v247
  v_mul_f32 v97, v97, v247
  v_mul_f32 v98, v98, v247
  v_mul_f32 v99, v99, v247
  v_mul_f32 v0, v0, v247
  v_mul_f32 v1, v1, v247
  v_mul_f32 v2, v2, v247
  v_mul_f32 v3, v3, v247
  v_mul_f32 v4, v4, v247
  v_mul_f32 v5, v5, v247
  v_mul_f32 v6, v6, v247
  v_mul_f32 v7, v7, v247
  v_mul_f32 v8, v8, v247
  v_mul_f32 v9, v9, v247
  v_mul_f32 v10, v10, v247
  v_mul_f32 v11, v11, v247
  v_mul_f32 v12, v12, v247
  v_mul_f32 v13, v13, v247
  v_mul_f32 v14, v14, v247
  v_mul_f32 v15, v15, v247
  v_mul_f32 v16, v16, v247
  v_mul_f32 v17, v17, v247
  v_mul_f32 v18, v18, v247
  v_mul_f32 v19, v19, v247
  v_mul_f32 v20, v20, v247
  v_mul_f32 v21, v21, v247
  v_mul_f32 v22, v22, v247
  v_mul_f32 v23, v23, v247
  v_mul_f32 v24, v24, v247
  v_mul_f32 v25, v25, v247
  v_mul_f32 v26, v26, v247
  v_mul_f32 v27, v27, v247
  v_mul_f32 v28, v28, v247
  v_mul_f32 v29, v29, v247
  v_mul_f32 v30, v30, v247
  v_mul_f32 v31, v31, v247
  v_lshlrev_b32 v250, 16, v192
  v_and_b32 v251, 0xffff0000, v192
  v_mul_f32 v250, v250, v247
  v_mul_f32 v251, v251, v247
  v_cvt_pk_bf16_f32 v192, v250, v251
  v_lshlrev_b32 v250, 16, v193
  v_and_b32 v251, 0xffff0000, v193
  v_mul_f32 v250, v250, v247
  v_mul_f32 v251, v251, v247
  v_cvt_pk_bf16_f32 v193, v250, v251
  v_lshlrev_b32 v250, 16, v194
  v_and_b32 v251, 0xffff0000, v194
  v_mul_f32 v250, v250, v247
  v_mul_f32 v251, v251, v247
  v_cvt_pk_bf16_f32 v194, v250, v251
  v_lshlrev_b32 v250, 16, v195
  v_and_b32 v251, 0xffff0000, v195
  v_mul_f32 v250, v250, v247
  v_mul_f32 v251, v251, v247
  v_cvt_pk_bf16_f32 v195, v250, v251
  v_sub_f32 v172, v172, v245
  v_sub_f32 v112, v112, v245
  v_sub_f32 v184, v184, v245
  v_sub_f32 v173, v173, v245
  v_sub_f32 v113, v113, v245
  v_sub_f32 v185, v185, v245
  v_sub_f32 v174, v174, v245
  v_sub_f32 v114, v114, v245
  v_sub_f32 v186, v186, v245
  v_sub_f32 v175, v175, v245
  v_sub_f32 v115, v115, v245
  v_sub_f32 v187, v187, v245
  v_mul_f32 v100, v100, v248
  v_mul_f32 v101, v101, v248
  v_mul_f32 v102, v102, v248
  v_mul_f32 v103, v103, v248
  v_mul_f32 v32, v32, v248
  v_mul_f32 v33, v33, v248
  v_mul_f32 v34, v34, v248
  v_mul_f32 v35, v35, v248
  v_mul_f32 v36, v36, v248
  v_mul_f32 v37, v37, v248
  v_mul_f32 v38, v38, v248
  v_mul_f32 v39, v39, v248
  v_mul_f32 v40, v40, v248
  v_mul_f32 v41, v41, v248
  v_mul_f32 v42, v42, v248
  v_mul_f32 v43, v43, v248
  v_mul_f32 v44, v44, v248
  v_mul_f32 v45, v45, v248
  v_mul_f32 v46, v46, v248
  v_mul_f32 v47, v47, v248
  v_mul_f32 v48, v48, v248
  v_mul_f32 v49, v49, v248
  v_mul_f32 v50, v50, v248
  v_mul_f32 v51, v51, v248
  v_mul_f32 v52, v52, v248
  v_mul_f32 v53, v53, v248
  v_mul_f32 v54, v54, v248
  v_mul_f32 v55, v55, v248
  v_mul_f32 v56, v56, v248
  v_mul_f32 v57, v57, v248
  v_mul_f32 v58, v58, v248
  v_mul_f32 v59, v59, v248
  v_mul_f32 v60, v60, v248
  v_mul_f32 v61, v61, v248
  v_mul_f32 v62, v62, v248
  v_mul_f32 v63, v63, v248
  v_lshlrev_b32 v250, 16, v196
  v_and_b32 v251, 0xffff0000, v196
  v_mul_f32 v250, v250, v248
  v_mul_f32 v251, v251, v248
  v_cvt_pk_bf16_f32 v196, v250, v251
  v_lshlrev_b32 v250, 16, v197
  v_and_b32 v251, 0xffff0000, v197
  v_mul_f32 v250, v250, v248
  v_mul_f32 v251, v251, v248
  v_cvt_pk_bf16_f32 v197, v250, v251
  v_lshlrev_b32 v250, 16, v198
  v_and_b32 v251, 0xffff0000, v198
  v_mul_f32 v250, v250, v248
  v_mul_f32 v251, v251, v248
  v_cvt_pk_bf16_f32 v198, v250, v251
  v_lshlrev_b32 v250, 16, v199
  v_and_b32 v251, 0xffff0000, v199
  v_mul_f32 v250, v250, v248
  v_mul_f32 v251, v251, v248
  v_cvt_pk_bf16_f32 v199, v250, v251
  v_sub_f32 v176, v176, v246
  v_sub_f32 v116, v116, v246
  v_sub_f32 v188, v188, v246
  v_sub_f32 v177, v177, v246
  v_sub_f32 v117, v117, v246
  v_sub_f32 v189, v189, v246
  v_sub_f32 v178, v178, v246
  v_sub_f32 v118, v118, v246
  v_sub_f32 v190, v190, v246
  v_sub_f32 v179, v179, v246
  v_sub_f32 v119, v119, v246
  v_sub_f32 v191, v191, v246
  v_mul_f32 v104, v104, v249
  v_mul_f32 v105, v105, v249
  v_mul_f32 v106, v106, v249
  v_mul_f32 v107, v107, v249
  v_mul_f32 v64, v64, v249
  v_mul_f32 v65, v65, v249
  v_mul_f32 v66, v66, v249
  v_mul_f32 v67, v67, v249
  v_mul_f32 v68, v68, v249
  v_mul_f32 v69, v69, v249
  v_mul_f32 v70, v70, v249
  v_mul_f32 v71, v71, v249
  v_mul_f32 v72, v72, v249
  v_mul_f32 v73, v73, v249
  v_mul_f32 v74, v74, v249
  v_mul_f32 v75, v75, v249
  v_mul_f32 v76, v76, v249
  v_mul_f32 v77, v77, v249
  v_mul_f32 v78, v78, v249
  v_mul_f32 v79, v79, v249
  v_mul_f32 v80, v80, v249
  v_mul_f32 v81, v81, v249
  v_mul_f32 v82, v82, v249
  v_mul_f32 v83, v83, v249
  v_mul_f32 v84, v84, v249
  v_mul_f32 v85, v85, v249
  v_mul_f32 v86, v86, v249
  v_mul_f32 v87, v87, v249
  v_mul_f32 v88, v88, v249
  v_mul_f32 v89, v89, v249
  v_mul_f32 v90, v90, v249
  v_mul_f32 v91, v91, v249
  v_mul_f32 v92, v92, v249
  v_mul_f32 v93, v93, v249
  v_mul_f32 v94, v94, v249
  v_mul_f32 v95, v95, v249
  v_lshlrev_b32 v250, 16, v200
  v_and_b32 v251, 0xffff0000, v200
  v_mul_f32 v250, v250, v249
  v_mul_f32 v251, v251, v249
  v_cvt_pk_bf16_f32 v200, v250, v251
  v_lshlrev_b32 v250, 16, v201
  v_and_b32 v251, 0xffff0000, v201
  v_mul_f32 v250, v250, v249
  v_mul_f32 v251, v251, v249
  v_cvt_pk_bf16_f32 v201, v250, v251
  v_lshlrev_b32 v250, 16, v202
  v_and_b32 v251, 0xffff0000, v202
  v_mul_f32 v250, v250, v249
  v_mul_f32 v251, v251, v249
  v_cvt_pk_bf16_f32 v202, v250, v251
  v_lshlrev_b32 v250, 16, v203
  v_and_b32 v251, 0xffff0000, v203
  v_mul_f32 v250, v250, v249
  v_mul_f32 v251, v251, v249
  v_cvt_pk_bf16_f32 v203, v250, v251
  s_nop 1
  s_setpc_b64 s[42:43]
L_slowB:
  s_nop 7
  v_max3_f32 v250, v180, v181, v182
  v_max_f32 v250, v250, v183
  v_mov_b32 v251, v250
  s_nop 1
  v_permlane16_swap_b32 v250, v251
  v_max_f32 v250, v250, v251
  v_mov_b32 v251, v250
  s_nop 1
  v_permlane32_swap_b32 v250, v251
  v_max3_f32 v244, v250, v251, 0
  v_exp_f32 v247, -v244
  v_max3_f32 v250, v184, v185, v186
  v_max_f32 v250, v250, v187
  v_mov_b32 v251, v250
  s_nop 1
  v_permlane16_swap_b32 v250, v251
  v_max_f32 v250, v250, v251
  v_mov_b32 v251, v250
  s_nop 1
  v_permlane32_swap_b32 v250, v251
  v_max3_f32 v245, v250, v251, 0
  v_exp_f32 v248, -v245
  v_max3_f32 v250, v188, v189, v190
  v_max_f32 v250, v250, v191
  v_mov_b32 v251, v250
  s_nop 1
  v_permlane16_swap_b32 v250, v251
  v_max_f32 v250, v250, v251
  v_mov_b32 v251, v250
  s_nop 1
  v_permlane32_swap_b32 v250, v251
  v_max3_f32 v246, v250, v251, 0
  v_exp_f32 v249, -v246
  v_mul_f32 v168, v168, v247
  v_sub_f32 v108, v108, v244
  v_sub_f32 v180, v180, v244
  v_mul_f32 v169, v169, v247
  v_sub_f32 v109, v109, v244
  v_sub_f32 v181, v181, v244
  v_mul_f32 v170, v170, v247
  v_sub_f32 v110, v110, v244
  v_sub_f32 v182, v182, v244
  v_mul_f32 v171, v171, v247
  v_sub_f32 v111, v111, v244
  v_sub_f32 v183, v183, v244
  v_mul_f32 v96, v96, v247
  v_mul_f32 v97, v97, v247
  v_mul_f32 v98, v98, v247
  v_mul_f32 v99, v99, v247
  v_mul_f32 v0, v0, v247
  v_mul_f32 v1, v1, v247
  v_mul_f32 v2, v2, v247
  v_mul_f32 v3, v3, v247
  v_mul_f32 v4, v4, v247
  v_mul_f32 v5, v5, v247
  v_mul_f32 v6, v6, v247
  v_mul_f32 v7, v7, v247
  v_mul_f32 v8, v8, v247
  v_mul_f32 v9, v9, v247
  v_mul_f32 v10, v10, v247
  v_mul_f32 v11, v11, v247
  v_mul_f32 v12, v12, v247
  v_mul_f32 v13, v13, v247
  v_mul_f32 v14, v14, v247
  v_mul_f32 v15, v15, v247
  v_mul_f32 v16, v16, v247
  v_mul_f32 v17, v17, v247
  v_mul_f32 v18, v18, v247
  v_mul_f32 v19, v19, v247
  v_mul_f32 v20, v20, v247
  v_mul_f32 v21, v21, v247
  v_mul_f32 v22, v22, v247
  v_mul_f32 v23, v23, v247
  v_mul_f32 v24, v24, v247
  v_mul_f32 v25, v25, v247
  v_mul_f32 v26, v26, v247
  v_mul_f32 v27, v27, v247
  v_mul_f32 v28, v28, v247
  v_mul_f32 v29, v29, v247
  v_mul_f32 v30, v30, v247
  v_mul_f32 v31, v31, v247
  v_lshlrev_b32 v250, 16, v192
  v_and_b32 v251, 0xffff0000, v192
  v_mul_f32 v250, v250, v247
  v_mul_f32 v251, v251, v247
  v_cvt_pk_bf16_f32 v192, v250, v251
  v_lshlrev_b32 v250, 16, v193
  v_and_b32 v251, 0xffff0000, v193
  v_mul_f32 v250, v250, v247
  v_mul_f32 v251, v251, v247
  v_cvt_pk_bf16_f32 v193, v250, v251
  v_lshlrev_b32 v250, 16, v194
  v_and_b32 v251, 0xffff0000, v194
  v_mul_f32 v250, v250, v247
  v_mul_f32 v251, v251, v247
  v_cvt_pk_bf16_f32 v194, v250, v251
  v_lshlrev_b32 v250, 16, v195
  v_and_b32 v251, 0xffff0000, v195
  v_mul_f32 v250, v250, v247
  v_mul_f32 v251, v251, v247
  v_cvt_pk_bf16_f32 v195, v250, v251
  v_mul_f32 v172, v172, v248
  v_sub_f32 v112, v112, v245
  v_sub_f32 v184, v184, v245
  v_mul_f32 v173, v173, v248
  v_sub_f32 v113, v113, v245
  v_sub_f32 v185, v185, v245
  v_mul_f32 v174, v174, v248
  v_sub_f32 v114, v114, v245
  v_sub_f32 v186, v186, v245
  v_mul_f32 v175, v175, v248
  v_sub_f32 v115, v115, v245
  v_sub_f32 v187, v187, v245
  v_mul_f32 v100, v100, v248
  v_mul_f32 v101, v101, v248
  v_mul_f32 v102, v102, v248
  v_mul_f32 v103, v103, v248
  v_mul_f32 v32, v32, v248
  v_mul_f32 v33, v33, v248
  v_mul_f32 v34, v34, v248
  v_mul_f32 v35, v35, v248
  v_mul_f32 v36, v36, v248
  v_mul_f32 v37, v37, v248
  v_mul_f32 v38, v38, v248
  v_mul_f32 v39, v39, v248
  v_mul_f32 v40, v40, v248
  v_mul_f32 v41, v41, v248
  v_mul_f32 v42, v42, v248
  v_mul_f32 v43, v43, v248
  v_mul_f32 v44, v44, v248
  v_mul_f32 v45, v45, v248
  v_mul_f32 v46, v46, v248
  v_mul_f32 v47, v47, v248
  v_mul_f32 v48, v48, v248
  v_mul_f32 v49, v49, v248
  v_mul_f32 v50, v50, v248
  v_mul_f32 v51, v51, v248
  v_mul_f32 v52, v52, v248
  v_mul_f32 v53, v53, v248
  v_mul_f32 v54, v54, v248
  v_mul_f32 v55, v55, v248
  v_mul_f32 v56, v56, v248
  v_mul_f32 v57, v57, v248
  v_mul_f32 v58, v58, v248
  v_mul_f32 v59, v59, v248
  v_mul_f32 v60, v60, v248
  v_mul_f32 v61, v61, v248
  v_mul_f32 v62, v62, v248
  v_mul_f32 v63, v63, v248
  v_lshlrev_b32 v250, 16, v196
  v_and_b32 v251, 0xffff0000, v196
  v_mul_f32 v250, v250, v248
  v_mul_f32 v251, v251, v248
  v_cvt_pk_bf16_f32 v196, v250, v251
  v_lshlrev_b32 v250, 16, v197
  v_and_b32 v251, 0xffff0000, v197
  v_mul_f32 v250, v250, v248
  v_mul_f32 v251, v251, v248
  v_cvt_pk_bf16_f32 v197, v250, v251
  v_lshlrev_b32 v250, 16, v198
  v_and_b32 v251, 0xffff0000, v198
  v_mul_f32 v250, v250, v248
  v_mul_f32 v251, v251, v248
  v_cvt_pk_bf16_f32 v198, v250, v251
  v_lshlrev_b32 v250, 16, v199
  v_and_b32 v251, 0xffff0000, v199
  v_mul_f32 v250, v250, v248
  v_mul_f32 v251, v251, v248
  v_cvt_pk_bf16_f32 v199, v250, v251
  v_mul_f32 v176, v176, v249
  v_sub_f32 v116, v116, v246
  v_sub_f32 v188, v188, v246
  v_mul_f32 v177, v177, v249
  v_sub_f32 v117, v117, v246
  v_sub_f32 v189, v189, v246
  v_mul_f32 v178, v178, v249
  v_sub_f32 v118, v118, v246
  v_sub_f32 v190, v190, v246
  v_mul_f32 v179, v179, v249
  v_sub_f32 v119, v119, v246
  v_sub_f32 v191, v191, v246
  v_mul_f32 v104, v104, v249
  v_mul_f32 v105, v105, v249
  v_mul_f32 v106, v106, v249
  v_mul_f32 v107, v107, v249
  v_mul_f32 v64, v64, v249
  v_mul_f32 v65, v65, v249
  v_mul_f32 v66, v66, v249
  v_mul_f32 v67, v67, v249
  v_mul_f32 v68, v68, v249
  v_mul_f32 v69, v69, v249
  v_mul_f32 v70, v70, v249
  v_mul_f32 v71, v71, v249
  v_mul_f32 v72, v72, v249
  v_mul_f32 v73, v73, v249
  v_mul_f32 v74, v74, v249
  v_mul_f32 v75, v75, v249
  v_mul_f32 v76, v76, v249
  v_mul_f32 v77, v77, v249
  v_mul_f32 v78, v78, v249
  v_mul_f32 v79, v79, v249
  v_mul_f32 v80, v80, v249
  v_mul_f32 v81, v81, v249
  v_mul_f32 v82, v82, v249
  v_mul_f32 v83, v83, v249
  v_mul_f32 v84, v84, v249
  v_mul_f32 v85, v85, v249
  v_mul_f32 v86, v86, v249
  v_mul_f32 v87, v87, v249
  v_mul_f32 v88, v88, v249
  v_mul_f32 v89, v89, v249
  v_mul_f32 v90, v90, v249
  v_mul_f32 v91, v91, v249
  v_mul_f32 v92, v92, v249
  v_mul_f32 v93, v93, v249
  v_mul_f32 v94, v94, v249
  v_mul_f32 v95, v95, v249
  v_lshlrev_b32 v250, 16, v200
  v_and_b32 v251, 0xffff0000, v200
  v_mul_f32 v250, v250, v249
  v_mul_f32 v251, v251, v249
  v_cvt_pk_bf16_f32 v200, v250, v251
  v_lshlrev_b32 v250, 16, v201
  v_and_b32 v251, 0xffff0000, v201
  v_mul_f32 v250, v250, v249
  v_mul_f32 v251, v251, v249
  v_cvt_pk_bf16_f32 v201, v250, v251
  v_lshlrev_b32 v250, 16, v202
  v_and_b32 v251, 0xffff0000, v202
  v_mul_f32 v250, v250, v249
  v_mul_f32 v251, v251, v249
  v_cvt_pk_bf16_f32 v202, v250, v251
  v_lshlrev_b32 v250, 16, v203
  v_and_b32 v251, 0xffff0000, v203
  v_mul_f32 v250, v250, v249
  v_mul_f32 v251, v251, v249
  v_cvt_pk_bf16_f32 v203, v250, v251
  s_nop 1
  s_setpc_b64 s[42:43]
L_loader:
  s_setprio 3
  v_lshlrev_b32 v5, 1, v3
  v_xor_b32 v5, v5, v4
  v_lshlrev_b32 v5, 4, v5
  v_lshlrev_b32 v6, 8, v3
  v_add_u32 v10, v5, v6
  v_xor_b32 v11, 0x80, v10
  v_mov_b32 v12, v253
  s_cmp_eq_u32 s29, 0
  s_waitcnt lgkmcnt(0)
  s_cselect_b64 s[20:21], s[48:49], s[56:57]
  s_cselect_b64 s[8:9], s[50:51], s[58:59]
  s_cselect_b64 s[12:13], s[52:53], s[60:61]
  s_cselect_b64 s[16:17], s[54:55], s[62:63]
  s_cmp_eq_u32 s28, 4
  s_cbranch_scc1 L_loadV
L_loadK:
  s_barrier
  s_load_dwordx2 s[48:49], s[0:1], 32
  s_load_dwordx2 s[50:51], s[0:1], 72
  s_load_dwordx2 s[56:57], s[0:1], 88
  s_memrealtime s[58:59]
  v_lshrrev_b32 v5, 3, v2
  v_lshlrev_b32 v5, 10, v5
  v_and_b32 v6, 7, v2
  v_lshlrev_b32 v7, 1, v3
  v_xor_b32 v6, v6, v7
  v_lshlrev_b32 v6, 4, v6
  v_add_u32 v14, v5, v6
  v_add_u32 v15, 7168, v14
  v_add_u32 v16, 14336, v14
  v_add_u32 v17, 21504, v14
  s_and_b32 s61, s30, 7
  s_lshr_b32 s62, s30, 3
  s_cmp_eq_u32 s29, 0
  s_waitcnt lgkmcnt(0)
  s_cselect_b64 s[48:49], s[48:49], s[50:51]
  s_mov_b32 s50, 0x400000
  s_mov_b32 s51, 0x20000
  s_cmp_lg_u32 s2, 0
  s_cbranch_scc1 L_nnX
  s_or_b32 s58, s58, 1
  s_atomic_swap s58, s[56:57], 0
L_nnX:
  s_barrier
  s_barrier
  s_barrier
  s_mov_b32 m0, 0
  s_add_u32 s35, s36, 0
  buffer_load_dwordx4 v10, s[8:11], s35 offen nt lds
  buffer_load_dwordx4 v11, s[8:11], s35 offen offset:1024 nt lds
  buffer_load_dwordx4 v10, s[8:11], s35 offen offset:2048 nt lds
  buffer_load_dwordx4 v11, s[8:11], s35 offen offset:3072 nt lds
  s_barrier
  s_mov_b32 m0, 4096
  s_add_u32 s35, s36, 4096
  buffer_load_dwordx4 v10, s[8:11], s35 offen nt lds
  buffer_load_dwordx4 v11, s[8:11], s35 offen offset:1024 nt lds
  buffer_load_dwordx4 v10, s[8:11], s35 offen offset:2048 nt lds
  buffer_load_dwordx4 v11, s[8:11], s35 offen offset:3072 nt lds
  s_barrier
  s_mov_b32 m0, 8192
  s_add_u32 s35, s36, 8192
  buffer_load_dwordx4 v10, s[8:11], s35 offen nt lds
  buffer_load_dwordx4 v11, s[8:11], s35 offen offset:1024 nt lds
  buffer_load_dwordx4 v10, s[8:11], s35 offen offset:2048 nt lds
  buffer_load_dwordx4 v11, s[8:11], s35 offen offset:3072 nt lds
  s_barrier
  s_mov_b32 m0, 12288
  s_add_u32 s35, s36, 12288
  buffer_load_dwordx4 v10, s[8:11], s35 offen nt lds
  buffer_load_dwordx4 v11, s[8:11], s35 offen offset:1024 nt lds
  buffer_load_dwordx4 v10, s[8:11], s35 offen offset:2048 nt lds
  buffer_load_dwordx4 v11, s[8:11], s35 offen offset:3072 nt lds
  s_barrier
  v_lshlrev_b32 v5, 1, v3
  v_xor_b32 v5, v5, v4
  v_lshlrev_b32 v5, 4, v5
  v_lshlrev_b32 v6, 13, v3
  v_add_u32 v18, v5, v6
  v_xor_b32 v19, 0x80, v18
  s_lshl_b32 s6, s31, 1
  s_add_u32 s68, s6, s30
  s_and_b32 s68, s68, 7
  s_lshl_b32 s70, s68, 1
  s_lshl_b32 s4, s70, 18
  s_add_u32 s4, s4, s37
  s_add_u32 s70, s70, 1
  s_and_b32 s70, s70, 15
  s_mov_b32 m0, 131072
  s_add_u32 s35, s4, 0
  buffer_load_dwordx4 v18, s[16:19], s35 offen lds
  s_mov_b32 m0, 132096
  s_add_u32 s35, s4, 32768
  buffer_load_dwordx4 v18, s[16:19], s35 offen lds
  s_mov_b32 m0, 133120
  s_add_u32 s35, s4, 65536
  buffer_load_dwordx4 v19, s[16:19], s35 offen lds
  s_mov_b32 m0, 134144
  s_add_u32 s35, s4, 98304
  buffer_load_dwordx4 v19, s[16:19], s35 offen lds
  s_mov_b32 m0, 135168
  s_add_u32 s35, s4, 131072
  buffer_load_dwordx4 v18, s[16:19], s35 offen lds
  s_mov_b32 m0, 136192
  s_add_u32 s35, s4, 163840
  buffer_load_dwordx4 v18, s[16:19], s35 offen lds
  s_mov_b32 m0, 137216
  s_add_u32 s35, s4, 196608
  buffer_load_dwordx4 v19, s[16:19], s35 offen lds
  s_mov_b32 m0, 138240
  s_add_u32 s35, s4, 229376
  buffer_load_dwordx4 v19, s[16:19], s35 offen lds
  s_add_u32 s35, s36, 16384
  buffer_load_dwordx4 v[24:27], v10, s[8:11], s35 offen nt
  buffer_load_dwordx4 v[28:31], v11, s[8:11], s35 offen offset:1024 nt
  buffer_load_dwordx4 v[32:35], v10, s[8:11], s35 offen offset:2048 nt
  buffer_load_dwordx4 v[36:39], v11, s[8:11], s35 offen offset:3072 nt
  s_add_u32 s35, s36, 20480
  buffer_load_dwordx4 v[40:43], v10, s[8:11], s35 offen nt
  buffer_load_dwordx4 v[44:47], v11, s[8:11], s35 offen offset:1024 nt
  buffer_load_dwordx4 v[48:51], v10, s[8:11], s35 offen offset:2048 nt
  buffer_load_dwordx4 v[52:55], v11, s[8:11], s35 offen offset:3072 nt
  s_barrier
  s_lshl_b32 s4, s70, 18
  s_add_u32 s4, s4, s37
  s_add_u32 s70, s70, 1
  s_and_b32 s70, s70, 15
  s_mov_b32 m0, 139264
  s_add_u32 s35, s4, 0
  buffer_load_dwordx4 v18, s[16:19], s35 offen lds
  s_mov_b32 m0, 140288
  s_add_u32 s35, s4, 32768
  buffer_load_dwordx4 v18, s[16:19], s35 offen lds
  s_mov_b32 m0, 141312
  s_add_u32 s35, s4, 65536
  buffer_load_dwordx4 v19, s[16:19], s35 offen lds
  s_mov_b32 m0, 142336
  s_add_u32 s35, s4, 98304
  buffer_load_dwordx4 v19, s[16:19], s35 offen lds
  s_mov_b32 m0, 143360
  s_add_u32 s35, s4, 131072
  buffer_load_dwordx4 v18, s[16:19], s35 offen lds
  s_mov_b32 m0, 144384
  s_add_u32 s35, s4, 163840
  buffer_load_dwordx4 v18, s[16:19], s35 offen lds
  s_mov_b32 m0, 145408
  s_add_u32 s35, s4, 196608
  buffer_load_dwordx4 v19, s[16:19], s35 offen lds
  s_mov_b32 m0, 146432
  s_add_u32 s35, s4, 229376
  buffer_load_dwordx4 v19, s[16:19], s35 offen lds
  s_mov_b32 m0, 24576
  s_add_u32 s35, s36, 24576
  buffer_load_dwordx4 v10, s[8:11], s35 offen nt lds
  buffer_load_dwordx4 v11, s[8:11], s35 offen offset:1024 nt lds
  buffer_load_dwordx4 v10, s[8:11], s35 offen offset:2048 nt lds
  buffer_load_dwordx4 v11, s[8:11], s35 offen offset:3072 nt lds
  s_mov_b32 m0, 28672
  s_add_u32 s35, s36, 28672
  buffer_load_dwordx4 v10, s[8:11], s35 offen nt lds
  buffer_load_dwordx4 v11, s[8:11], s35 offen offset:1024 nt lds
  buffer_load_dwordx4 v10, s[8:11], s35 offen offset:2048 nt lds
  buffer_load_dwordx4 v11, s[8:11], s35 offen offset:3072 nt lds
  s_waitcnt vmcnt(24)
  s_barrier
  s_lshl_b32 s4, s70, 18
  s_add_u32 s4, s4, s37
  s_add_u32 s70, s70, 1
  s_and_b32 s70, s70, 15
  s_mov_b32 m0, 147456
  s_add_u32 s35, s4, 0
  buffer_load_dwordx4 v18, s[16:19], s35 offen lds
  s_mov_b32 m0, 148480
  s_add_u32 s35, s4, 32768
  buffer_load_dwordx4 v18, s[16:19], s35 offen lds
  s_mov_b32 m0, 149504
  s_add_u32 s35, s4, 65536
  buffer_load_dwordx4 v19, s[16:19], s35 offen lds
  s_mov_b32 m0, 150528
  s_add_u32 s35, s4, 98304
  buffer_load_dwordx4 v19, s[16:19], s35 offen lds
  s_mov_b32 m0, 151552
  s_add_u32 s35, s4, 131072
  buffer_load_dwordx4 v18, s[16:19], s35 offen lds
  s_mov_b32 m0, 152576
  s_add_u32 s35, s4, 163840
  buffer_load_dwordx4 v18, s[16:19], s35 offen lds
  s_mov_b32 m0, 153600
  s_add_u32 s35, s4, 196608
  buffer_load_dwordx4 v19, s[16:19], s35 offen lds
  s_mov_b32 m0, 154624
  s_add_u32 s35, s4, 229376
  buffer_load_dwordx4 v19, s[16:19], s35 offen lds
  s_mov_b32 m0, 32768
  s_add_u32 s35, s36, 32768
  buffer_load_dwordx4 v10, s[8:11], s35 offen nt lds
  buffer_load_dwordx4 v11, s[8:11], s35 offen offset:1024 nt lds
  buffer_load_dwordx4 v10, s[8:11], s35 offen offset:2048 nt lds
  buffer_load_dwordx4 v11, s[8:11], s35 offen offset:3072 nt lds
  s_mov_b32 m0, 36864
  s_add_u32 s35, s36, 36864
  buffer_load_dwordx4 v10, s[8:11], s35 offen nt lds
  buffer_load_dwordx4 v11, s[8:11], s35 offen offset:1024 nt lds
  buffer_load_dwordx4 v10, s[8:11], s35 offen offset:2048 nt lds
  buffer_load_dwordx4 v11, s[8:11], s35 offen offset:3072 nt lds
  s_mov_b32 m0, 40960
  s_add_u32 s35, s36, 40960
  buffer_load_dwordx4 v10, s[8:11], s35 offen nt lds
  buffer_load_dwordx4 v11, s[8:11], s35 offen offset:1024 nt lds
  buffer_load_dwordx4 v10, s[8:11], s35 offen offset:2048 nt lds
  buffer_load_dwordx4 v11, s[8:11], s35 offen offset:3072 nt lds
  s_mov_b32 m0, 45056
  s_add_u32 s35, s36, 45056
  buffer_load_dwordx4 v10, s[8:11], s35 offen nt lds
  buffer_load_dwordx4 v11, s[8:11], s35 offen offset:1024 nt lds
  buffer_load_dwordx4 v10, s[8:11], s35 offen offset:2048 nt lds
  buffer_load_dwordx4 v11, s[8:11], s35 offen offset:3072 nt lds
  s_waitcnt vmcnt(44)
  ds_write_b128 v12, v[24:27] offset:16384
  ds_write_b128 v12, v[28:31] offset:17408
  ds_write_b128 v12, v[32:35] offset:18432
  ds_write_b128 v12, v[36:39] offset:19456
  s_waitcnt vmcnt(40)
  ds_write_b128 v12, v[40:43] offset:20480
  ds_write_b128 v12, v[44:47] offset:21504
  ds_write_b128 v12, v[48:51] offset:22528
  ds_write_b128 v12, v[52:55] offset:23552
  s_waitcnt vmcnt(24)
  s_waitcnt lgkmcnt(0)
  s_barrier
  s_lshl_b32 s4, s70, 18
  s_add_u32 s4, s4, s37
  s_add_u32 s70, s70, 1
  s_and_b32 s70, s70, 15
  s_mov_b32 m0, 131072
  s_add_u32 s35, s4, 0
  buffer_load_dwordx4 v18, s[16:19], s35 offen lds
  s_mov_b32 m0, 132096
  s_add_u32 s35, s4, 32768
  buffer_load_dwordx4 v18, s[16:19], s35 offen lds
  s_mov_b32 m0, 133120
  s_add_u32 s35, s4, 65536
  buffer_load_dwordx4 v19, s[16:19], s35 offen lds
  s_mov_b32 m0, 134144
  s_add_u32 s35, s4, 98304
  buffer_load_dwordx4 v19, s[16:19], s35 offen lds
  s_mov_b32 m0, 135168
  s_add_u32 s35, s4, 131072
  buffer_load_dwordx4 v18, s[16:19], s35 offen lds
  s_mov_b32 m0, 136192
  s_add_u32 s35, s4, 163840
  buffer_load_dwordx4 v18, s[16:19], s35 offen lds
  s_mov_b32 m0, 137216
  s_add_u32 s35, s4, 196608
  buffer_load_dwordx4 v19, s[16:19], s35 offen lds
  s_mov_b32 m0, 138240
  s_add_u32 s35, s4, 229376
  buffer_load_dwordx4 v19, s[16:19], s35 offen lds
  s_mov_b32 m0, 49152
  s_add_u32 s35, s36, 49152
  buffer_load_dwordx4 v10, s[8:11], s35 offen nt lds
  buffer_load_dwordx4 v11, s[8:11], s35 offen offset:1024 nt lds
  buffer_load_dwordx4 v10, s[8:11], s35 offen offset:2048 nt lds
  buffer_load_dwordx4 v11, s[8:11], s35 offen offset:3072 nt lds
  s_mov_b32 m0, 53248
  s_add_u32 s35, s36, 53248
  buffer_load_dwordx4 v10, s[8:11], s35 offen nt lds
  buffer_load_dwordx4 v11, s[8:11], s35 offen offset:1024 nt lds
  buffer_load_dwordx4 v10, s[8:11], s35 offen offset:2048 nt lds
  buffer_load_dwordx4 v11, s[8:11], s35 offen offset:3072 nt lds
  s_mov_b32 m0, 57344
  s_add_u32 s35, s36, 57344
  buffer_load_dwordx4 v10, s[8:11], s35 offen nt lds
  buffer_load_dwordx4 v11, s[8:11], s35 offen offset:1024 nt lds
  buffer_load_dwordx4 v10, s[8:11], s35 offen offset:2048 nt lds
  buffer_load_dwordx4 v11, s[8:11], s35 offen offset:3072 nt lds
  s_mov_b32 m0, 61440
  s_add_u32 s35, s36, 61440
  buffer_load_dwordx4 v10, s[8:11], s35 offen nt lds
  buffer_load_dwordx4 v11, s[8:11], s35 offen offset:1024 nt lds
  buffer_load_dwordx4 v10, s[8:11], s35 offen offset:2048 nt lds
  buffer_load_dwordx4 v11, s[8:11], s35 offen offset:3072 nt lds
  s_mov_b32 m0, 0
  s_add_u32 s35, s36, 65536
  buffer_load_dwordx4 v10, s[8:11], s35 offen nt lds
  buffer_load_dwordx4 v11, s[8:11], s35 offen offset:1024 nt lds
  buffer_load_dwordx4 v10, s[8:11], s35 offen offset:2048 nt lds
  buffer_load_dwordx4 v11, s[8:11], s35 offen offset:3072 nt lds
  s_mov_b32 m0, 4096
  s_add_u32 s35, s36, 69632
  buffer_load_dwordx4 v10, s[8:11], s35 offen nt lds
  buffer_load_dwordx4 v11, s[8:11], s35 offen offset:1024 nt lds
  buffer_load_dwordx4 v10, s[8:11], s35 offen offset:2048 nt lds
  buffer_load_dwordx4 v11, s[8:11], s35 offen offset:3072 nt lds
  s_mov_b32 m0, 8192
  s_add_u32 s35, s36, 73728
  buffer_load_dwordx4 v10, s[8:11], s35 offen nt lds
  buffer_load_dwordx4 v11, s[8:11], s35 offen offset:1024 nt lds
  buffer_load_dwordx4 v10, s[8:11], s35 offen offset:2048 nt lds
  buffer_load_dwordx4 v11, s[8:11], s35 offen offset:3072 nt lds
  s_mov_b32 m0, 12288
  s_add_u32 s35, s36, 77824
  buffer_load_dwordx4 v10, s[8:11], s35 offen nt lds
  buffer_load_dwordx4 v11, s[8:11], s35 offen offset:1024 nt lds
  buffer_load_dwordx4 v10, s[8:11], s35 offen offset:2048 nt lds
  buffer_load_dwordx4 v11, s[8:11], s35 offen offset:3072 nt lds
  s_waitcnt vmcnt(40)
  s_barrier
  s_lshl_b32 s4, s70, 18
  s_add_u32 s4, s4, s37
  s_add_u32 s70, s70, 1
  s_and_b32 s70, s70, 15
  s_mov_b32 m0, 139264
  s_add_u32 s35, s4, 0
  buffer_load_dwordx4 v18, s[16:19], s35 offen lds
  s_mov_b32 m0, 140288
  s_add_u32 s35, s4, 32768
  buffer_load_dwordx4 v18, s[16:19], s35 offen lds
  s_mov_b32 m0, 141312
  s_add_u32 s35, s4, 65536
  buffer_load_dwordx4 v19, s[16:19], s35 offen lds
  s_mov_b32 m0, 142336
  s_add_u32 s35, s4, 98304
  buffer_load_dwordx4 v19, s[16:19], s35 offen lds
  s_mov_b32 m0, 143360
  s_add_u32 s35, s4, 131072
  buffer_load_dwordx4 v18, s[16:19], s35 offen lds
  s_mov_b32 m0, 144384
  s_add_u32 s35, s4, 163840
  buffer_load_dwordx4 v18, s[16:19], s35 offen lds
  s_mov_b32 m0, 145408
  s_add_u32 s35, s4, 196608
  buffer_load_dwordx4 v19, s[16:19], s35 offen lds
  s_mov_b32 m0, 146432
  s_add_u32 s35, s4, 229376
  buffer_load_dwordx4 v19, s[16:19], s35 offen lds
  s_mov_b32 m0, 16384
  s_add_u32 s35, s36, 81920
  buffer_load_dwordx4 v10, s[8:11], s35 offen nt lds
  buffer_load_dwordx4 v11, s[8:11], s35 offen offset:1024 nt lds
  buffer_load_dwordx4 v10, s[8:11], s35 offen offset:2048 nt lds
  buffer_load_dwordx4 v11, s[8:11], s35 offen offset:3072 nt lds
  s_mov_b32 m0, 20480
  s_add_u32 s35, s36, 86016
  buffer_load_dwordx4 v10, s[8:11], s35 offen nt lds
  buffer_load_dwordx4 v11, s[8:11], s35 offen offset:1024 nt lds
  buffer_load_dwordx4 v10, s[8:11], s35 offen offset:2048 nt lds
  buffer_load_dwordx4 v11, s[8:11], s35 offen offset:3072 nt lds
  s_mov_b32 m0, 24576
  s_add_u32 s35, s36, 90112
  buffer_load_dwordx4 v10, s[8:11], s35 offen nt lds
  buffer_load_dwordx4 v11, s[8:11], s35 offen offset:1024 nt lds
  buffer_load_dwordx4 v10, s[8:11], s35 offen offset:2048 nt lds
  buffer_load_dwordx4 v11, s[8:11], s35 offen offset:3072 nt lds
  s_mov_b32 m0, 28672
  s_add_u32 s35, s36, 94208
  buffer_load_dwordx4 v10, s[8:11], s35 offen nt lds
  buffer_load_dwordx4 v11, s[8:11], s35 offen offset:1024 nt lds
  buffer_load_dwordx4 v10, s[8:11], s35 offen offset:2048 nt lds
  buffer_load_dwordx4 v11, s[8:11], s35 offen offset:3072 nt lds
  s_waitcnt vmcnt(40)
  s_barrier
  s_lshl_b32 s4, s70, 18
  s_add_u32 s4, s4, s37
  s_add_u32 s70, s70, 1
  s_and_b32 s70, s70, 15
  s_mov_b32 m0, 147456
  s_add_u32 s35, s4, 0
  buffer_load_dwordx4 v18, s[16:19], s35 offen lds
  s_mov_b32 m0, 148480
  s_add_u32 s35, s4, 32768
  buffer_load_dwordx4 v18, s[16:19], s35 offen lds
  s_mov_b32 m0, 149504
  s_add_u32 s35, s4, 65536
  buffer_load_dwordx4 v19, s[16:19], s35 offen lds
  s_mov_b32 m0, 150528
  s_add_u32 s35, s4, 98304
  buffer_load_dwordx4 v19, s[16:19], s35 offen lds
  s_mov_b32 m0, 151552
  s_add_u32 s35, s4, 131072
  buffer_load_dwordx4 v18, s[16:19], s35 offen lds
  s_mov_b32 m0, 152576
  s_add_u32 s35, s4, 163840
  buffer_load_dwordx4 v18, s[16:19], s35 offen lds
  s_mov_b32 m0, 153600
  s_add_u32 s35, s4, 196608
  buffer_load_dwordx4 v19, s[16:19], s35 offen lds
  s_mov_b32 m0, 154624
  s_add_u32 s35, s4, 229376
  buffer_load_dwordx4 v19, s[16:19], s35 offen lds
  s_mov_b32 m0, 32768
  s_add_u32 s35, s36, 98304
  buffer_load_dwordx4 v10, s[8:11], s35 offen nt lds
  buffer_load_dwordx4 v11, s[8:11], s35 offen offset:1024 nt lds
  buffer_load_dwordx4 v10, s[8:11], s35 offen offset:2048 nt lds
  buffer_load_dwordx4 v11, s[8:11], s35 offen offset:3072 nt lds
  s_mov_b32 m0, 36864
  s_add_u32 s35, s36, 102400
  buffer_load_dwordx4 v10, s[8:11], s35 offen nt lds
  buffer_load_dwordx4 v11, s[8:11], s35 offen offset:1024 nt lds
  buffer_load_dwordx4 v10, s[8:11], s35 offen offset:2048 nt lds
  buffer_load_dwordx4 v11, s[8:11], s35 offen offset:3072 nt lds
  s_mov_b32 m0, 40960
  s_add_u32 s35, s36, 106496
  buffer_load_dwordx4 v10, s[8:11], s35 offen nt lds
  buffer_load_dwordx4 v11, s[8:11], s35 offen offset:1024 nt lds
  buffer_load_dwordx4 v10, s[8:11], s35 offen offset:2048 nt lds
  buffer_load_dwordx4 v11, s[8:11], s35 offen offset:3072 nt lds
  s_mov_b32 m0, 45056
  s_add_u32 s35, s36, 110592
  buffer_load_dwordx4 v10, s[8:11], s35 offen nt lds
  buffer_load_dwordx4 v11, s[8:11], s35 offen offset:1024 nt lds
  buffer_load_dwordx4 v10, s[8:11], s35 offen offset:2048 nt lds
  buffer_load_dwordx4 v11, s[8:11], s35 offen offset:3072 nt lds
  s_waitcnt vmcnt(40)
  s_barrier
  s_lshl_b32 s4, s70, 18
  s_add_u32 s4, s4, s37
  s_add_u32 s70, s70, 1
  s_and_b32 s70, s70, 15
  s_mov_b32 m0, 131072
  s_add_u32 s35, s4, 0
  buffer_load_dwordx4 v18, s[16:19], s35 offen lds
  s_mov_b32 m0, 132096
  s_add_u32 s35, s4, 32768
  buffer_load_dwordx4 v18, s[16:19], s35 offen lds
  s_mov_b32 m0, 133120
  s_add_u32 s35, s4, 65536
  buffer_load_dwordx4 v19, s[16:19], s35 offen lds
  s_mov_b32 m0, 134144
  s_add_u32 s35, s4, 98304
  buffer_load_dwordx4 v19, s[16:19], s35 offen lds
  s_mov_b32 m0, 135168
  s_add_u32 s35, s4, 131072
  buffer_load_dwordx4 v18, s[16:19], s35 offen lds
  s_mov_b32 m0, 136192
  s_add_u32 s35, s4, 163840
  buffer_load_dwordx4 v18, s[16:19], s35 offen lds
  s_mov_b32 m0, 137216
  s_add_u32 s35, s4, 196608
  buffer_load_dwordx4 v19, s[16:19], s35 offen lds
  s_mov_b32 m0, 138240
  s_add_u32 s35, s4, 229376
  buffer_load_dwordx4 v19, s[16:19], s35 offen lds
  s_mov_b32 m0, 49152
  s_add_u32 s35, s36, 114688
  buffer_load_dwordx4 v10, s[8:11], s35 offen nt lds
  buffer_load_dwordx4 v11, s[8:11], s35 offen offset:1024 nt lds
  buffer_load_dwordx4 v10, s[8:11], s35 offen offset:2048 nt lds
  buffer_load_dwordx4 v11, s[8:11], s35 offen offset:3072 nt lds
  s_mov_b32 m0, 53248
  s_add_u32 s35, s36, 118784
  buffer_load_dwordx4 v10, s[8:11], s35 offen nt lds
  buffer_load_dwordx4 v11, s[8:11], s35 offen offset:1024 nt lds
  buffer_load_dwordx4 v10, s[8:11], s35 offen offset:2048 nt lds
  buffer_load_dwordx4 v11, s[8:11], s35 offen offset:3072 nt lds
  s_mov_b32 m0, 57344
  s_add_u32 s35, s36, 122880
  buffer_load_dwordx4 v10, s[8:11], s35 offen nt lds
  buffer_load_dwordx4 v11, s[8:11], s35 offen offset:1024 nt lds
  buffer_load_dwordx4 v10, s[8:11], s35 offen offset:2048 nt lds
  buffer_load_dwordx4 v11, s[8:11], s35 offen offset:3072 nt lds
  s_mov_b32 m0, 61440
  s_add_u32 s35, s36, 126976
  buffer_load_dwordx4 v10, s[8:11], s35 offen nt lds
  buffer_load_dwordx4 v11, s[8:11], s35 offen offset:1024 nt lds
  buffer_load_dwordx4 v10, s[8:11], s35 offen offset:2048 nt lds
  buffer_load_dwordx4 v11, s[8:11], s35 offen offset:3072 nt lds
  s_waitcnt vmcnt(40)
  s_barrier
  s_lshl_b32 s4, s70, 18
  s_add_u32 s4, s4, s37
  s_add_u32 s70, s70, 1
  s_and_b32 s70, s70, 15
  s_mov_b32 m0, 139264
  s_add_u32 s35, s4, 0
  buffer_load_dwordx4 v18, s[16:19], s35 offen lds
  s_mov_b32 m0, 140288
  s_add_u32 s35, s4, 32768
  buffer_load_dwordx4 v18, s[16:19], s35 offen lds
  s_mov_b32 m0, 141312
  s_add_u32 s35, s4, 65536
  buffer_load_dwordx4 v19, s[16:19], s35 offen lds
  s_mov_b32 m0, 142336
  s_add_u32 s35, s4, 98304
  buffer_load_dwordx4 v19, s[16:19], s35 offen lds
  s_mov_b32 m0, 143360
  s_add_u32 s35, s4, 131072
  buffer_load_dwordx4 v18, s[16:19], s35 offen lds
  s_mov_b32 m0, 144384
  s_add_u32 s35, s4, 163840
  buffer_load_dwordx4 v18, s[16:19], s35 offen lds
  s_mov_b32 m0, 145408
  s_add_u32 s35, s4, 196608
  buffer_load_dwordx4 v19, s[16:19], s35 offen lds
  s_mov_b32 m0, 146432
  s_add_u32 s35, s4, 229376
  buffer_load_dwordx4 v19, s[16:19], s35 offen lds
  s_mov_b32 m0, 0
  s_add_u32 s35, s36, 131072
  buffer_load_dwordx4 v10, s[8:11], s35 offen nt lds
  buffer_load_dwordx4 v11, s[8:11], s35 offen offset:1024 nt lds
  buffer_load_dwordx4 v10, s[8:11], s35 offen offset:2048 nt lds
  buffer_load_dwordx4 v11, s[8:11], s35 offen offset:3072 nt lds
  s_mov_b32 m0, 4096
  s_add_u32 s35, s36, 135168
  buffer_load_dwordx4 v10, s[8:11], s35 offen nt lds
  buffer_load_dwordx4 v11, s[8:11], s35 offen offset:1024 nt lds
  buffer_load_dwordx4 v10, s[8:11], s35 offen offset:2048 nt lds
  buffer_load_dwordx4 v11, s[8:11], s35 offen offset:3072 nt lds
  s_mov_b32 m0, 8192
  s_add_u32 s35, s36, 139264
  buffer_load_dwordx4 v10, s[8:11], s35 offen nt lds
  buffer_load_dwordx4 v11, s[8:11], s35 offen offset:1024 nt lds
  buffer_load_dwordx4 v10, s[8:11], s35 offen offset:2048 nt lds
  buffer_load_dwordx4 v11, s[8:11], s35 offen offset:3072 nt lds
  s_mov_b32 m0, 12288
  s_add_u32 s35, s36, 143360
  buffer_load_dwordx4 v10, s[8:11], s35 offen nt lds
  buffer_load_dwordx4 v11, s[8:11], s35 offen offset:1024 nt lds
  buffer_load_dwordx4 v10, s[8:11], s35 offen offset:2048 nt lds
  buffer_load_dwordx4 v11, s[8:11], s35 offen offset:3072 nt lds
  s_waitcnt vmcnt(40)
  s_barrier
  s_lshl_b32 s4, s70, 18
  s_add_u32 s4, s4, s37
  s_add_u32 s70, s70, 1
  s_and_b32 s70, s70, 15
  s_mov_b32 m0, 147456
  s_add_u32 s35, s4, 0
  buffer_load_dwordx4 v18, s[16:19], s35 offen lds
  s_mov_b32 m0, 148480
  s_add_u32 s35, s4, 32768
  buffer_load_dwordx4 v18, s[16:19], s35 offen lds
  s_mov_b32 m0, 149504
  s_add_u32 s35, s4, 65536
  buffer_load_dwordx4 v19, s[16:19], s35 offen lds
  s_mov_b32 m0, 150528
  s_add_u32 s35, s4, 98304
  buffer_load_dwordx4 v19, s[16:19], s35 offen lds
  s_mov_b32 m0, 151552
  s_add_u32 s35, s4, 131072
  buffer_load_dwordx4 v18, s[16:19], s35 offen lds
  s_mov_b32 m0, 152576
  s_add_u32 s35, s4, 163840
  buffer_load_dwordx4 v18, s[16:19], s35 offen lds
  s_mov_b32 m0, 153600
  s_add_u32 s35, s4, 196608
  buffer_load_dwordx4 v19, s[16:19], s35 offen lds
  s_mov_b32 m0, 154624
  s_add_u32 s35, s4, 229376
  buffer_load_dwordx4 v19, s[16:19], s35 offen lds
  s_mov_b32 m0, 16384
  s_add_u32 s35, s36, 147456
  buffer_load_dwordx4 v10, s[8:11], s35 offen nt lds
  buffer_load_dwordx4 v11, s[8:11], s35 offen offset:1024 nt lds
  buffer_load_dwordx4 v10, s[8:11], s35 offen offset:2048 nt lds
  buffer_load_dwordx4 v11, s[8:11], s35 offen offset:3072 nt lds
  s_mov_b32 m0, 20480
  s_add_u32 s35, s36, 151552
  buffer_load_dwordx4 v10, s[8:11], s35 offen nt lds
  buffer_load_dwordx4 v11, s[8:11], s35 offen offset:1024 nt lds
  buffer_load_dwordx4 v10, s[8:11], s35 offen offset:2048 nt lds
  buffer_load_dwordx4 v11, s[8:11], s35 offen offset:3072 nt lds
  s_mov_b32 m0, 24576
  s_add_u32 s35, s36, 155648
  buffer_load_dwordx4 v10, s[8:11], s35 offen nt lds
  buffer_load_dwordx4 v11, s[8:11], s35 offen offset:1024 nt lds
  buffer_load_dwordx4 v10, s[8:11], s35 offen offset:2048 nt lds
  buffer_load_dwordx4 v11, s[8:11], s35 offen offset:3072 nt lds
  s_mov_b32 m0, 28672
  s_add_u32 s35, s36, 159744
  buffer_load_dwordx4 v10, s[8:11], s35 offen nt lds
  buffer_load_dwordx4 v11, s[8:11], s35 offen offset:1024 nt lds
  buffer_load_dwordx4 v10, s[8:11], s35 offen offset:2048 nt lds
  buffer_load_dwordx4 v11, s[8:11], s35 offen offset:3072 nt lds
  s_waitcnt vmcnt(40)
  s_barrier
  s_lshl_b32 s4, s70, 18
  s_add_u32 s4, s4, s37
  s_add_u32 s70, s70, 1
  s_and_b32 s70, s70, 15
  s_mov_b32 m0, 131072
  s_add_u32 s35, s4, 0
  buffer_load_dwordx4 v18, s[16:19], s35 offen lds
  s_mov_b32 m0, 132096
  s_add_u32 s35, s4, 32768
  buffer_load_dwordx4 v18, s[16:19], s35 offen lds
  s_mov_b32 m0, 133120
  s_add_u32 s35, s4, 65536
  buffer_load_dwordx4 v19, s[16:19], s35 offen lds
  s_mov_b32 m0, 134144
  s_add_u32 s35, s4, 98304
  buffer_load_dwordx4 v19, s[16:19], s35 offen lds
  s_mov_b32 m0, 135168
  s_add_u32 s35, s4, 131072
  buffer_load_dwordx4 v18, s[16:19], s35 offen lds
  s_mov_b32 m0, 136192
  s_add_u32 s35, s4, 163840
  buffer_load_dwordx4 v18, s[16:19], s35 offen lds
  s_mov_b32 m0, 137216
  s_add_u32 s35, s4, 196608
  buffer_load_dwordx4 v19, s[16:19], s35 offen lds
  s_mov_b32 m0, 138240
  s_add_u32 s35, s4, 229376
  buffer_load_dwordx4 v19, s[16:19], s35 offen lds
  s_mov_b32 m0, 32768
  s_add_u32 s35, s36, 163840
  buffer_load_dwordx4 v10, s[8:11], s35 offen nt lds
  buffer_load_dwordx4 v11, s[8:11], s35 offen offset:1024 nt lds
  buffer_load_dwordx4 v10, s[8:11], s35 offen offset:2048 nt lds
  buffer_load_dwordx4 v11, s[8:11], s35 offen offset:3072 nt lds
  s_mov_b32 m0, 36864
  s_add_u32 s35, s36, 167936
  buffer_load_dwordx4 v10, s[8:11], s35 offen nt lds
  buffer_load_dwordx4 v11, s[8:11], s35 offen offset:1024 nt lds
  buffer_load_dwordx4 v10, s[8:11], s35 offen offset:2048 nt lds
  buffer_load_dwordx4 v11, s[8:11], s35 offen offset:3072 nt lds
  s_mov_b32 m0, 40960
  s_add_u32 s35, s36, 172032
  buffer_load_dwordx4 v10, s[8:11], s35 offen nt lds
  buffer_load_dwordx4 v11, s[8:11], s35 offen offset:1024 nt lds
  buffer_load_dwordx4 v10, s[8:11], s35 offen offset:2048 nt lds
  buffer_load_dwordx4 v11, s[8:11], s35 offen offset:3072 nt lds
  s_mov_b32 m0, 45056
  s_add_u32 s35, s36, 176128
  buffer_load_dwordx4 v10, s[8:11], s35 offen nt lds
  buffer_load_dwordx4 v11, s[8:11], s35 offen offset:1024 nt lds
  buffer_load_dwordx4 v10, s[8:11], s35 offen offset:2048 nt lds
  buffer_load_dwordx4 v11, s[8:11], s35 offen offset:3072 nt lds
  s_waitcnt vmcnt(40)
  s_barrier
  s_lshl_b32 s4, s70, 18
  s_add_u32 s4, s4, s37
  s_add_u32 s70, s70, 1
  s_and_b32 s70, s70, 15
  s_mov_b32 m0, 139264
  s_add_u32 s35, s4, 0
  buffer_load_dwordx4 v18, s[16:19], s35 offen lds
  s_mov_b32 m0, 140288
  s_add_u32 s35, s4, 32768
  buffer_load_dwordx4 v18, s[16:19], s35 offen lds
  s_mov_b32 m0, 141312
  s_add_u32 s35, s4, 65536
  buffer_load_dwordx4 v19, s[16:19], s35 offen lds
  s_mov_b32 m0, 142336
  s_add_u32 s35, s4, 98304
  buffer_load_dwordx4 v19, s[16:19], s35 offen lds
  s_mov_b32 m0, 143360
  s_add_u32 s35, s4, 131072
  buffer_load_dwordx4 v18, s[16:19], s35 offen lds
  s_mov_b32 m0, 144384
  s_add_u32 s35, s4, 163840
  buffer_load_dwordx4 v18, s[16:19], s35 offen lds
  s_mov_b32 m0, 145408
  s_add_u32 s35, s4, 196608
  buffer_load_dwordx4 v19, s[16:19], s35 offen lds
  s_mov_b32 m0, 146432
  s_add_u32 s35, s4, 229376
  buffer_load_dwordx4 v19, s[16:19], s35 offen lds
  s_mov_b32 m0, 49152
  s_add_u32 s35, s36, 180224
  buffer_load_dwordx4 v10, s[8:11], s35 offen nt lds
  buffer_load_dwordx4 v11, s[8:11], s35 offen offset:1024 nt lds
  buffer_load_dwordx4 v10, s[8:11], s35 offen offset:2048 nt lds
  buffer_load_dwordx4 v11, s[8:11], s35 offen offset:3072 nt lds
  s_mov_b32 m0, 53248
  s_add_u32 s35, s36, 184320
  buffer_load_dwordx4 v10, s[8:11], s35 offen nt lds
  buffer_load_dwordx4 v11, s[8:11], s35 offen offset:1024 nt lds
  buffer_load_dwordx4 v10, s[8:11], s35 offen offset:2048 nt lds
  buffer_load_dwordx4 v11, s[8:11], s35 offen offset:3072 nt lds
  s_mov_b32 m0, 57344
  s_add_u32 s35, s36, 188416
  buffer_load_dwordx4 v10, s[8:11], s35 offen nt lds
  buffer_load_dwordx4 v11, s[8:11], s35 offen offset:1024 nt lds
  buffer_load_dwordx4 v10, s[8:11], s35 offen offset:2048 nt lds
  buffer_load_dwordx4 v11, s[8:11], s35 offen offset:3072 nt lds
  s_mov_b32 m0, 61440
  s_add_u32 s35, s36, 192512
  buffer_load_dwordx4 v10, s[8:11], s35 offen nt lds
  buffer_load_dwordx4 v11, s[8:11], s35 offen offset:1024 nt lds
  buffer_load_dwordx4 v10, s[8:11], s35 offen offset:2048 nt lds
  buffer_load_dwordx4 v11, s[8:11], s35 offen offset:3072 nt lds
  s_waitcnt vmcnt(40)
  s_barrier
  s_lshl_b32 s4, s70, 18
  s_add_u32 s4, s4, s37
  s_add_u32 s70, s70, 1
  s_and_b32 s70, s70, 15
  s_mov_b32 m0, 147456
  s_add_u32 s35, s4, 0
  buffer_load_dwordx4 v18, s[16:19], s35 offen lds
  s_mov_b32 m0, 148480
  s_add_u32 s35, s4, 32768
  buffer_load_dwordx4 v18, s[16:19], s35 offen lds
  s_mov_b32 m0, 149504
  s_add_u32 s35, s4, 65536
  buffer_load_dwordx4 v19, s[16:19], s35 offen lds
  s_mov_b32 m0, 150528
  s_add_u32 s35, s4, 98304
  buffer_load_dwordx4 v19, s[16:19], s35 offen lds
  s_mov_b32 m0, 151552
  s_add_u32 s35, s4, 131072
  buffer_load_dwordx4 v18, s[16:19], s35 offen lds
  s_mov_b32 m0, 152576
  s_add_u32 s35, s4, 163840
  buffer_load_dwordx4 v18, s[16:19], s35 offen lds
  s_mov_b32 m0, 153600
  s_add_u32 s35, s4, 196608
  buffer_load_dwordx4 v19, s[16:19], s35 offen lds
  s_mov_b32 m0, 154624
  s_add_u32 s35, s4, 229376
  buffer_load_dwordx4 v19, s[16:19], s35 offen lds
  s_mov_b32 m0, 0
  s_add_u32 s35, s36, 196608
  buffer_load_dwordx4 v10, s[8:11], s35 offen nt lds
  buffer_load_dwordx4 v11, s[8:11], s35 offen offset:1024 nt lds
  buffer_load_dwordx4 v10, s[8:11], s35 offen offset:2048 nt lds
  buffer_load_dwordx4 v11, s[8:11], s35 offen offset:3072 nt lds
  s_mov_b32 m0, 4096
  s_add_u32 s35, s36, 200704
  buffer_load_dwordx4 v10, s[8:11], s35 offen nt lds
  buffer_load_dwordx4 v11, s[8:11], s35 offen offset:1024 nt lds
  buffer_load_dwordx4 v10, s[8:11], s35 offen offset:2048 nt lds
  buffer_load_dwordx4 v11, s[8:11], s35 offen offset:3072 nt lds
  s_mov_b32 m0, 8192
  s_add_u32 s35, s36, 204800
  buffer_load_dwordx4 v10, s[8:11], s35 offen nt lds
  buffer_load_dwordx4 v11, s[8:11], s35 offen offset:1024 nt lds
  buffer_load_dwordx4 v10, s[8:11], s35 offen offset:2048 nt lds
  buffer_load_dwordx4 v11, s[8:11], s35 offen offset:3072 nt lds
  s_mov_b32 m0, 12288
  s_add_u32 s35, s36, 208896
  buffer_load_dwordx4 v10, s[8:11], s35 offen nt lds
  buffer_load_dwordx4 v11, s[8:11], s35 offen offset:1024 nt lds
  buffer_load_dwordx4 v10, s[8:11], s35 offen offset:2048 nt lds
  buffer_load_dwordx4 v11, s[8:11], s35 offen offset:3072 nt lds
  s_waitcnt vmcnt(40)
  s_barrier
  s_lshl_b32 s4, s70, 18
  s_add_u32 s4, s4, s37
  s_add_u32 s70, s70, 1
  s_and_b32 s70, s70, 15
  s_mov_b32 m0, 131072
  s_add_u32 s35, s4, 0
  buffer_load_dwordx4 v18, s[16:19], s35 offen lds
  s_mov_b32 m0, 132096
  s_add_u32 s35, s4, 32768
  buffer_load_dwordx4 v18, s[16:19], s35 offen lds
  s_mov_b32 m0, 133120
  s_add_u32 s35, s4, 65536
  buffer_load_dwordx4 v19, s[16:19], s35 offen lds
  s_mov_b32 m0, 134144
  s_add_u32 s35, s4, 98304
  buffer_load_dwordx4 v19, s[16:19], s35 offen lds
  s_mov_b32 m0, 135168
  s_add_u32 s35, s4, 131072
  buffer_load_dwordx4 v18, s[16:19], s35 offen lds
  s_mov_b32 m0, 136192
  s_add_u32 s35, s4, 163840
  buffer_load_dwordx4 v18, s[16:19], s35 offen lds
  s_mov_b32 m0, 137216
  s_add_u32 s35, s4, 196608
  buffer_load_dwordx4 v19, s[16:19], s35 offen lds
  s_mov_b32 m0, 138240
  s_add_u32 s35, s4, 229376
  buffer_load_dwordx4 v19, s[16:19], s35 offen lds
  s_mov_b32 m0, 16384
  s_add_u32 s35, s36, 212992
  buffer_load_dwordx4 v10, s[8:11], s35 offen nt lds
  buffer_load_dwordx4 v11, s[8:11], s35 offen offset:1024 nt lds
  buffer_load_dwordx4 v10, s[8:11], s35 offen offset:2048 nt lds
  buffer_load_dwordx4 v11, s[8:11], s35 offen offset:3072 nt lds
  s_mov_b32 m0, 20480
  s_add_u32 s35, s36, 217088
  buffer_load_dwordx4 v10, s[8:11], s35 offen nt lds
  buffer_load_dwordx4 v11, s[8:11], s35 offen offset:1024 nt lds
  buffer_load_dwordx4 v10, s[8:11], s35 offen offset:2048 nt lds
  buffer_load_dwordx4 v11, s[8:11], s35 offen offset:3072 nt lds
  s_mov_b32 m0, 24576
  s_add_u32 s35, s36, 221184
  buffer_load_dwordx4 v10, s[8:11], s35 offen nt lds
  buffer_load_dwordx4 v11, s[8:11], s35 offen offset:1024 nt lds
  buffer_load_dwordx4 v10, s[8:11], s35 offen offset:2048 nt lds
  buffer_load_dwordx4 v11, s[8:11], s35 offen offset:3072 nt lds
  s_mov_b32 m0, 28672
  s_add_u32 s35, s36, 225280
  buffer_load_dwordx4 v10, s[8:11], s35 offen nt lds
  buffer_load_dwordx4 v11, s[8:11], s35 offen offset:1024 nt lds
  buffer_load_dwordx4 v10, s[8:11], s35 offen offset:2048 nt lds
  buffer_load_dwordx4 v11, s[8:11], s35 offen offset:3072 nt lds
  s_waitcnt vmcnt(40)
  s_barrier
  s_lshl_b32 s4, s70, 18
  s_add_u32 s4, s4, s37
  s_add_u32 s70, s70, 1
  s_and_b32 s70, s70, 15
  s_mov_b32 m0, 139264
  s_add_u32 s35, s4, 0
  buffer_load_dwordx4 v18, s[16:19], s35 offen lds
  s_mov_b32 m0, 140288
  s_add_u32 s35, s4, 32768
  buffer_load_dwordx4 v18, s[16:19], s35 offen lds
  s_mov_b32 m0, 141312
  s_add_u32 s35, s4, 65536
  buffer_load_dwordx4 v19, s[16:19], s35 offen lds
  s_mov_b32 m0, 142336
  s_add_u32 s35, s4, 98304
  buffer_load_dwordx4 v19, s[16:19], s35 offen lds
  s_mov_b32 m0, 143360
  s_add_u32 s35, s4, 131072
  buffer_load_dwordx4 v18, s[16:19], s35 offen lds
  s_mov_b32 m0, 144384
  s_add_u32 s35, s4, 163840
  buffer_load_dwordx4 v18, s[16:19], s35 offen lds
  s_mov_b32 m0, 145408
  s_add_u32 s35, s4, 196608
  buffer_load_dwordx4 v19, s[16:19], s35 offen lds
  s_mov_b32 m0, 146432
  s_add_u32 s35, s4, 229376
  buffer_load_dwordx4 v19, s[16:19], s35 offen lds
  s_mov_b32 m0, 32768
  s_add_u32 s35, s36, 229376
  buffer_load_dwordx4 v10, s[8:11], s35 offen nt lds
  buffer_load_dwordx4 v11, s[8:11], s35 offen offset:1024 nt lds
  buffer_load_dwordx4 v10, s[8:11], s35 offen offset:2048 nt lds
  buffer_load_dwordx4 v11, s[8:11], s35 offen offset:3072 nt lds
  s_mov_b32 m0, 36864
  s_add_u32 s35, s36, 233472
  buffer_load_dwordx4 v10, s[8:11], s35 offen nt lds
  buffer_load_dwordx4 v11, s[8:11], s35 offen offset:1024 nt lds
  buffer_load_dwordx4 v10, s[8:11], s35 offen offset:2048 nt lds
  buffer_load_dwordx4 v11, s[8:11], s35 offen offset:3072 nt lds
  s_mov_b32 m0, 40960
  s_add_u32 s35, s36, 237568
  buffer_load_dwordx4 v10, s[8:11], s35 offen nt lds
  buffer_load_dwordx4 v11, s[8:11], s35 offen offset:1024 nt lds
  buffer_load_dwordx4 v10, s[8:11], s35 offen offset:2048 nt lds
  buffer_load_dwordx4 v11, s[8:11], s35 offen offset:3072 nt lds
  s_mov_b32 m0, 45056
  s_add_u32 s35, s36, 241664
  buffer_load_dwordx4 v10, s[8:11], s35 offen nt lds
  buffer_load_dwordx4 v11, s[8:11], s35 offen offset:1024 nt lds
  buffer_load_dwordx4 v10, s[8:11], s35 offen offset:2048 nt lds
  buffer_load_dwordx4 v11, s[8:11], s35 offen offset:3072 nt lds
  s_waitcnt vmcnt(40)
  s_barrier
  s_lshl_b32 s4, s70, 18
  s_add_u32 s4, s4, s37
  s_add_u32 s70, s70, 1
  s_and_b32 s70, s70, 15
  s_mov_b32 m0, 147456
  s_add_u32 s35, s4, 0
  buffer_load_dwordx4 v18, s[16:19], s35 offen lds
  s_mov_b32 m0, 148480
  s_add_u32 s35, s4, 32768
  buffer_load_dwordx4 v18, s[16:19], s35 offen lds
  s_mov_b32 m0, 149504
  s_add_u32 s35, s4, 65536
  buffer_load_dwordx4 v19, s[16:19], s35 offen lds
  s_mov_b32 m0, 150528
  s_add_u32 s35, s4, 98304
  buffer_load_dwordx4 v19, s[16:19], s35 offen lds
  s_mov_b32 m0, 151552
  s_add_u32 s35, s4, 131072
  buffer_load_dwordx4 v18, s[16:19], s35 offen lds
  s_mov_b32 m0, 152576
  s_add_u32 s35, s4, 163840
  buffer_load_dwordx4 v18, s[16:19], s35 offen lds
  s_mov_b32 m0, 153600
  s_add_u32 s35, s4, 196608
  buffer_load_dwordx4 v19, s[16:19], s35 offen lds
  s_mov_b32 m0, 154624
  s_add_u32 s35, s4, 229376
  buffer_load_dwordx4 v19, s[16:19], s35 offen lds
  s_mov_b32 m0, 49152
  s_add_u32 s35, s36, 245760
  buffer_load_dwordx4 v10, s[8:11], s35 offen nt lds
  buffer_load_dwordx4 v11, s[8:11], s35 offen offset:1024 nt lds
  buffer_load_dwordx4 v10, s[8:11], s35 offen offset:2048 nt lds
  buffer_load_dwordx4 v11, s[8:11], s35 offen offset:3072 nt lds
  s_mov_b32 m0, 53248
  s_add_u32 s35, s36, 249856
  buffer_load_dwordx4 v10, s[8:11], s35 offen nt lds
  buffer_load_dwordx4 v11, s[8:11], s35 offen offset:1024 nt lds
  buffer_load_dwordx4 v10, s[8:11], s35 offen offset:2048 nt lds
  buffer_load_dwordx4 v11, s[8:11], s35 offen offset:3072 nt lds
  s_mov_b32 m0, 57344
  s_add_u32 s35, s36, 253952
  buffer_load_dwordx4 v10, s[8:11], s35 offen nt lds
  buffer_load_dwordx4 v11, s[8:11], s35 offen offset:1024 nt lds
  buffer_load_dwordx4 v10, s[8:11], s35 offen offset:2048 nt lds
  buffer_load_dwordx4 v11, s[8:11], s35 offen offset:3072 nt lds
  s_mov_b32 m0, 61440
  s_add_u32 s35, s36, 258048
  buffer_load_dwordx4 v10, s[8:11], s35 offen nt lds
  buffer_load_dwordx4 v11, s[8:11], s35 offen offset:1024 nt lds
  buffer_load_dwordx4 v10, s[8:11], s35 offen offset:2048 nt lds
  buffer_load_dwordx4 v11, s[8:11], s35 offen offset:3072 nt lds
  s_waitcnt vmcnt(40)
  s_barrier
  s_lshl_b32 s4, s70, 18
  s_add_u32 s4, s4, s37
  s_add_u32 s70, s70, 1
  s_and_b32 s70, s70, 15
  s_mov_b32 m0, 131072
  s_add_u32 s35, s4, 0
  buffer_load_dwordx4 v18, s[16:19], s35 offen lds
  s_mov_b32 m0, 132096
  s_add_u32 s35, s4, 32768
  buffer_load_dwordx4 v18, s[16:19], s35 offen lds
  s_mov_b32 m0, 133120
  s_add_u32 s35, s4, 65536
  buffer_load_dwordx4 v19, s[16:19], s35 offen lds
  s_mov_b32 m0, 134144
  s_add_u32 s35, s4, 98304
  buffer_load_dwordx4 v19, s[16:19], s35 offen lds
  s_mov_b32 m0, 135168
  s_add_u32 s35, s4, 131072
  buffer_load_dwordx4 v18, s[16:19], s35 offen lds
  s_mov_b32 m0, 136192
  s_add_u32 s35, s4, 163840
  buffer_load_dwordx4 v18, s[16:19], s35 offen lds
  s_mov_b32 m0, 137216
  s_add_u32 s35, s4, 196608
  buffer_load_dwordx4 v19, s[16:19], s35 offen lds
  s_mov_b32 m0, 138240
  s_add_u32 s35, s4, 229376
  buffer_load_dwordx4 v19, s[16:19], s35 offen lds
  s_mov_b32 m0, 0
  s_add_u32 s35, s36, 33554432
  buffer_load_dwordx4 v10, s[8:11], s35 offen nt lds
  buffer_load_dwordx4 v11, s[8:11], s35 offen offset:1024 nt lds
  buffer_load_dwordx4 v10, s[8:11], s35 offen offset:2048 nt lds
  buffer_load_dwordx4 v11, s[8:11], s35 offen offset:3072 nt lds
  s_mov_b32 m0, 4096
  s_add_u32 s35, s36, 33558528
  buffer_load_dwordx4 v10, s[8:11], s35 offen nt lds
  buffer_load_dwordx4 v11, s[8:11], s35 offen offset:1024 nt lds
  buffer_load_dwordx4 v10, s[8:11], s35 offen offset:2048 nt lds
  buffer_load_dwordx4 v11, s[8:11], s35 offen offset:3072 nt lds
  s_mov_b32 m0, 8192
  s_add_u32 s35, s36, 33562624
  buffer_load_dwordx4 v10, s[8:11], s35 offen nt lds
  buffer_load_dwordx4 v11, s[8:11], s35 offen offset:1024 nt lds
  buffer_load_dwordx4 v10, s[8:11], s35 offen offset:2048 nt lds
  buffer_load_dwordx4 v11, s[8:11], s35 offen offset:3072 nt lds
  s_mov_b32 m0, 12288
  s_add_u32 s35, s36, 33566720
  buffer_load_dwordx4 v10, s[8:11], s35 offen nt lds
  buffer_load_dwordx4 v11, s[8:11], s35 offen offset:1024 nt lds
  buffer_load_dwordx4 v10, s[8:11], s35 offen offset:2048 nt lds
  buffer_load_dwordx4 v11, s[8:11], s35 offen offset:3072 nt lds
  s_waitcnt vmcnt(40)
  s_barrier
  s_mov_b32 m0, 16384
  s_add_u32 s35, s36, 33570816
  buffer_load_dwordx4 v10, s[8:11], s35 offen nt lds
  buffer_load_dwordx4 v11, s[8:11], s35 offen offset:1024 nt lds
  buffer_load_dwordx4 v10, s[8:11], s35 offen offset:2048 nt lds
  buffer_load_dwordx4 v11, s[8:11], s35 offen offset:3072 nt lds
  s_mov_b32 m0, 20480
  s_add_u32 s35, s36, 33574912
  buffer_load_dwordx4 v10, s[8:11], s35 offen nt lds
  buffer_load_dwordx4 v11, s[8:11], s35 offen offset:1024 nt lds
  buffer_load_dwordx4 v10, s[8:11], s35 offen offset:2048 nt lds
  buffer_load_dwordx4 v11, s[8:11], s35 offen offset:3072 nt lds
  s_mov_b32 m0, 24576
  s_add_u32 s35, s36, 33579008
  buffer_load_dwordx4 v10, s[8:11], s35 offen nt lds
  buffer_load_dwordx4 v11, s[8:11], s35 offen offset:1024 nt lds
  buffer_load_dwordx4 v10, s[8:11], s35 offen offset:2048 nt lds
  buffer_load_dwordx4 v11, s[8:11], s35 offen offset:3072 nt lds
  s_mov_b32 m0, 28672
  s_add_u32 s35, s36, 33583104
  buffer_load_dwordx4 v10, s[8:11], s35 offen nt lds
  buffer_load_dwordx4 v11, s[8:11], s35 offen offset:1024 nt lds
  buffer_load_dwordx4 v10, s[8:11], s35 offen offset:2048 nt lds
  buffer_load_dwordx4 v11, s[8:11], s35 offen offset:3072 nt lds
  s_waitcnt vmcnt(32)
  s_barrier
  s_mov_b32 m0, 32768
  s_add_u32 s35, s36, 33587200
  buffer_load_dwordx4 v10, s[8:11], s35 offen nt lds
  buffer_load_dwordx4 v11, s[8:11], s35 offen offset:1024 nt lds
  buffer_load_dwordx4 v10, s[8:11], s35 offen offset:2048 nt lds
  buffer_load_dwordx4 v11, s[8:11], s35 offen offset:3072 nt lds
  s_mov_b32 m0, 36864
  s_add_u32 s35, s36, 33591296
  buffer_load_dwordx4 v10, s[8:11], s35 offen nt lds
  buffer_load_dwordx4 v11, s[8:11], s35 offen offset:1024 nt lds
  buffer_load_dwordx4 v10, s[8:11], s35 offen offset:2048 nt lds
  buffer_load_dwordx4 v11, s[8:11], s35 offen offset:3072 nt lds
  s_mov_b32 m0, 40960
  s_add_u32 s35, s36, 33595392
  buffer_load_dwordx4 v10, s[8:11], s35 offen nt lds
  buffer_load_dwordx4 v11, s[8:11], s35 offen offset:1024 nt lds
  buffer_load_dwordx4 v10, s[8:11], s35 offen offset:2048 nt lds
  buffer_load_dwordx4 v11, s[8:11], s35 offen offset:3072 nt lds
  s_mov_b32 m0, 45056
  s_add_u32 s35, s36, 33599488
  buffer_load_dwordx4 v10, s[8:11], s35 offen nt lds
  buffer_load_dwordx4 v11, s[8:11], s35 offen offset:1024 nt lds
  buffer_load_dwordx4 v10, s[8:11], s35 offen offset:2048 nt lds
  buffer_load_dwordx4 v11, s[8:11], s35 offen offset:3072 nt lds
  s_waitcnt vmcnt(32)
  s_barrier
  s_mov_b32 m0, 49152
  s_add_u32 s35, s36, 33603584
  buffer_load_dwordx4 v10, s[8:11], s35 offen nt lds
  buffer_load_dwordx4 v11, s[8:11], s35 offen offset:1024 nt lds
  buffer_load_dwordx4 v10, s[8:11], s35 offen offset:2048 nt lds
  buffer_load_dwordx4 v11, s[8:11], s35 offen offset:3072 nt lds
  s_mov_b32 m0, 53248
  s_add_u32 s35, s36, 33607680
  buffer_load_dwordx4 v10, s[8:11], s35 offen nt lds
  buffer_load_dwordx4 v11, s[8:11], s35 offen offset:1024 nt lds
  buffer_load_dwordx4 v10, s[8:11], s35 offen offset:2048 nt lds
  buffer_load_dwordx4 v11, s[8:11], s35 offen offset:3072 nt lds
  s_mov_b32 m0, 57344
  s_add_u32 s35, s36, 33611776
  buffer_load_dwordx4 v10, s[8:11], s35 offen nt lds
  buffer_load_dwordx4 v11, s[8:11], s35 offen offset:1024 nt lds
  buffer_load_dwordx4 v10, s[8:11], s35 offen offset:2048 nt lds
  buffer_load_dwordx4 v11, s[8:11], s35 offen offset:3072 nt lds
  s_mov_b32 m0, 61440
  s_add_u32 s35, s36, 33615872
  buffer_load_dwordx4 v10, s[8:11], s35 offen nt lds
  buffer_load_dwordx4 v11, s[8:11], s35 offen offset:1024 nt lds
  buffer_load_dwordx4 v10, s[8:11], s35 offen offset:2048 nt lds
  buffer_load_dwordx4 v11, s[8:11], s35 offen offset:3072 nt lds
  s_waitcnt vmcnt(32)
  s_barrier
  s_mov_b32 m0, 0
  s_add_u32 s35, s36, 33619968
  buffer_load_dwordx4 v10, s[8:11], s35 offen nt lds
  buffer_load_dwordx4 v11, s[8:11], s35 offen offset:1024 nt lds
  buffer_load_dwordx4 v10, s[8:11], s35 offen offset:2048 nt lds
  buffer_load_dwordx4 v11, s[8:11], s35 offen offset:3072 nt lds
  s_mov_b32 m0, 4096
  s_add_u32 s35, s36, 33624064
  buffer_load_dwordx4 v10, s[8:11], s35 offen nt lds
  buffer_load_dwordx4 v11, s[8:11], s35 offen offset:1024 nt lds
  buffer_load_dwordx4 v10, s[8:11], s35 offen offset:2048 nt lds
  buffer_load_dwordx4 v11, s[8:11], s35 offen offset:3072 nt lds
  s_mov_b32 m0, 8192
  s_add_u32 s35, s36, 33628160
  buffer_load_dwordx4 v10, s[8:11], s35 offen nt lds
  buffer_load_dwordx4 v11, s[8:11], s35 offen offset:1024 nt lds
  buffer_load_dwordx4 v10, s[8:11], s35 offen offset:2048 nt lds
  buffer_load_dwordx4 v11, s[8:11], s35 offen offset:3072 nt lds
  s_mov_b32 m0, 12288
  s_add_u32 s35, s36, 33632256
  buffer_load_dwordx4 v10, s[8:11], s35 offen nt lds
  buffer_load_dwordx4 v11, s[8:11], s35 offen offset:1024 nt lds
  buffer_load_dwordx4 v10, s[8:11], s35 offen offset:2048 nt lds
  buffer_load_dwordx4 v11, s[8:11], s35 offen offset:3072 nt lds
  s_waitcnt vmcnt(32)
  s_barrier
  s_mov_b32 m0, 16384
  s_add_u32 s35, s36, 33636352
  buffer_load_dwordx4 v10, s[8:11], s35 offen nt lds
  buffer_load_dwordx4 v11, s[8:11], s35 offen offset:1024 nt lds
  buffer_load_dwordx4 v10, s[8:11], s35 offen offset:2048 nt lds
  buffer_load_dwordx4 v11, s[8:11], s35 offen offset:3072 nt lds
  s_mov_b32 m0, 20480
  s_add_u32 s35, s36, 33640448
  buffer_load_dwordx4 v10, s[8:11], s35 offen nt lds
  buffer_load_dwordx4 v11, s[8:11], s35 offen offset:1024 nt lds
  buffer_load_dwordx4 v10, s[8:11], s35 offen offset:2048 nt lds
  buffer_load_dwordx4 v11, s[8:11], s35 offen offset:3072 nt lds
  s_mov_b32 m0, 24576
  s_add_u32 s35, s36, 33644544
  buffer_load_dwordx4 v10, s[8:11], s35 offen nt lds
  buffer_load_dwordx4 v11, s[8:11], s35 offen offset:1024 nt lds
  buffer_load_dwordx4 v10, s[8:11], s35 offen offset:2048 nt lds
  buffer_load_dwordx4 v11, s[8:11], s35 offen offset:3072 nt lds
  s_mov_b32 m0, 28672
  s_add_u32 s35, s36, 33648640
  buffer_load_dwordx4 v10, s[8:11], s35 offen nt lds
  buffer_load_dwordx4 v11, s[8:11], s35 offen offset:1024 nt lds
  buffer_load_dwordx4 v10, s[8:11], s35 offen offset:2048 nt lds
  buffer_load_dwordx4 v11, s[8:11], s35 offen offset:3072 nt lds
  s_waitcnt vmcnt(32)
  s_barrier
  s_mov_b32 m0, 32768
  s_add_u32 s35, s36, 33652736
  buffer_load_dwordx4 v10, s[8:11], s35 offen nt lds
  buffer_load_dwordx4 v11, s[8:11], s35 offen offset:1024 nt lds
  buffer_load_dwordx4 v10, s[8:11], s35 offen offset:2048 nt lds
  buffer_load_dwordx4 v11, s[8:11], s35 offen offset:3072 nt lds
  s_mov_b32 m0, 36864
  s_add_u32 s35, s36, 33656832
  buffer_load_dwordx4 v10, s[8:11], s35 offen nt lds
  buffer_load_dwordx4 v11, s[8:11], s35 offen offset:1024 nt lds
  buffer_load_dwordx4 v10, s[8:11], s35 offen offset:2048 nt lds
  buffer_load_dwordx4 v11, s[8:11], s35 offen offset:3072 nt lds
  s_mov_b32 m0, 40960
  s_add_u32 s35, s36, 33660928
  buffer_load_dwordx4 v10, s[8:11], s35 offen nt lds
  buffer_load_dwordx4 v11, s[8:11], s35 offen offset:1024 nt lds
  buffer_load_dwordx4 v10, s[8:11], s35 offen offset:2048 nt lds
  buffer_load_dwordx4 v11, s[8:11], s35 offen offset:3072 nt lds
  s_mov_b32 m0, 45056
  s_add_u32 s35, s36, 33665024
  buffer_load_dwordx4 v10, s[8:11], s35 offen nt lds
  buffer_load_dwordx4 v11, s[8:11], s35 offen offset:1024 nt lds
  buffer_load_dwordx4 v10, s[8:11], s35 offen offset:2048 nt lds
  buffer_load_dwordx4 v11, s[8:11], s35 offen offset:3072 nt lds
  s_waitcnt vmcnt(32)
  s_barrier
  s_mov_b32 m0, 49152
  s_add_u32 s35, s36, 33669120
  buffer_load_dwordx4 v10, s[8:11], s35 offen nt lds
  buffer_load_dwordx4 v11, s[8:11], s35 offen offset:1024 nt lds
  buffer_load_dwordx4 v10, s[8:11], s35 offen offset:2048 nt lds
  buffer_load_dwordx4 v11, s[8:11], s35 offen offset:3072 nt lds
  s_mov_b32 m0, 53248
  s_add_u32 s35, s36, 33673216
  buffer_load_dwordx4 v10, s[8:11], s35 offen nt lds
  buffer_load_dwordx4 v11, s[8:11], s35 offen offset:1024 nt lds
  buffer_load_dwordx4 v10, s[8:11], s35 offen offset:2048 nt lds
  buffer_load_dwordx4 v11, s[8:11], s35 offen offset:3072 nt lds
  s_mov_b32 m0, 57344
  s_add_u32 s35, s36, 33677312
  buffer_load_dwordx4 v10, s[8:11], s35 offen nt lds
  buffer_load_dwordx4 v11, s[8:11], s35 offen offset:1024 nt lds
  buffer_load_dwordx4 v10, s[8:11], s35 offen offset:2048 nt lds
  buffer_load_dwordx4 v11, s[8:11], s35 offen offset:3072 nt lds
  s_mov_b32 m0, 61440
  s_add_u32 s35, s36, 33681408
  buffer_load_dwordx4 v10, s[8:11], s35 offen nt lds
  buffer_load_dwordx4 v11, s[8:11], s35 offen offset:1024 nt lds
  buffer_load_dwordx4 v10, s[8:11], s35 offen offset:2048 nt lds
  buffer_load_dwordx4 v11, s[8:11], s35 offen offset:3072 nt lds
  s_waitcnt vmcnt(32)
  s_barrier
  s_mov_b32 m0, 0
  s_add_u32 s35, s36, 33685504
  buffer_load_dwordx4 v10, s[8:11], s35 offen nt lds
  buffer_load_dwordx4 v11, s[8:11], s35 offen offset:1024 nt lds
  buffer_load_dwordx4 v10, s[8:11], s35 offen offset:2048 nt lds
  buffer_load_dwordx4 v11, s[8:11], s35 offen offset:3072 nt lds
  s_mov_b32 m0, 4096
  s_add_u32 s35, s36, 33689600
  buffer_load_dwordx4 v10, s[8:11], s35 offen nt lds
  buffer_load_dwordx4 v11, s[8:11], s35 offen offset:1024 nt lds
  buffer_load_dwordx4 v10, s[8:11], s35 offen offset:2048 nt lds
  buffer_load_dwordx4 v11, s[8:11], s35 offen offset:3072 nt lds
  s_mov_b32 m0, 8192
  s_add_u32 s35, s36, 33693696
  buffer_load_dwordx4 v10, s[8:11], s35 offen nt lds
  buffer_load_dwordx4 v11, s[8:11], s35 offen offset:1024 nt lds
  buffer_load_dwordx4 v10, s[8:11], s35 offen offset:2048 nt lds
  buffer_load_dwordx4 v11, s[8:11], s35 offen offset:3072 nt lds
  s_mov_b32 m0, 12288
  s_add_u32 s35, s36, 33697792
  buffer_load_dwordx4 v10, s[8:11], s35 offen nt lds
  buffer_load_dwordx4 v11, s[8:11], s35 offen offset:1024 nt lds
  buffer_load_dwordx4 v10, s[8:11], s35 offen offset:2048 nt lds
  buffer_load_dwordx4 v11, s[8:11], s35 offen offset:3072 nt lds
  s_waitcnt vmcnt(32)
  s_barrier
  s_mov_b32 m0, 16384
  s_add_u32 s35, s36, 33701888
  buffer_load_dwordx4 v10, s[8:11], s35 offen nt lds
  buffer_load_dwordx4 v11, s[8:11], s35 offen offset:1024 nt lds
  buffer_load_dwordx4 v10, s[8:11], s35 offen offset:2048 nt lds
  buffer_load_dwordx4 v11, s[8:11], s35 offen offset:3072 nt lds
  s_mov_b32 m0, 20480
  s_add_u32 s35, s36, 33705984
  buffer_load_dwordx4 v10, s[8:11], s35 offen nt lds
  buffer_load_dwordx4 v11, s[8:11], s35 offen offset:1024 nt lds
  buffer_load_dwordx4 v10, s[8:11], s35 offen offset:2048 nt lds
  buffer_load_dwordx4 v11, s[8:11], s35 offen offset:3072 nt lds
  s_mov_b32 m0, 24576
  s_add_u32 s35, s36, 33710080
  buffer_load_dwordx4 v10, s[8:11], s35 offen nt lds
  buffer_load_dwordx4 v11, s[8:11], s35 offen offset:1024 nt lds
  buffer_load_dwordx4 v10, s[8:11], s35 offen offset:2048 nt lds
  buffer_load_dwordx4 v11, s[8:11], s35 offen offset:3072 nt lds
  s_mov_b32 m0, 28672
  s_add_u32 s35, s36, 33714176
  buffer_load_dwordx4 v10, s[8:11], s35 offen nt lds
  buffer_load_dwordx4 v11, s[8:11], s35 offen offset:1024 nt lds
  buffer_load_dwordx4 v10, s[8:11], s35 offen offset:2048 nt lds
  buffer_load_dwordx4 v11, s[8:11], s35 offen offset:3072 nt lds
  s_waitcnt vmcnt(32)
  s_barrier
  s_mov_b32 m0, 32768
  s_add_u32 s35, s36, 33718272
  buffer_load_dwordx4 v10, s[8:11], s35 offen nt lds
  buffer_load_dwordx4 v11, s[8:11], s35 offen offset:1024 nt lds
  buffer_load_dwordx4 v10, s[8:11], s35 offen offset:2048 nt lds
  buffer_load_dwordx4 v11, s[8:11], s35 offen offset:3072 nt lds
  s_mov_b32 m0, 36864
  s_add_u32 s35, s36, 33722368
  buffer_load_dwordx4 v10, s[8:11], s35 offen nt lds
  buffer_load_dwordx4 v11, s[8:11], s35 offen offset:1024 nt lds
  buffer_load_dwordx4 v10, s[8:11], s35 offen offset:2048 nt lds
  buffer_load_dwordx4 v11, s[8:11], s35 offen offset:3072 nt lds
  s_mov_b32 m0, 40960
  s_add_u32 s35, s36, 33726464
  buffer_load_dwordx4 v10, s[8:11], s35 offen nt lds
  buffer_load_dwordx4 v11, s[8:11], s35 offen offset:1024 nt lds
  buffer_load_dwordx4 v10, s[8:11], s35 offen offset:2048 nt lds
  buffer_load_dwordx4 v11, s[8:11], s35 offen offset:3072 nt lds
  s_mov_b32 m0, 45056
  s_add_u32 s35, s36, 33730560
  buffer_load_dwordx4 v10, s[8:11], s35 offen nt lds
  buffer_load_dwordx4 v11, s[8:11], s35 offen offset:1024 nt lds
  buffer_load_dwordx4 v10, s[8:11], s35 offen offset:2048 nt lds
  buffer_load_dwordx4 v11, s[8:11], s35 offen offset:3072 nt lds
  s_waitcnt vmcnt(32)
  s_barrier
  s_mov_b32 m0, 49152
  s_add_u32 s35, s36, 33734656
  buffer_load_dwordx4 v10, s[8:11], s35 offen nt lds
  buffer_load_dwordx4 v11, s[8:11], s35 offen offset:1024 nt lds
  buffer_load_dwordx4 v10, s[8:11], s35 offen offset:2048 nt lds
  buffer_load_dwordx4 v11, s[8:11], s35 offen offset:3072 nt lds
  s_mov_b32 m0, 53248
  s_add_u32 s35, s36, 33738752
  buffer_load_dwordx4 v10, s[8:11], s35 offen nt lds
  buffer_load_dwordx4 v11, s[8:11], s35 offen offset:1024 nt lds
  buffer_load_dwordx4 v10, s[8:11], s35 offen offset:2048 nt lds
  buffer_load_dwordx4 v11, s[8:11], s35 offen offset:3072 nt lds
  s_mov_b32 m0, 57344
  s_add_u32 s35, s36, 33742848
  buffer_load_dwordx4 v10, s[8:11], s35 offen nt lds
  buffer_load_dwordx4 v11, s[8:11], s35 offen offset:1024 nt lds
  buffer_load_dwordx4 v10, s[8:11], s35 offen offset:2048 nt lds
  buffer_load_dwordx4 v11, s[8:11], s35 offen offset:3072 nt lds
  s_mov_b32 m0, 61440
  s_add_u32 s35, s36, 33746944
  buffer_load_dwordx4 v10, s[8:11], s35 offen nt lds
  buffer_load_dwordx4 v11, s[8:11], s35 offen offset:1024 nt lds
  buffer_load_dwordx4 v10, s[8:11], s35 offen offset:2048 nt lds
  buffer_load_dwordx4 v11, s[8:11], s35 offen offset:3072 nt lds
  s_waitcnt vmcnt(32)
  s_barrier
  s_mov_b32 m0, 0
  s_add_u32 s35, s36, 33751040
  buffer_load_dwordx4 v10, s[8:11], s35 offen nt lds
  buffer_load_dwordx4 v11, s[8:11], s35 offen offset:1024 nt lds
  buffer_load_dwordx4 v10, s[8:11], s35 offen offset:2048 nt lds
  buffer_load_dwordx4 v11, s[8:11], s35 offen offset:3072 nt lds
  s_mov_b32 m0, 4096
  s_add_u32 s35, s36, 33755136
  buffer_load_dwordx4 v10, s[8:11], s35 offen nt lds
  buffer_load_dwordx4 v11, s[8:11], s35 offen offset:1024 nt lds
  buffer_load_dwordx4 v10, s[8:11], s35 offen offset:2048 nt lds
  buffer_load_dwordx4 v11, s[8:11], s35 offen offset:3072 nt lds
  s_mov_b32 m0, 8192
  s_add_u32 s35, s36, 33759232
  buffer_load_dwordx4 v10, s[8:11], s35 offen nt lds
  buffer_load_dwordx4 v11, s[8:11], s35 offen offset:1024 nt lds
  buffer_load_dwordx4 v10, s[8:11], s35 offen offset:2048 nt lds
  buffer_load_dwordx4 v11, s[8:11], s35 offen offset:3072 nt lds
  s_mov_b32 m0, 12288
  s_add_u32 s35, s36, 33763328
  buffer_load_dwordx4 v10, s[8:11], s35 offen nt lds
  buffer_load_dwordx4 v11, s[8:11], s35 offen offset:1024 nt lds
  buffer_load_dwordx4 v10, s[8:11], s35 offen offset:2048 nt lds
  buffer_load_dwordx4 v11, s[8:11], s35 offen offset:3072 nt lds
  s_waitcnt vmcnt(32)
  s_barrier
  s_mov_b32 m0, 16384
  s_add_u32 s35, s36, 33767424
  buffer_load_dwordx4 v10, s[8:11], s35 offen nt lds
  buffer_load_dwordx4 v11, s[8:11], s35 offen offset:1024 nt lds
  buffer_load_dwordx4 v10, s[8:11], s35 offen offset:2048 nt lds
  buffer_load_dwordx4 v11, s[8:11], s35 offen offset:3072 nt lds
  s_mov_b32 m0, 20480
  s_add_u32 s35, s36, 33771520
  buffer_load_dwordx4 v10, s[8:11], s35 offen nt lds
  buffer_load_dwordx4 v11, s[8:11], s35 offen offset:1024 nt lds
  buffer_load_dwordx4 v10, s[8:11], s35 offen offset:2048 nt lds
  buffer_load_dwordx4 v11, s[8:11], s35 offen offset:3072 nt lds
  s_mov_b32 m0, 24576
  s_add_u32 s35, s36, 33775616
  buffer_load_dwordx4 v10, s[8:11], s35 offen nt lds
  buffer_load_dwordx4 v11, s[8:11], s35 offen offset:1024 nt lds
  buffer_load_dwordx4 v10, s[8:11], s35 offen offset:2048 nt lds
  buffer_load_dwordx4 v11, s[8:11], s35 offen offset:3072 nt lds
  s_mov_b32 m0, 28672
  s_add_u32 s35, s36, 33779712
  buffer_load_dwordx4 v10, s[8:11], s35 offen nt lds
  buffer_load_dwordx4 v11, s[8:11], s35 offen offset:1024 nt lds
  buffer_load_dwordx4 v10, s[8:11], s35 offen offset:2048 nt lds
  buffer_load_dwordx4 v11, s[8:11], s35 offen offset:3072 nt lds
  s_waitcnt vmcnt(32)
  s_barrier
  s_mov_b32 m0, 32768
  s_add_u32 s35, s36, 33783808
  buffer_load_dwordx4 v10, s[8:11], s35 offen nt lds
  buffer_load_dwordx4 v11, s[8:11], s35 offen offset:1024 nt lds
  buffer_load_dwordx4 v10, s[8:11], s35 offen offset:2048 nt lds
  buffer_load_dwordx4 v11, s[8:11], s35 offen offset:3072 nt lds
  s_mov_b32 m0, 36864
  s_add_u32 s35, s36, 33787904
  buffer_load_dwordx4 v10, s[8:11], s35 offen nt lds
  buffer_load_dwordx4 v11, s[8:11], s35 offen offset:1024 nt lds
  buffer_load_dwordx4 v10, s[8:11], s35 offen offset:2048 nt lds
  buffer_load_dwordx4 v11, s[8:11], s35 offen offset:3072 nt lds
  s_mov_b32 m0, 40960
  s_add_u32 s35, s36, 33792000
  buffer_load_dwordx4 v10, s[8:11], s35 offen nt lds
  buffer_load_dwordx4 v11, s[8:11], s35 offen offset:1024 nt lds
  buffer_load_dwordx4 v10, s[8:11], s35 offen offset:2048 nt lds
  buffer_load_dwordx4 v11, s[8:11], s35 offen offset:3072 nt lds
  s_mov_b32 m0, 45056
  s_add_u32 s35, s36, 33796096
  buffer_load_dwordx4 v10, s[8:11], s35 offen nt lds
  buffer_load_dwordx4 v11, s[8:11], s35 offen offset:1024 nt lds
  buffer_load_dwordx4 v10, s[8:11], s35 offen offset:2048 nt lds
  buffer_load_dwordx4 v11, s[8:11], s35 offen offset:3072 nt lds
  s_waitcnt vmcnt(32)
  s_barrier
  s_mov_b32 m0, 49152
  s_add_u32 s35, s36, 33800192
  buffer_load_dwordx4 v10, s[8:11], s35 offen nt lds
  buffer_load_dwordx4 v11, s[8:11], s35 offen offset:1024 nt lds
  buffer_load_dwordx4 v10, s[8:11], s35 offen offset:2048 nt lds
  buffer_load_dwordx4 v11, s[8:11], s35 offen offset:3072 nt lds
  s_mov_b32 m0, 53248
  s_add_u32 s35, s36, 33804288
  buffer_load_dwordx4 v10, s[8:11], s35 offen nt lds
  buffer_load_dwordx4 v11, s[8:11], s35 offen offset:1024 nt lds
  buffer_load_dwordx4 v10, s[8:11], s35 offen offset:2048 nt lds
  buffer_load_dwordx4 v11, s[8:11], s35 offen offset:3072 nt lds
  s_mov_b32 m0, 57344
  s_add_u32 s35, s36, 33808384
  buffer_load_dwordx4 v10, s[8:11], s35 offen nt lds
  buffer_load_dwordx4 v11, s[8:11], s35 offen offset:1024 nt lds
  buffer_load_dwordx4 v10, s[8:11], s35 offen offset:2048 nt lds
  buffer_load_dwordx4 v11, s[8:11], s35 offen offset:3072 nt lds
  s_mov_b32 m0, 61440
  s_add_u32 s35, s36, 33812480
  buffer_load_dwordx4 v10, s[8:11], s35 offen nt lds
  buffer_load_dwordx4 v11, s[8:11], s35 offen offset:1024 nt lds
  buffer_load_dwordx4 v10, s[8:11], s35 offen offset:2048 nt lds
  buffer_load_dwordx4 v11, s[8:11], s35 offen offset:3072 nt lds
  s_waitcnt vmcnt(32)
  s_barrier
  s_lshl_b32 s4, s31, 1
  s_add_u32 s4, s4, 1
  s_and_b32 s4, s4, 7
  s_lshl_b32 s5, s62, 3
  s_add_u32 s4, s4, s5
  s_lshl_b32 s4, s4, 17
  s_lshl_b32 s5, s61, 7
  s_add_u32 s4, s4, s5
  s_mov_b32 m0, 147456
  s_add_u32 s35, s4, 0
  buffer_load_dwordx4 v14, s[48:51], s35 offen lds
  buffer_load_dwordx4 v15, s[48:51], s35 offen offset:1024 lds
  buffer_load_dwordx4 v16, s[48:51], s35 offen offset:2048 lds
  buffer_load_dwordx4 v17, s[48:51], s35 offen offset:3072 lds
  s_mov_b32 m0, 151552
  s_add_u32 s35, s4, 32768
  buffer_load_dwordx4 v14, s[48:51], s35 offen lds
  buffer_load_dwordx4 v15, s[48:51], s35 offen offset:1024 lds
  buffer_load_dwordx4 v16, s[48:51], s35 offen offset:2048 lds
  buffer_load_dwordx4 v17, s[48:51], s35 offen offset:3072 lds
  s_mov_b32 m0, 155648
  s_add_u32 s35, s4, 65536
  buffer_load_dwordx4 v14, s[48:51], s35 offen lds
  buffer_load_dwordx4 v15, s[48:51], s35 offen offset:1024 lds
  buffer_load_dwordx4 v16, s[48:51], s35 offen offset:2048 lds
  buffer_load_dwordx4 v17, s[48:51], s35 offen offset:3072 lds
  s_mov_b32 m0, 159744
  s_add_u32 s35, s4, 98304
  buffer_load_dwordx4 v14, s[48:51], s35 offen lds
  buffer_load_dwordx4 v15, s[48:51], s35 offen offset:1024 lds
  buffer_load_dwordx4 v16, s[48:51], s35 offen offset:2048 lds
  buffer_load_dwordx4 v17, s[48:51], s35 offen offset:3072 lds
  s_waitcnt vmcnt(32)
  s_barrier
  s_lshl_b32 s4, s31, 1
  s_add_u32 s4, s4, 2
  s_and_b32 s4, s4, 7
  s_lshl_b32 s5, s62, 3
  s_add_u32 s4, s4, s5
  s_lshl_b32 s4, s4, 17
  s_lshl_b32 s5, s61, 7
  s_add_u32 s4, s4, s5
  s_mov_b32 m0, 0
  s_add_u32 s35, s4, 0
  buffer_load_dwordx4 v14, s[48:51], s35 offen lds
  buffer_load_dwordx4 v15, s[48:51], s35 offen offset:1024 lds
  buffer_load_dwordx4 v16, s[48:51], s35 offen offset:2048 lds
  buffer_load_dwordx4 v17, s[48:51], s35 offen offset:3072 lds
  s_mov_b32 m0, 4096
  s_add_u32 s35, s4, 32768
  buffer_load_dwordx4 v14, s[48:51], s35 offen lds
  buffer_load_dwordx4 v15, s[48:51], s35 offen offset:1024 lds
  buffer_load_dwordx4 v16, s[48:51], s35 offen offset:2048 lds
  buffer_load_dwordx4 v17, s[48:51], s35 offen offset:3072 lds
  s_mov_b32 m0, 8192
  s_add_u32 s35, s4, 65536
  buffer_load_dwordx4 v14, s[48:51], s35 offen lds
  buffer_load_dwordx4 v15, s[48:51], s35 offen offset:1024 lds
  buffer_load_dwordx4 v16, s[48:51], s35 offen offset:2048 lds
  buffer_load_dwordx4 v17, s[48:51], s35 offen offset:3072 lds
  s_mov_b32 m0, 12288
  s_add_u32 s35, s4, 98304
  buffer_load_dwordx4 v14, s[48:51], s35 offen lds
  buffer_load_dwordx4 v15, s[48:51], s35 offen offset:1024 lds
  buffer_load_dwordx4 v16, s[48:51], s35 offen offset:2048 lds
  buffer_load_dwordx4 v17, s[48:51], s35 offen offset:3072 lds
  s_lshl_b32 s4, s31, 1
  s_add_u32 s4, s4, 3
  s_and_b32 s4, s4, 7
  s_lshl_b32 s5, s62, 3
  s_add_u32 s4, s4, s5
  s_lshl_b32 s4, s4, 17
  s_lshl_b32 s5, s61, 7
  s_add_u32 s4, s4, s5
  s_mov_b32 m0, 16384
  s_add_u32 s35, s4, 0
  buffer_load_dwordx4 v14, s[48:51], s35 offen lds
  buffer_load_dwordx4 v15, s[48:51], s35 offen offset:1024 lds
  buffer_load_dwordx4 v16, s[48:51], s35 offen offset:2048 lds
  buffer_load_dwordx4 v17, s[48:51], s35 offen offset:3072 lds
  s_mov_b32 m0, 20480
  s_add_u32 s35, s4, 32768
  buffer_load_dwordx4 v14, s[48:51], s35 offen lds
  buffer_load_dwordx4 v15, s[48:51], s35 offen offset:1024 lds
  buffer_load_dwordx4 v16, s[48:51], s35 offen offset:2048 lds
  buffer_load_dwordx4 v17, s[48:51], s35 offen offset:3072 lds
  s_mov_b32 m0, 24576
  s_add_u32 s35, s4, 65536
  buffer_load_dwordx4 v14, s[48:51], s35 offen lds
  buffer_load_dwordx4 v15, s[48:51], s35 offen offset:1024 lds
  buffer_load_dwordx4 v16, s[48:51], s35 offen offset:2048 lds
  buffer_load_dwordx4 v17, s[48:51], s35 offen offset:3072 lds
  s_mov_b32 m0, 28672
  s_add_u32 s35, s4, 98304
  buffer_load_dwordx4 v14, s[48:51], s35 offen lds
  buffer_load_dwordx4 v15, s[48:51], s35 offen offset:1024 lds
  buffer_load_dwordx4 v16, s[48:51], s35 offen offset:2048 lds
  buffer_load_dwordx4 v17, s[48:51], s35 offen offset:3072 lds
  s_waitcnt vmcnt(48)
  s_barrier
  s_lshl_b32 s4, s31, 1
  s_add_u32 s4, s4, 5
  s_and_b32 s4, s4, 7
  s_lshl_b32 s5, s62, 3
  s_add_u32 s4, s4, s5
  s_lshl_b32 s4, s4, 17
  s_lshl_b32 s5, s61, 7
  s_add_u32 s4, s4, s5
  s_mov_b32 m0, 32768
  s_add_u32 s35, s4, 0
  buffer_load_dwordx4 v14, s[48:51], s35 offen lds
  buffer_load_dwordx4 v15, s[48:51], s35 offen offset:1024 lds
  buffer_load_dwordx4 v16, s[48:51], s35 offen offset:2048 lds
  buffer_load_dwordx4 v17, s[48:51], s35 offen offset:3072 lds
  s_mov_b32 m0, 36864
  s_add_u32 s35, s4, 32768
  buffer_load_dwordx4 v14, s[48:51], s35 offen lds
  buffer_load_dwordx4 v15, s[48:51], s35 offen offset:1024 lds
  buffer_load_dwordx4 v16, s[48:51], s35 offen offset:2048 lds
  buffer_load_dwordx4 v17, s[48:51], s35 offen offset:3072 lds
  s_mov_b32 m0, 40960
  s_add_u32 s35, s4, 65536
  buffer_load_dwordx4 v14, s[48:51], s35 offen lds
  buffer_load_dwordx4 v15, s[48:51], s35 offen offset:1024 lds
  buffer_load_dwordx4 v16, s[48:51], s35 offen offset:2048 lds
  buffer_load_dwordx4 v17, s[48:51], s35 offen offset:3072 lds
  s_mov_b32 m0, 45056
  s_add_u32 s35, s4, 98304
  buffer_load_dwordx4 v14, s[48:51], s35 offen lds
  buffer_load_dwordx4 v15, s[48:51], s35 offen offset:1024 lds
  buffer_load_dwordx4 v16, s[48:51], s35 offen offset:2048 lds
  buffer_load_dwordx4 v17, s[48:51], s35 offen offset:3072 lds
  s_lshl_b32 s4, s31, 1
  s_add_u32 s4, s4, 7
  s_and_b32 s4, s4, 7
  s_lshl_b32 s5, s62, 3
  s_add_u32 s4, s4, s5
  s_lshl_b32 s4, s4, 17
  s_lshl_b32 s5, s61, 7
  s_add_u32 s4, s4, s5
  s_add_u32 s35, s4, 0
  buffer_load_dwordx4 v[24:27], v14, s[48:51], s35 offen
  buffer_load_dwordx4 v[28:31], v15, s[48:51], s35 offen offset:1024
  buffer_load_dwordx4 v[32:35], v16, s[48:51], s35 offen offset:2048
  buffer_load_dwordx4 v[36:39], v17, s[48:51], s35 offen offset:3072
  s_add_u32 s35, s4, 32768
  buffer_load_dwordx4 v[40:43], v14, s[48:51], s35 offen
  buffer_load_dwordx4 v[44:47], v15, s[48:51], s35 offen offset:1024
  buffer_load_dwordx4 v[48:51], v16, s[48:51], s35 offen offset:2048
  buffer_load_dwordx4 v[52:55], v17, s[48:51], s35 offen offset:3072
  s_add_u32 s35, s4, 65536
  buffer_load_dwordx4 v[56:59], v14, s[48:51], s35 offen
  buffer_load_dwordx4 v[60:63], v15, s[48:51], s35 offen offset:1024
  buffer_load_dwordx4 v[64:67], v16, s[48:51], s35 offen offset:2048
  buffer_load_dwordx4 v[68:71], v17, s[48:51], s35 offen offset:3072
  s_add_u32 s35, s4, 98304
  buffer_load_dwordx4 v[72:75], v14, s[48:51], s35 offen
  buffer_load_dwordx4 v[76:79], v15, s[48:51], s35 offen offset:1024
  buffer_load_dwordx4 v[80:83], v16, s[48:51], s35 offen offset:2048
  buffer_load_dwordx4 v[84:87], v17, s[48:51], s35 offen offset:3072
  s_barrier
  s_waitcnt vmcnt(0)
  ds_write_b128 v12, v[24:27] offset:49152
  ds_write_b128 v12, v[28:31] offset:50176
  ds_write_b128 v12, v[32:35] offset:51200
  ds_write_b128 v12, v[36:39] offset:52224
  ds_write_b128 v12, v[40:43] offset:53248
  ds_write_b128 v12, v[44:47] offset:54272
  ds_write_b128 v12, v[48:51] offset:55296
  ds_write_b128 v12, v[52:55] offset:56320
  ds_write_b128 v12, v[56:59] offset:57344
  ds_write_b128 v12, v[60:63] offset:58368
  ds_write_b128 v12, v[64:67] offset:59392
  ds_write_b128 v12, v[68:71] offset:60416
  ds_write_b128 v12, v[72:75] offset:61440
  ds_write_b128 v12, v[76:79] offset:62464
  ds_write_b128 v12, v[80:83] offset:63488
  ds_write_b128 v12, v[84:87] offset:64512
  s_waitcnt lgkmcnt(0)
  s_waitcnt vmcnt(16)
  s_barrier
  s_endpgm
L_loadV:
  v_add_u32 v12, 65536, v12
  s_barrier
  s_load_dwordx2 s[48:49], s[0:1], 32
  s_load_dwordx2 s[50:51], s[0:1], 72
  s_load_dwordx2 s[56:57], s[0:1], 88
  v_lshrrev_b32 v5, 3, v2
  v_lshlrev_b32 v5, 10, v5
  v_and_b32 v6, 7, v2
  v_lshlrev_b32 v7, 1, v3
  v_xor_b32 v6, v6, v7
  v_lshlrev_b32 v6, 4, v6
  v_add_u32 v14, v5, v6
  v_add_u32 v15, 7168, v14
  v_add_u32 v16, 14336, v14
  v_add_u32 v17, 21504, v14
  s_and_b32 s61, s30, 7
  s_lshr_b32 s62, s30, 3
  s_cmp_eq_u32 s29, 0
  s_waitcnt lgkmcnt(0)
  s_cselect_b64 s[48:49], s[48:49], s[50:51]
  s_mov_b32 s50, 0x400000
  s_mov_b32 s51, 0x20000
  s_barrier
  s_barrier
  s_load_dword s58, s[56:57], 0
  s_mov_b32 s63, 0x40000
  s_waitcnt lgkmcnt(0)
L_tagLX:
  s_cmp_lg_u32 s58, 0
  s_cbranch_scc1 L_tagxLX
  s_atomic_or s58, s[56:57], 0 glc
  s_sub_u32 s63, s63, 1
  s_cmp_lg_u32 s63, 0
  s_waitcnt lgkmcnt(0)
  s_cbranch_scc1 L_tagLX
L_tagxLX:
  s_not_b32 s59, s58
  s_and_b32 s4, s2, 7
  s_lshl_b32 s4, s4, 2
  s_add_u32 s4, s4, s31
  s_lshl_b32 s4, s4, 7
  s_add_u32 s87, s4, 48365568
  s_getreg_b32 s4, hwreg(HW_REG_XCC_ID, 0, 4)
  s_xor_b32 s83, s59, s4
  s_lshl_b32 s4, s61, 3
  s_add_u32 s4, s4, s87
  v_mov_b32 v8, s58
  v_mov_b32 v9, s83
  v_mov_b32 v13, 0
  s_nop 0
  buffer_store_dwordx2 v[8:9], v13, s[24:27], s4 offen sc1
  s_barrier
  s_barrier
  s_barrier
  s_mov_b32 m0, 73728
  s_add_u32 s35, s36, 0
  buffer_load_dwordx4 v10, s[12:15], s35 offen nt lds
  buffer_load_dwordx4 v11, s[12:15], s35 offen offset:1024 nt lds
  buffer_load_dwordx4 v10, s[12:15], s35 offen offset:2048 nt lds
  buffer_load_dwordx4 v11, s[12:15], s35 offen offset:3072 nt lds
  s_barrier
  s_mov_b32 m0, 77824
  s_add_u32 s35, s36, 4096
  buffer_load_dwordx4 v10, s[12:15], s35 offen nt lds
  buffer_load_dwordx4 v11, s[12:15], s35 offen offset:1024 nt lds
  buffer_load_dwordx4 v10, s[12:15], s35 offen offset:2048 nt lds
  buffer_load_dwordx4 v11, s[12:15], s35 offen offset:3072 nt lds
  s_barrier
  s_mov_b32 m0, 81920
  s_add_u32 s35, s36, 8192
  buffer_load_dwordx4 v10, s[12:15], s35 offen nt lds
  buffer_load_dwordx4 v11, s[12:15], s35 offen offset:1024 nt lds
  buffer_load_dwordx4 v10, s[12:15], s35 offen offset:2048 nt lds
  buffer_load_dwordx4 v11, s[12:15], s35 offen offset:3072 nt lds
  s_mov_b32 m0, 86016
  s_add_u32 s35, s36, 12288
  buffer_load_dwordx4 v10, s[12:15], s35 offen nt lds
  buffer_load_dwordx4 v11, s[12:15], s35 offen offset:1024 nt lds
  buffer_load_dwordx4 v10, s[12:15], s35 offen offset:2048 nt lds
  buffer_load_dwordx4 v11, s[12:15], s35 offen offset:3072 nt lds
  s_barrier
  s_mov_b32 m0, 90112
  s_add_u32 s35, s36, 16384
  buffer_load_dwordx4 v10, s[12:15], s35 offen nt lds
  buffer_load_dwordx4 v11, s[12:15], s35 offen offset:1024 nt lds
  buffer_load_dwordx4 v10, s[12:15], s35 offen offset:2048 nt lds
  buffer_load_dwordx4 v11, s[12:15], s35 offen offset:3072 nt lds
  s_mov_b32 m0, 94208
  s_add_u32 s35, s36, 20480
  buffer_load_dwordx4 v10, s[12:15], s35 offen nt lds
  buffer_load_dwordx4 v11, s[12:15], s35 offen offset:1024 nt lds
  buffer_load_dwordx4 v10, s[12:15], s35 offen offset:2048 nt lds
  buffer_load_dwordx4 v11, s[12:15], s35 offen offset:3072 nt lds
  s_waitcnt vmcnt(16)
  s_barrier
  s_mov_b32 m0, 98304
  s_add_u32 s35, s36, 24576
  buffer_load_dwordx4 v10, s[12:15], s35 offen nt lds
  buffer_load_dwordx4 v11, s[12:15], s35 offen offset:1024 nt lds
  buffer_load_dwordx4 v10, s[12:15], s35 offen offset:2048 nt lds
  buffer_load_dwordx4 v11, s[12:15], s35 offen offset:3072 nt lds
  s_mov_b32 m0, 102400
  s_add_u32 s35, s36, 28672
  buffer_load_dwordx4 v10, s[12:15], s35 offen nt lds
  buffer_load_dwordx4 v11, s[12:15], s35 offen offset:1024 nt lds
  buffer_load_dwordx4 v10, s[12:15], s35 offen offset:2048 nt lds
  buffer_load_dwordx4 v11, s[12:15], s35 offen offset:3072 nt lds
  s_mov_b32 m0, 106496
  s_add_u32 s35, s36, 32768
  buffer_load_dwordx4 v10, s[12:15], s35 offen nt lds
  buffer_load_dwordx4 v11, s[12:15], s35 offen offset:1024 nt lds
  buffer_load_dwordx4 v10, s[12:15], s35 offen offset:2048 nt lds
  buffer_load_dwordx4 v11, s[12:15], s35 offen offset:3072 nt lds
  s_mov_b32 m0, 110592
  s_add_u32 s35, s36, 36864
  buffer_load_dwordx4 v10, s[12:15], s35 offen nt lds
  buffer_load_dwordx4 v11, s[12:15], s35 offen offset:1024 nt lds
  buffer_load_dwordx4 v10, s[12:15], s35 offen offset:2048 nt lds
  buffer_load_dwordx4 v11, s[12:15], s35 offen offset:3072 nt lds
  s_waitcnt vmcnt(16)
  s_barrier
  s_mov_b32 m0, 114688
  s_add_u32 s35, s36, 40960
  buffer_load_dwordx4 v10, s[12:15], s35 offen nt lds
  buffer_load_dwordx4 v11, s[12:15], s35 offen offset:1024 nt lds
  buffer_load_dwordx4 v10, s[12:15], s35 offen offset:2048 nt lds
  buffer_load_dwordx4 v11, s[12:15], s35 offen offset:3072 nt lds
  s_mov_b32 m0, 118784
  s_add_u32 s35, s36, 45056
  buffer_load_dwordx4 v10, s[12:15], s35 offen nt lds
  buffer_load_dwordx4 v11, s[12:15], s35 offen offset:1024 nt lds
  buffer_load_dwordx4 v10, s[12:15], s35 offen offset:2048 nt lds
  buffer_load_dwordx4 v11, s[12:15], s35 offen offset:3072 nt lds
  s_mov_b32 m0, 122880
  s_add_u32 s35, s36, 49152
  buffer_load_dwordx4 v10, s[12:15], s35 offen nt lds
  buffer_load_dwordx4 v11, s[12:15], s35 offen offset:1024 nt lds
  buffer_load_dwordx4 v10, s[12:15], s35 offen offset:2048 nt lds
  buffer_load_dwordx4 v11, s[12:15], s35 offen offset:3072 nt lds
  s_mov_b32 m0, 126976
  s_add_u32 s35, s36, 53248
  buffer_load_dwordx4 v10, s[12:15], s35 offen nt lds
  buffer_load_dwordx4 v11, s[12:15], s35 offen offset:1024 nt lds
  buffer_load_dwordx4 v10, s[12:15], s35 offen offset:2048 nt lds
  buffer_load_dwordx4 v11, s[12:15], s35 offen offset:3072 nt lds
  s_mov_b32 m0, 65536
  s_add_u32 s35, s36, 57344
  buffer_load_dwordx4 v10, s[12:15], s35 offen nt lds
  buffer_load_dwordx4 v11, s[12:15], s35 offen offset:1024 nt lds
  buffer_load_dwordx4 v10, s[12:15], s35 offen offset:2048 nt lds
  buffer_load_dwordx4 v11, s[12:15], s35 offen offset:3072 nt lds
  s_mov_b32 m0, 69632
  s_add_u32 s35, s36, 61440
  buffer_load_dwordx4 v10, s[12:15], s35 offen nt lds
  buffer_load_dwordx4 v11, s[12:15], s35 offen offset:1024 nt lds
  buffer_load_dwordx4 v10, s[12:15], s35 offen offset:2048 nt lds
  buffer_load_dwordx4 v11, s[12:15], s35 offen offset:3072 nt lds
  s_mov_b32 m0, 73728
  s_add_u32 s35, s36, 65536
  buffer_load_dwordx4 v10, s[12:15], s35 offen nt lds
  buffer_load_dwordx4 v11, s[12:15], s35 offen offset:1024 nt lds
  buffer_load_dwordx4 v10, s[12:15], s35 offen offset:2048 nt lds
  buffer_load_dwordx4 v11, s[12:15], s35 offen offset:3072 nt lds
  s_mov_b32 m0, 77824
  s_add_u32 s35, s36, 69632
  buffer_load_dwordx4 v10, s[12:15], s35 offen nt lds
  buffer_load_dwordx4 v11, s[12:15], s35 offen offset:1024 nt lds
  buffer_load_dwordx4 v10, s[12:15], s35 offen offset:2048 nt lds
  buffer_load_dwordx4 v11, s[12:15], s35 offen offset:3072 nt lds
  s_waitcnt vmcnt(32)
  s_barrier
  s_mov_b32 m0, 81920
  s_add_u32 s35, s36, 73728
  buffer_load_dwordx4 v10, s[12:15], s35 offen nt lds
  buffer_load_dwordx4 v11, s[12:15], s35 offen offset:1024 nt lds
  buffer_load_dwordx4 v10, s[12:15], s35 offen offset:2048 nt lds
  buffer_load_dwordx4 v11, s[12:15], s35 offen offset:3072 nt lds
  s_mov_b32 m0, 86016
  s_add_u32 s35, s36, 77824
  buffer_load_dwordx4 v10, s[12:15], s35 offen nt lds
  buffer_load_dwordx4 v11, s[12:15], s35 offen offset:1024 nt lds
  buffer_load_dwordx4 v10, s[12:15], s35 offen offset:2048 nt lds
  buffer_load_dwordx4 v11, s[12:15], s35 offen offset:3072 nt lds
  s_mov_b32 m0, 90112
  s_add_u32 s35, s36, 81920
  buffer_load_dwordx4 v10, s[12:15], s35 offen nt lds
  buffer_load_dwordx4 v11, s[12:15], s35 offen offset:1024 nt lds
  buffer_load_dwordx4 v10, s[12:15], s35 offen offset:2048 nt lds
  buffer_load_dwordx4 v11, s[12:15], s35 offen offset:3072 nt lds
  s_mov_b32 m0, 94208
  s_add_u32 s35, s36, 86016
  buffer_load_dwordx4 v10, s[12:15], s35 offen nt lds
  buffer_load_dwordx4 v11, s[12:15], s35 offen offset:1024 nt lds
  buffer_load_dwordx4 v10, s[12:15], s35 offen offset:2048 nt lds
  buffer_load_dwordx4 v11, s[12:15], s35 offen offset:3072 nt lds
  s_waitcnt vmcnt(32)
  s_barrier
  s_mov_b32 m0, 98304
  s_add_u32 s35, s36, 90112
  buffer_load_dwordx4 v10, s[12:15], s35 offen nt lds
  buffer_load_dwordx4 v11, s[12:15], s35 offen offset:1024 nt lds
  buffer_load_dwordx4 v10, s[12:15], s35 offen offset:2048 nt lds
  buffer_load_dwordx4 v11, s[12:15], s35 offen offset:3072 nt lds
  s_mov_b32 m0, 102400
  s_add_u32 s35, s36, 94208
  buffer_load_dwordx4 v10, s[12:15], s35 offen nt lds
  buffer_load_dwordx4 v11, s[12:15], s35 offen offset:1024 nt lds
  buffer_load_dwordx4 v10, s[12:15], s35 offen offset:2048 nt lds
  buffer_load_dwordx4 v11, s[12:15], s35 offen offset:3072 nt lds
  s_mov_b32 m0, 106496
  s_add_u32 s35, s36, 98304
  buffer_load_dwordx4 v10, s[12:15], s35 offen nt lds
  buffer_load_dwordx4 v11, s[12:15], s35 offen offset:1024 nt lds
  buffer_load_dwordx4 v10, s[12:15], s35 offen offset:2048 nt lds
  buffer_load_dwordx4 v11, s[12:15], s35 offen offset:3072 nt lds
  s_mov_b32 m0, 110592
  s_add_u32 s35, s36, 102400
  buffer_load_dwordx4 v10, s[12:15], s35 offen nt lds
  buffer_load_dwordx4 v11, s[12:15], s35 offen offset:1024 nt lds
  buffer_load_dwordx4 v10, s[12:15], s35 offen offset:2048 nt lds
  buffer_load_dwordx4 v11, s[12:15], s35 offen offset:3072 nt lds
  s_waitcnt vmcnt(32)
  s_barrier
  s_mov_b32 m0, 114688
  s_add_u32 s35, s36, 106496
  buffer_load_dwordx4 v10, s[12:15], s35 offen nt lds
  buffer_load_dwordx4 v11, s[12:15], s35 offen offset:1024 nt lds
  buffer_load_dwordx4 v10, s[12:15], s35 offen offset:2048 nt lds
  buffer_load_dwordx4 v11, s[12:15], s35 offen offset:3072 nt lds
  s_mov_b32 m0, 118784
  s_add_u32 s35, s36, 110592
  buffer_load_dwordx4 v10, s[12:15], s35 offen nt lds
  buffer_load_dwordx4 v11, s[12:15], s35 offen offset:1024 nt lds
  buffer_load_dwordx4 v10, s[12:15], s35 offen offset:2048 nt lds
  buffer_load_dwordx4 v11, s[12:15], s35 offen offset:3072 nt lds
  s_mov_b32 m0, 122880
  s_add_u32 s35, s36, 114688
  buffer_load_dwordx4 v10, s[12:15], s35 offen nt lds
  buffer_load_dwordx4 v11, s[12:15], s35 offen offset:1024 nt lds
  buffer_load_dwordx4 v10, s[12:15], s35 offen offset:2048 nt lds
  buffer_load_dwordx4 v11, s[12:15], s35 offen offset:3072 nt lds
  s_mov_b32 m0, 126976
  s_add_u32 s35, s36, 118784
  buffer_load_dwordx4 v10, s[12:15], s35 offen nt lds
  buffer_load_dwordx4 v11, s[12:15], s35 offen offset:1024 nt lds
  buffer_load_dwordx4 v10, s[12:15], s35 offen offset:2048 nt lds
  buffer_load_dwordx4 v11, s[12:15], s35 offen offset:3072 nt lds
  s_waitcnt vmcnt(32)
  s_barrier
  s_mov_b32 m0, 65536
  s_add_u32 s35, s36, 122880
  buffer_load_dwordx4 v10, s[12:15], s35 offen nt lds
  buffer_load_dwordx4 v11, s[12:15], s35 offen offset:1024 nt lds
  buffer_load_dwordx4 v10, s[12:15], s35 offen offset:2048 nt lds
  buffer_load_dwordx4 v11, s[12:15], s35 offen offset:3072 nt lds
  s_mov_b32 m0, 69632
  s_add_u32 s35, s36, 126976
  buffer_load_dwordx4 v10, s[12:15], s35 offen nt lds
  buffer_load_dwordx4 v11, s[12:15], s35 offen offset:1024 nt lds
  buffer_load_dwordx4 v10, s[12:15], s35 offen offset:2048 nt lds
  buffer_load_dwordx4 v11, s[12:15], s35 offen offset:3072 nt lds
  s_mov_b32 m0, 73728
  s_add_u32 s35, s36, 131072
  buffer_load_dwordx4 v10, s[12:15], s35 offen nt lds
  buffer_load_dwordx4 v11, s[12:15], s35 offen offset:1024 nt lds
  buffer_load_dwordx4 v10, s[12:15], s35 offen offset:2048 nt lds
  buffer_load_dwordx4 v11, s[12:15], s35 offen offset:3072 nt lds
  s_mov_b32 m0, 77824
  s_add_u32 s35, s36, 135168
  buffer_load_dwordx4 v10, s[12:15], s35 offen nt lds
  buffer_load_dwordx4 v11, s[12:15], s35 offen offset:1024 nt lds
  buffer_load_dwordx4 v10, s[12:15], s35 offen offset:2048 nt lds
  buffer_load_dwordx4 v11, s[12:15], s35 offen offset:3072 nt lds
  s_waitcnt vmcnt(32)
  s_barrier
  s_mov_b32 m0, 81920
  s_add_u32 s35, s36, 139264
  buffer_load_dwordx4 v10, s[12:15], s35 offen nt lds
  buffer_load_dwordx4 v11, s[12:15], s35 offen offset:1024 nt lds
  buffer_load_dwordx4 v10, s[12:15], s35 offen offset:2048 nt lds
  buffer_load_dwordx4 v11, s[12:15], s35 offen offset:3072 nt lds
  s_mov_b32 m0, 86016
  s_add_u32 s35, s36, 143360
  buffer_load_dwordx4 v10, s[12:15], s35 offen nt lds
  buffer_load_dwordx4 v11, s[12:15], s35 offen offset:1024 nt lds
  buffer_load_dwordx4 v10, s[12:15], s35 offen offset:2048 nt lds
  buffer_load_dwordx4 v11, s[12:15], s35 offen offset:3072 nt lds
  s_mov_b32 m0, 90112
  s_add_u32 s35, s36, 147456
  buffer_load_dwordx4 v10, s[12:15], s35 offen nt lds
  buffer_load_dwordx4 v11, s[12:15], s35 offen offset:1024 nt lds
  buffer_load_dwordx4 v10, s[12:15], s35 offen offset:2048 nt lds
  buffer_load_dwordx4 v11, s[12:15], s35 offen offset:3072 nt lds
  s_mov_b32 m0, 94208
  s_add_u32 s35, s36, 151552
  buffer_load_dwordx4 v10, s[12:15], s35 offen nt lds
  buffer_load_dwordx4 v11, s[12:15], s35 offen offset:1024 nt lds
  buffer_load_dwordx4 v10, s[12:15], s35 offen offset:2048 nt lds
  buffer_load_dwordx4 v11, s[12:15], s35 offen offset:3072 nt lds
  s_waitcnt vmcnt(32)
  s_barrier
  s_mov_b32 m0, 98304
  s_add_u32 s35, s36, 155648
  buffer_load_dwordx4 v10, s[12:15], s35 offen nt lds
  buffer_load_dwordx4 v11, s[12:15], s35 offen offset:1024 nt lds
  buffer_load_dwordx4 v10, s[12:15], s35 offen offset:2048 nt lds
  buffer_load_dwordx4 v11, s[12:15], s35 offen offset:3072 nt lds
  s_mov_b32 m0, 102400
  s_add_u32 s35, s36, 159744
  buffer_load_dwordx4 v10, s[12:15], s35 offen nt lds
  buffer_load_dwordx4 v11, s[12:15], s35 offen offset:1024 nt lds
  buffer_load_dwordx4 v10, s[12:15], s35 offen offset:2048 nt lds
  buffer_load_dwordx4 v11, s[12:15], s35 offen offset:3072 nt lds
  s_mov_b32 m0, 106496
  s_add_u32 s35, s36, 163840
  buffer_load_dwordx4 v10, s[12:15], s35 offen nt lds
  buffer_load_dwordx4 v11, s[12:15], s35 offen offset:1024 nt lds
  buffer_load_dwordx4 v10, s[12:15], s35 offen offset:2048 nt lds
  buffer_load_dwordx4 v11, s[12:15], s35 offen offset:3072 nt lds
  s_mov_b32 m0, 110592
  s_add_u32 s35, s36, 167936
  buffer_load_dwordx4 v10, s[12:15], s35 offen nt lds
  buffer_load_dwordx4 v11, s[12:15], s35 offen offset:1024 nt lds
  buffer_load_dwordx4 v10, s[12:15], s35 offen offset:2048 nt lds
  buffer_load_dwordx4 v11, s[12:15], s35 offen offset:3072 nt lds
  s_waitcnt vmcnt(32)
  s_barrier
  s_mov_b32 m0, 114688
  s_add_u32 s35, s36, 172032
  buffer_load_dwordx4 v10, s[12:15], s35 offen nt lds
  buffer_load_dwordx4 v11, s[12:15], s35 offen offset:1024 nt lds
  buffer_load_dwordx4 v10, s[12:15], s35 offen offset:2048 nt lds
  buffer_load_dwordx4 v11, s[12:15], s35 offen offset:3072 nt lds
  s_mov_b32 m0, 118784
  s_add_u32 s35, s36, 176128
  buffer_load_dwordx4 v10, s[12:15], s35 offen nt lds
  buffer_load_dwordx4 v11, s[12:15], s35 offen offset:1024 nt lds
  buffer_load_dwordx4 v10, s[12:15], s35 offen offset:2048 nt lds
  buffer_load_dwordx4 v11, s[12:15], s35 offen offset:3072 nt lds
  s_mov_b32 m0, 122880
  s_add_u32 s35, s36, 180224
  buffer_load_dwordx4 v10, s[12:15], s35 offen nt lds
  buffer_load_dwordx4 v11, s[12:15], s35 offen offset:1024 nt lds
  buffer_load_dwordx4 v10, s[12:15], s35 offen offset:2048 nt lds
  buffer_load_dwordx4 v11, s[12:15], s35 offen offset:3072 nt lds
  s_mov_b32 m0, 126976
  s_add_u32 s35, s36, 184320
  buffer_load_dwordx4 v10, s[12:15], s35 offen nt lds
  buffer_load_dwordx4 v11, s[12:15], s35 offen offset:1024 nt lds
  buffer_load_dwordx4 v10, s[12:15], s35 offen offset:2048 nt lds
  buffer_load_dwordx4 v11, s[12:15], s35 offen offset:3072 nt lds
  s_waitcnt vmcnt(32)
  s_barrier
  s_mov_b32 m0, 65536
  s_add_u32 s35, s36, 188416
  buffer_load_dwordx4 v10, s[12:15], s35 offen nt lds
  buffer_load_dwordx4 v11, s[12:15], s35 offen offset:1024 nt lds
  buffer_load_dwordx4 v10, s[12:15], s35 offen offset:2048 nt lds
  buffer_load_dwordx4 v11, s[12:15], s35 offen offset:3072 nt lds
  s_mov_b32 m0, 69632
  s_add_u32 s35, s36, 192512
  buffer_load_dwordx4 v10, s[12:15], s35 offen nt lds
  buffer_load_dwordx4 v11, s[12:15], s35 offen offset:1024 nt lds
  buffer_load_dwordx4 v10, s[12:15], s35 offen offset:2048 nt lds
  buffer_load_dwordx4 v11, s[12:15], s35 offen offset:3072 nt lds
  s_mov_b32 m0, 73728
  s_add_u32 s35, s36, 196608
  buffer_load_dwordx4 v10, s[12:15], s35 offen nt lds
  buffer_load_dwordx4 v11, s[12:15], s35 offen offset:1024 nt lds
  buffer_load_dwordx4 v10, s[12:15], s35 offen offset:2048 nt lds
  buffer_load_dwordx4 v11, s[12:15], s35 offen offset:3072 nt lds
  s_mov_b32 m0, 77824
  s_add_u32 s35, s36, 200704
  buffer_load_dwordx4 v10, s[12:15], s35 offen nt lds
  buffer_load_dwordx4 v11, s[12:15], s35 offen offset:1024 nt lds
  buffer_load_dwordx4 v10, s[12:15], s35 offen offset:2048 nt lds
  buffer_load_dwordx4 v11, s[12:15], s35 offen offset:3072 nt lds
  s_waitcnt vmcnt(32)
  s_barrier
  s_mov_b32 m0, 81920
  s_add_u32 s35, s36, 204800
  buffer_load_dwordx4 v10, s[12:15], s35 offen nt lds
  buffer_load_dwordx4 v11, s[12:15], s35 offen offset:1024 nt lds
  buffer_load_dwordx4 v10, s[12:15], s35 offen offset:2048 nt lds
  buffer_load_dwordx4 v11, s[12:15], s35 offen offset:3072 nt lds
  s_mov_b32 m0, 86016
  s_add_u32 s35, s36, 208896
  buffer_load_dwordx4 v10, s[12:15], s35 offen nt lds
  buffer_load_dwordx4 v11, s[12:15], s35 offen offset:1024 nt lds
  buffer_load_dwordx4 v10, s[12:15], s35 offen offset:2048 nt lds
  buffer_load_dwordx4 v11, s[12:15], s35 offen offset:3072 nt lds
  s_mov_b32 m0, 90112
  s_add_u32 s35, s36, 212992
  buffer_load_dwordx4 v10, s[12:15], s35 offen nt lds
  buffer_load_dwordx4 v11, s[12:15], s35 offen offset:1024 nt lds
  buffer_load_dwordx4 v10, s[12:15], s35 offen offset:2048 nt lds
  buffer_load_dwordx4 v11, s[12:15], s35 offen offset:3072 nt lds
  s_mov_b32 m0, 94208
  s_add_u32 s35, s36, 217088
  buffer_load_dwordx4 v10, s[12:15], s35 offen nt lds
  buffer_load_dwordx4 v11, s[12:15], s35 offen offset:1024 nt lds
  buffer_load_dwordx4 v10, s[12:15], s35 offen offset:2048 nt lds
  buffer_load_dwordx4 v11, s[12:15], s35 offen offset:3072 nt lds
  s_waitcnt vmcnt(32)
  s_barrier
  s_mov_b32 m0, 98304
  s_add_u32 s35, s36, 221184
  buffer_load_dwordx4 v10, s[12:15], s35 offen nt lds
  buffer_load_dwordx4 v11, s[12:15], s35 offen offset:1024 nt lds
  buffer_load_dwordx4 v10, s[12:15], s35 offen offset:2048 nt lds
  buffer_load_dwordx4 v11, s[12:15], s35 offen offset:3072 nt lds
  s_mov_b32 m0, 102400
  s_add_u32 s35, s36, 225280
  buffer_load_dwordx4 v10, s[12:15], s35 offen nt lds
  buffer_load_dwordx4 v11, s[12:15], s35 offen offset:1024 nt lds
  buffer_load_dwordx4 v10, s[12:15], s35 offen offset:2048 nt lds
  buffer_load_dwordx4 v11, s[12:15], s35 offen offset:3072 nt lds
  s_mov_b32 m0, 106496
  s_add_u32 s35, s36, 229376
  buffer_load_dwordx4 v10, s[12:15], s35 offen nt lds
  buffer_load_dwordx4 v11, s[12:15], s35 offen offset:1024 nt lds
  buffer_load_dwordx4 v10, s[12:15], s35 offen offset:2048 nt lds
  buffer_load_dwordx4 v11, s[12:15], s35 offen offset:3072 nt lds
  s_mov_b32 m0, 110592
  s_add_u32 s35, s36, 233472
  buffer_load_dwordx4 v10, s[12:15], s35 offen nt lds
  buffer_load_dwordx4 v11, s[12:15], s35 offen offset:1024 nt lds
  buffer_load_dwordx4 v10, s[12:15], s35 offen offset:2048 nt lds
  buffer_load_dwordx4 v11, s[12:15], s35 offen offset:3072 nt lds
  s_waitcnt vmcnt(32)
  s_barrier
  s_mov_b32 m0, 114688
  s_add_u32 s35, s36, 237568
  buffer_load_dwordx4 v10, s[12:15], s35 offen nt lds
  buffer_load_dwordx4 v11, s[12:15], s35 offen offset:1024 nt lds
  buffer_load_dwordx4 v10, s[12:15], s35 offen offset:2048 nt lds
  buffer_load_dwordx4 v11, s[12:15], s35 offen offset:3072 nt lds
  s_mov_b32 m0, 118784
  s_add_u32 s35, s36, 241664
  buffer_load_dwordx4 v10, s[12:15], s35 offen nt lds
  buffer_load_dwordx4 v11, s[12:15], s35 offen offset:1024 nt lds
  buffer_load_dwordx4 v10, s[12:15], s35 offen offset:2048 nt lds
  buffer_load_dwordx4 v11, s[12:15], s35 offen offset:3072 nt lds
  s_mov_b32 m0, 122880
  s_add_u32 s35, s36, 245760
  buffer_load_dwordx4 v10, s[12:15], s35 offen nt lds
  buffer_load_dwordx4 v11, s[12:15], s35 offen offset:1024 nt lds
  buffer_load_dwordx4 v10, s[12:15], s35 offen offset:2048 nt lds
  buffer_load_dwordx4 v11, s[12:15], s35 offen offset:3072 nt lds
  s_mov_b32 m0, 126976
  s_add_u32 s35, s36, 249856
  buffer_load_dwordx4 v10, s[12:15], s35 offen nt lds
  buffer_load_dwordx4 v11, s[12:15], s35 offen offset:1024 nt lds
  buffer_load_dwordx4 v10, s[12:15], s35 offen offset:2048 nt lds
  buffer_load_dwordx4 v11, s[12:15], s35 offen offset:3072 nt lds
  s_waitcnt vmcnt(32)
  s_barrier
  s_mov_b32 m0, 65536
  s_add_u32 s35, s36, 253952
  buffer_load_dwordx4 v10, s[12:15], s35 offen nt lds
  buffer_load_dwordx4 v11, s[12:15], s35 offen offset:1024 nt lds
  buffer_load_dwordx4 v10, s[12:15], s35 offen offset:2048 nt lds
  buffer_load_dwordx4 v11, s[12:15], s35 offen offset:3072 nt lds
  s_mov_b32 m0, 69632
  s_add_u32 s35, s36, 258048
  buffer_load_dwordx4 v10, s[12:15], s35 offen nt lds
  buffer_load_dwordx4 v11, s[12:15], s35 offen offset:1024 nt lds
  buffer_load_dwordx4 v10, s[12:15], s35 offen offset:2048 nt lds
  buffer_load_dwordx4 v11, s[12:15], s35 offen offset:3072 nt lds
  s_mov_b32 m0, 73728
  s_add_u32 s35, s36, 33554432
  buffer_load_dwordx4 v10, s[12:15], s35 offen nt lds
  buffer_load_dwordx4 v11, s[12:15], s35 offen offset:1024 nt lds
  buffer_load_dwordx4 v10, s[12:15], s35 offen offset:2048 nt lds
  buffer_load_dwordx4 v11, s[12:15], s35 offen offset:3072 nt lds
  s_mov_b32 m0, 77824
  s_add_u32 s35, s36, 33558528
  buffer_load_dwordx4 v10, s[12:15], s35 offen nt lds
  buffer_load_dwordx4 v11, s[12:15], s35 offen offset:1024 nt lds
  buffer_load_dwordx4 v10, s[12:15], s35 offen offset:2048 nt lds
  buffer_load_dwordx4 v11, s[12:15], s35 offen offset:3072 nt lds
  s_waitcnt vmcnt(32)
  s_barrier
  s_mov_b32 m0, 81920
  s_add_u32 s35, s36, 33562624
  buffer_load_dwordx4 v10, s[12:15], s35 offen nt lds
  buffer_load_dwordx4 v11, s[12:15], s35 offen offset:1024 nt lds
  buffer_load_dwordx4 v10, s[12:15], s35 offen offset:2048 nt lds
  buffer_load_dwordx4 v11, s[12:15], s35 offen offset:3072 nt lds
  s_mov_b32 m0, 86016
  s_add_u32 s35, s36, 33566720
  buffer_load_dwordx4 v10, s[12:15], s35 offen nt lds
  buffer_load_dwordx4 v11, s[12:15], s35 offen offset:1024 nt lds
  buffer_load_dwordx4 v10, s[12:15], s35 offen offset:2048 nt lds
  buffer_load_dwordx4 v11, s[12:15], s35 offen offset:3072 nt lds
  s_mov_b32 m0, 90112
  s_add_u32 s35, s36, 33570816
  buffer_load_dwordx4 v10, s[12:15], s35 offen nt lds
  buffer_load_dwordx4 v11, s[12:15], s35 offen offset:1024 nt lds
  buffer_load_dwordx4 v10, s[12:15], s35 offen offset:2048 nt lds
  buffer_load_dwordx4 v11, s[12:15], s35 offen offset:3072 nt lds
  s_mov_b32 m0, 94208
  s_add_u32 s35, s36, 33574912
  buffer_load_dwordx4 v10, s[12:15], s35 offen nt lds
  buffer_load_dwordx4 v11, s[12:15], s35 offen offset:1024 nt lds
  buffer_load_dwordx4 v10, s[12:15], s35 offen offset:2048 nt lds
  buffer_load_dwordx4 v11, s[12:15], s35 offen offset:3072 nt lds
  s_waitcnt vmcnt(32)
  s_barrier
  s_mov_b32 m0, 98304
  s_add_u32 s35, s36, 33579008
  buffer_load_dwordx4 v10, s[12:15], s35 offen nt lds
  buffer_load_dwordx4 v11, s[12:15], s35 offen offset:1024 nt lds
  buffer_load_dwordx4 v10, s[12:15], s35 offen offset:2048 nt lds
  buffer_load_dwordx4 v11, s[12:15], s35 offen offset:3072 nt lds
  s_mov_b32 m0, 102400
  s_add_u32 s35, s36, 33583104
  buffer_load_dwordx4 v10, s[12:15], s35 offen nt lds
  buffer_load_dwordx4 v11, s[12:15], s35 offen offset:1024 nt lds
  buffer_load_dwordx4 v10, s[12:15], s35 offen offset:2048 nt lds
  buffer_load_dwordx4 v11, s[12:15], s35 offen offset:3072 nt lds
  s_mov_b32 m0, 106496
  s_add_u32 s35, s36, 33587200
  buffer_load_dwordx4 v10, s[12:15], s35 offen nt lds
  buffer_load_dwordx4 v11, s[12:15], s35 offen offset:1024 nt lds
  buffer_load_dwordx4 v10, s[12:15], s35 offen offset:2048 nt lds
  buffer_load_dwordx4 v11, s[12:15], s35 offen offset:3072 nt lds
  s_mov_b32 m0, 110592
  s_add_u32 s35, s36, 33591296
  buffer_load_dwordx4 v10, s[12:15], s35 offen nt lds
  buffer_load_dwordx4 v11, s[12:15], s35 offen offset:1024 nt lds
  buffer_load_dwordx4 v10, s[12:15], s35 offen offset:2048 nt lds
  buffer_load_dwordx4 v11, s[12:15], s35 offen offset:3072 nt lds
  s_waitcnt vmcnt(32)
  s_barrier
  s_mov_b32 m0, 114688
  s_add_u32 s35, s36, 33595392
  buffer_load_dwordx4 v10, s[12:15], s35 offen nt lds
  buffer_load_dwordx4 v11, s[12:15], s35 offen offset:1024 nt lds
  buffer_load_dwordx4 v10, s[12:15], s35 offen offset:2048 nt lds
  buffer_load_dwordx4 v11, s[12:15], s35 offen offset:3072 nt lds
  s_mov_b32 m0, 118784
  s_add_u32 s35, s36, 33599488
  buffer_load_dwordx4 v10, s[12:15], s35 offen nt lds
  buffer_load_dwordx4 v11, s[12:15], s35 offen offset:1024 nt lds
  buffer_load_dwordx4 v10, s[12:15], s35 offen offset:2048 nt lds
  buffer_load_dwordx4 v11, s[12:15], s35 offen offset:3072 nt lds
  s_mov_b32 m0, 122880
  s_add_u32 s35, s36, 33603584
  buffer_load_dwordx4 v10, s[12:15], s35 offen nt lds
  buffer_load_dwordx4 v11, s[12:15], s35 offen offset:1024 nt lds
  buffer_load_dwordx4 v10, s[12:15], s35 offen offset:2048 nt lds
  buffer_load_dwordx4 v11, s[12:15], s35 offen offset:3072 nt lds
  s_mov_b32 m0, 126976
  s_add_u32 s35, s36, 33607680
  buffer_load_dwordx4 v10, s[12:15], s35 offen nt lds
  buffer_load_dwordx4 v11, s[12:15], s35 offen offset:1024 nt lds
  buffer_load_dwordx4 v10, s[12:15], s35 offen offset:2048 nt lds
  buffer_load_dwordx4 v11, s[12:15], s35 offen offset:3072 nt lds
  s_waitcnt vmcnt(32)
  s_barrier
  s_mov_b32 m0, 65536
  s_add_u32 s35, s36, 33611776
  buffer_load_dwordx4 v10, s[12:15], s35 offen nt lds
  buffer_load_dwordx4 v11, s[12:15], s35 offen offset:1024 nt lds
  buffer_load_dwordx4 v10, s[12:15], s35 offen offset:2048 nt lds
  buffer_load_dwordx4 v11, s[12:15], s35 offen offset:3072 nt lds
  s_mov_b32 m0, 69632
  s_add_u32 s35, s36, 33615872
  buffer_load_dwordx4 v10, s[12:15], s35 offen nt lds
  buffer_load_dwordx4 v11, s[12:15], s35 offen offset:1024 nt lds
  buffer_load_dwordx4 v10, s[12:15], s35 offen offset:2048 nt lds
  buffer_load_dwordx4 v11, s[12:15], s35 offen offset:3072 nt lds
  s_mov_b32 m0, 73728
  s_add_u32 s35, s36, 33619968
  buffer_load_dwordx4 v10, s[12:15], s35 offen nt lds
  buffer_load_dwordx4 v11, s[12:15], s35 offen offset:1024 nt lds
  buffer_load_dwordx4 v10, s[12:15], s35 offen offset:2048 nt lds
  buffer_load_dwordx4 v11, s[12:15], s35 offen offset:3072 nt lds
  s_mov_b32 m0, 77824
  s_add_u32 s35, s36, 33624064
  buffer_load_dwordx4 v10, s[12:15], s35 offen nt lds
  buffer_load_dwordx4 v11, s[12:15], s35 offen offset:1024 nt lds
  buffer_load_dwordx4 v10, s[12:15], s35 offen offset:2048 nt lds
  buffer_load_dwordx4 v11, s[12:15], s35 offen offset:3072 nt lds
  s_waitcnt vmcnt(32)
  s_barrier
  s_mov_b32 m0, 81920
  s_add_u32 s35, s36, 33628160
  buffer_load_dwordx4 v10, s[12:15], s35 offen nt lds
  buffer_load_dwordx4 v11, s[12:15], s35 offen offset:1024 nt lds
  buffer_load_dwordx4 v10, s[12:15], s35 offen offset:2048 nt lds
  buffer_load_dwordx4 v11, s[12:15], s35 offen offset:3072 nt lds
  s_mov_b32 m0, 86016
  s_add_u32 s35, s36, 33632256
  buffer_load_dwordx4 v10, s[12:15], s35 offen nt lds
  buffer_load_dwordx4 v11, s[12:15], s35 offen offset:1024 nt lds
  buffer_load_dwordx4 v10, s[12:15], s35 offen offset:2048 nt lds
  buffer_load_dwordx4 v11, s[12:15], s35 offen offset:3072 nt lds
  s_mov_b32 m0, 90112
  s_add_u32 s35, s36, 33636352
  buffer_load_dwordx4 v10, s[12:15], s35 offen nt lds
  buffer_load_dwordx4 v11, s[12:15], s35 offen offset:1024 nt lds
  buffer_load_dwordx4 v10, s[12:15], s35 offen offset:2048 nt lds
  buffer_load_dwordx4 v11, s[12:15], s35 offen offset:3072 nt lds
  s_mov_b32 m0, 94208
  s_add_u32 s35, s36, 33640448
  buffer_load_dwordx4 v10, s[12:15], s35 offen nt lds
  buffer_load_dwordx4 v11, s[12:15], s35 offen offset:1024 nt lds
  buffer_load_dwordx4 v10, s[12:15], s35 offen offset:2048 nt lds
  buffer_load_dwordx4 v11, s[12:15], s35 offen offset:3072 nt lds
  s_waitcnt vmcnt(32)
  s_barrier
  s_mov_b32 m0, 98304
  s_add_u32 s35, s36, 33644544
  buffer_load_dwordx4 v10, s[12:15], s35 offen nt lds
  buffer_load_dwordx4 v11, s[12:15], s35 offen offset:1024 nt lds
  buffer_load_dwordx4 v10, s[12:15], s35 offen offset:2048 nt lds
  buffer_load_dwordx4 v11, s[12:15], s35 offen offset:3072 nt lds
  s_mov_b32 m0, 102400
  s_add_u32 s35, s36, 33648640
  buffer_load_dwordx4 v10, s[12:15], s35 offen nt lds
  buffer_load_dwordx4 v11, s[12:15], s35 offen offset:1024 nt lds
  buffer_load_dwordx4 v10, s[12:15], s35 offen offset:2048 nt lds
  buffer_load_dwordx4 v11, s[12:15], s35 offen offset:3072 nt lds
  s_mov_b32 m0, 106496
  s_add_u32 s35, s36, 33652736
  buffer_load_dwordx4 v10, s[12:15], s35 offen nt lds
  buffer_load_dwordx4 v11, s[12:15], s35 offen offset:1024 nt lds
  buffer_load_dwordx4 v10, s[12:15], s35 offen offset:2048 nt lds
  buffer_load_dwordx4 v11, s[12:15], s35 offen offset:3072 nt lds
  s_mov_b32 m0, 110592
  s_add_u32 s35, s36, 33656832
  buffer_load_dwordx4 v10, s[12:15], s35 offen nt lds
  buffer_load_dwordx4 v11, s[12:15], s35 offen offset:1024 nt lds
  buffer_load_dwordx4 v10, s[12:15], s35 offen offset:2048 nt lds
  buffer_load_dwordx4 v11, s[12:15], s35 offen offset:3072 nt lds
  s_waitcnt vmcnt(32)
  s_barrier
  s_mov_b32 m0, 114688
  s_add_u32 s35, s36, 33660928
  buffer_load_dwordx4 v10, s[12:15], s35 offen nt lds
  buffer_load_dwordx4 v11, s[12:15], s35 offen offset:1024 nt lds
  buffer_load_dwordx4 v10, s[12:15], s35 offen offset:2048 nt lds
  buffer_load_dwordx4 v11, s[12:15], s35 offen offset:3072 nt lds
  s_mov_b32 m0, 118784
  s_add_u32 s35, s36, 33665024
  buffer_load_dwordx4 v10, s[12:15], s35 offen nt lds
  buffer_load_dwordx4 v11, s[12:15], s35 offen offset:1024 nt lds
  buffer_load_dwordx4 v10, s[12:15], s35 offen offset:2048 nt lds
  buffer_load_dwordx4 v11, s[12:15], s35 offen offset:3072 nt lds
  s_mov_b32 m0, 122880
  s_add_u32 s35, s36, 33669120
  buffer_load_dwordx4 v10, s[12:15], s35 offen nt lds
  buffer_load_dwordx4 v11, s[12:15], s35 offen offset:1024 nt lds
  buffer_load_dwordx4 v10, s[12:15], s35 offen offset:2048 nt lds
  buffer_load_dwordx4 v11, s[12:15], s35 offen offset:3072 nt lds
  s_mov_b32 m0, 126976
  s_add_u32 s35, s36, 33673216
  buffer_load_dwordx4 v10, s[12:15], s35 offen nt lds
  buffer_load_dwordx4 v11, s[12:15], s35 offen offset:1024 nt lds
  buffer_load_dwordx4 v10, s[12:15], s35 offen offset:2048 nt lds
  buffer_load_dwordx4 v11, s[12:15], s35 offen offset:3072 nt lds
  s_waitcnt vmcnt(32)
  s_barrier
  s_mov_b32 m0, 65536
  s_add_u32 s35, s36, 33677312
  buffer_load_dwordx4 v10, s[12:15], s35 offen nt lds
  buffer_load_dwordx4 v11, s[12:15], s35 offen offset:1024 nt lds
  buffer_load_dwordx4 v10, s[12:15], s35 offen offset:2048 nt lds
  buffer_load_dwordx4 v11, s[12:15], s35 offen offset:3072 nt lds
  s_mov_b32 m0, 69632
  s_add_u32 s35, s36, 33681408
  buffer_load_dwordx4 v10, s[12:15], s35 offen nt lds
  buffer_load_dwordx4 v11, s[12:15], s35 offen offset:1024 nt lds
  buffer_load_dwordx4 v10, s[12:15], s35 offen offset:2048 nt lds
  buffer_load_dwordx4 v11, s[12:15], s35 offen offset:3072 nt lds
  s_mov_b32 m0, 73728
  s_add_u32 s35, s36, 33685504
  buffer_load_dwordx4 v10, s[12:15], s35 offen nt lds
  buffer_load_dwordx4 v11, s[12:15], s35 offen offset:1024 nt lds
  buffer_load_dwordx4 v10, s[12:15], s35 offen offset:2048 nt lds
  buffer_load_dwordx4 v11, s[12:15], s35 offen offset:3072 nt lds
  s_mov_b32 m0, 77824
  s_add_u32 s35, s36, 33689600
  buffer_load_dwordx4 v10, s[12:15], s35 offen nt lds
  buffer_load_dwordx4 v11, s[12:15], s35 offen offset:1024 nt lds
  buffer_load_dwordx4 v10, s[12:15], s35 offen offset:2048 nt lds
  buffer_load_dwordx4 v11, s[12:15], s35 offen offset:3072 nt lds
  s_waitcnt vmcnt(32)
  s_barrier
  s_mov_b32 m0, 81920
  s_add_u32 s35, s36, 33693696
  buffer_load_dwordx4 v10, s[12:15], s35 offen nt lds
  buffer_load_dwordx4 v11, s[12:15], s35 offen offset:1024 nt lds
  buffer_load_dwordx4 v10, s[12:15], s35 offen offset:2048 nt lds
  buffer_load_dwordx4 v11, s[12:15], s35 offen offset:3072 nt lds
  s_mov_b32 m0, 86016
  s_add_u32 s35, s36, 33697792
  buffer_load_dwordx4 v10, s[12:15], s35 offen nt lds
  buffer_load_dwordx4 v11, s[12:15], s35 offen offset:1024 nt lds
  buffer_load_dwordx4 v10, s[12:15], s35 offen offset:2048 nt lds
  buffer_load_dwordx4 v11, s[12:15], s35 offen offset:3072 nt lds
  s_mov_b32 m0, 90112
  s_add_u32 s35, s36, 33701888
  buffer_load_dwordx4 v10, s[12:15], s35 offen nt lds
  buffer_load_dwordx4 v11, s[12:15], s35 offen offset:1024 nt lds
  buffer_load_dwordx4 v10, s[12:15], s35 offen offset:2048 nt lds
  buffer_load_dwordx4 v11, s[12:15], s35 offen offset:3072 nt lds
  s_mov_b32 m0, 94208
  s_add_u32 s35, s36, 33705984
  buffer_load_dwordx4 v10, s[12:15], s35 offen nt lds
  buffer_load_dwordx4 v11, s[12:15], s35 offen offset:1024 nt lds
  buffer_load_dwordx4 v10, s[12:15], s35 offen offset:2048 nt lds
  buffer_load_dwordx4 v11, s[12:15], s35 offen offset:3072 nt lds
  s_waitcnt vmcnt(32)
  s_barrier
  s_mov_b32 m0, 98304
  s_add_u32 s35, s36, 33710080
  buffer_load_dwordx4 v10, s[12:15], s35 offen nt lds
  buffer_load_dwordx4 v11, s[12:15], s35 offen offset:1024 nt lds
  buffer_load_dwordx4 v10, s[12:15], s35 offen offset:2048 nt lds
  buffer_load_dwordx4 v11, s[12:15], s35 offen offset:3072 nt lds
  s_mov_b32 m0, 102400
  s_add_u32 s35, s36, 33714176
  buffer_load_dwordx4 v10, s[12:15], s35 offen nt lds
  buffer_load_dwordx4 v11, s[12:15], s35 offen offset:1024 nt lds
  buffer_load_dwordx4 v10, s[12:15], s35 offen offset:2048 nt lds
  buffer_load_dwordx4 v11, s[12:15], s35 offen offset:3072 nt lds
  s_mov_b32 m0, 106496
  s_add_u32 s35, s36, 33718272
  buffer_load_dwordx4 v10, s[12:15], s35 offen nt lds
  buffer_load_dwordx4 v11, s[12:15], s35 offen offset:1024 nt lds
  buffer_load_dwordx4 v10, s[12:15], s35 offen offset:2048 nt lds
  buffer_load_dwordx4 v11, s[12:15], s35 offen offset:3072 nt lds
  s_mov_b32 m0, 110592
  s_add_u32 s35, s36, 33722368
  buffer_load_dwordx4 v10, s[12:15], s35 offen nt lds
  buffer_load_dwordx4 v11, s[12:15], s35 offen offset:1024 nt lds
  buffer_load_dwordx4 v10, s[12:15], s35 offen offset:2048 nt lds
  buffer_load_dwordx4 v11, s[12:15], s35 offen offset:3072 nt lds
  s_waitcnt vmcnt(32)
  s_barrier
  s_mov_b32 m0, 114688
  s_add_u32 s35, s36, 33726464
  buffer_load_dwordx4 v10, s[12:15], s35 offen nt lds
  buffer_load_dwordx4 v11, s[12:15], s35 offen offset:1024 nt lds
  buffer_load_dwordx4 v10, s[12:15], s35 offen offset:2048 nt lds
  buffer_load_dwordx4 v11, s[12:15], s35 offen offset:3072 nt lds
  s_mov_b32 m0, 118784
  s_add_u32 s35, s36, 33730560
  buffer_load_dwordx4 v10, s[12:15], s35 offen nt lds
  buffer_load_dwordx4 v11, s[12:15], s35 offen offset:1024 nt lds
  buffer_load_dwordx4 v10, s[12:15], s35 offen offset:2048 nt lds
  buffer_load_dwordx4 v11, s[12:15], s35 offen offset:3072 nt lds
  s_mov_b32 m0, 122880
  s_add_u32 s35, s36, 33734656
  buffer_load_dwordx4 v10, s[12:15], s35 offen nt lds
  buffer_load_dwordx4 v11, s[12:15], s35 offen offset:1024 nt lds
  buffer_load_dwordx4 v10, s[12:15], s35 offen offset:2048 nt lds
  buffer_load_dwordx4 v11, s[12:15], s35 offen offset:3072 nt lds
  s_mov_b32 m0, 126976
  s_add_u32 s35, s36, 33738752
  buffer_load_dwordx4 v10, s[12:15], s35 offen nt lds
  buffer_load_dwordx4 v11, s[12:15], s35 offen offset:1024 nt lds
  buffer_load_dwordx4 v10, s[12:15], s35 offen offset:2048 nt lds
  buffer_load_dwordx4 v11, s[12:15], s35 offen offset:3072 nt lds
  s_waitcnt vmcnt(32)
  s_barrier
  s_mov_b32 m0, 65536
  s_add_u32 s35, s36, 33742848
  buffer_load_dwordx4 v10, s[12:15], s35 offen nt lds
  buffer_load_dwordx4 v11, s[12:15], s35 offen offset:1024 nt lds
  buffer_load_dwordx4 v10, s[12:15], s35 offen offset:2048 nt lds
  buffer_load_dwordx4 v11, s[12:15], s35 offen offset:3072 nt lds
  s_mov_b32 m0, 69632
  s_add_u32 s35, s36, 33746944
  buffer_load_dwordx4 v10, s[12:15], s35 offen nt lds
  buffer_load_dwordx4 v11, s[12:15], s35 offen offset:1024 nt lds
  buffer_load_dwordx4 v10, s[12:15], s35 offen offset:2048 nt lds
  buffer_load_dwordx4 v11, s[12:15], s35 offen offset:3072 nt lds
  s_mov_b32 m0, 73728
  s_add_u32 s35, s36, 33751040
  buffer_load_dwordx4 v10, s[12:15], s35 offen nt lds
  buffer_load_dwordx4 v11, s[12:15], s35 offen offset:1024 nt lds
  buffer_load_dwordx4 v10, s[12:15], s35 offen offset:2048 nt lds
  buffer_load_dwordx4 v11, s[12:15], s35 offen offset:3072 nt lds
  s_mov_b32 m0, 77824
  s_add_u32 s35, s36, 33755136
  buffer_load_dwordx4 v10, s[12:15], s35 offen nt lds
  buffer_load_dwordx4 v11, s[12:15], s35 offen offset:1024 nt lds
  buffer_load_dwordx4 v10, s[12:15], s35 offen offset:2048 nt lds
  buffer_load_dwordx4 v11, s[12:15], s35 offen offset:3072 nt lds
  s_waitcnt vmcnt(32)
  s_barrier
  s_mov_b32 m0, 81920
  s_add_u32 s35, s36, 33759232
  buffer_load_dwordx4 v10, s[12:15], s35 offen nt lds
  buffer_load_dwordx4 v11, s[12:15], s35 offen offset:1024 nt lds
  buffer_load_dwordx4 v10, s[12:15], s35 offen offset:2048 nt lds
  buffer_load_dwordx4 v11, s[12:15], s35 offen offset:3072 nt lds
  s_mov_b32 m0, 86016
  s_add_u32 s35, s36, 33763328
  buffer_load_dwordx4 v10, s[12:15], s35 offen nt lds
  buffer_load_dwordx4 v11, s[12:15], s35 offen offset:1024 nt lds
  buffer_load_dwordx4 v10, s[12:15], s35 offen offset:2048 nt lds
  buffer_load_dwordx4 v11, s[12:15], s35 offen offset:3072 nt lds
  s_mov_b32 m0, 90112
  s_add_u32 s35, s36, 33767424
  buffer_load_dwordx4 v10, s[12:15], s35 offen nt lds
  buffer_load_dwordx4 v11, s[12:15], s35 offen offset:1024 nt lds
  buffer_load_dwordx4 v10, s[12:15], s35 offen offset:2048 nt lds
  buffer_load_dwordx4 v11, s[12:15], s35 offen offset:3072 nt lds
  s_mov_b32 m0, 94208
  s_add_u32 s35, s36, 33771520
  buffer_load_dwordx4 v10, s[12:15], s35 offen nt lds
  buffer_load_dwordx4 v11, s[12:15], s35 offen offset:1024 nt lds
  buffer_load_dwordx4 v10, s[12:15], s35 offen offset:2048 nt lds
  buffer_load_dwordx4 v11, s[12:15], s35 offen offset:3072 nt lds
  s_waitcnt vmcnt(32)
  s_barrier
  s_mov_b32 m0, 98304
  s_add_u32 s35, s36, 33775616
  buffer_load_dwordx4 v10, s[12:15], s35 offen nt lds
  buffer_load_dwordx4 v11, s[12:15], s35 offen offset:1024 nt lds
  buffer_load_dwordx4 v10, s[12:15], s35 offen offset:2048 nt lds
  buffer_load_dwordx4 v11, s[12:15], s35 offen offset:3072 nt lds
  s_mov_b32 m0, 102400
  s_add_u32 s35, s36, 33779712
  buffer_load_dwordx4 v10, s[12:15], s35 offen nt lds
  buffer_load_dwordx4 v11, s[12:15], s35 offen offset:1024 nt lds
  buffer_load_dwordx4 v10, s[12:15], s35 offen offset:2048 nt lds
  buffer_load_dwordx4 v11, s[12:15], s35 offen offset:3072 nt lds
  s_mov_b32 m0, 106496
  s_add_u32 s35, s36, 33783808
  buffer_load_dwordx4 v10, s[12:15], s35 offen nt lds
  buffer_load_dwordx4 v11, s[12:15], s35 offen offset:1024 nt lds
  buffer_load_dwordx4 v10, s[12:15], s35 offen offset:2048 nt lds
  buffer_load_dwordx4 v11, s[12:15], s35 offen offset:3072 nt lds
  s_mov_b32 m0, 110592
  s_add_u32 s35, s36, 33787904
  buffer_load_dwordx4 v10, s[12:15], s35 offen nt lds
  buffer_load_dwordx4 v11, s[12:15], s35 offen offset:1024 nt lds
  buffer_load_dwordx4 v10, s[12:15], s35 offen offset:2048 nt lds
  buffer_load_dwordx4 v11, s[12:15], s35 offen offset:3072 nt lds
  s_waitcnt vmcnt(32)
  s_barrier
  s_mov_b32 m0, 114688
  s_add_u32 s35, s36, 33792000
  buffer_load_dwordx4 v10, s[12:15], s35 offen nt lds
  buffer_load_dwordx4 v11, s[12:15], s35 offen offset:1024 nt lds
  buffer_load_dwordx4 v10, s[12:15], s35 offen offset:2048 nt lds
  buffer_load_dwordx4 v11, s[12:15], s35 offen offset:3072 nt lds
  s_mov_b32 m0, 118784
  s_add_u32 s35, s36, 33796096
  buffer_load_dwordx4 v10, s[12:15], s35 offen nt lds
  buffer_load_dwordx4 v11, s[12:15], s35 offen offset:1024 nt lds
  buffer_load_dwordx4 v10, s[12:15], s35 offen offset:2048 nt lds
  buffer_load_dwordx4 v11, s[12:15], s35 offen offset:3072 nt lds
  s_mov_b32 m0, 122880
  s_add_u32 s35, s36, 33800192
  buffer_load_dwordx4 v10, s[12:15], s35 offen nt lds
  buffer_load_dwordx4 v11, s[12:15], s35 offen offset:1024 nt lds
  buffer_load_dwordx4 v10, s[12:15], s35 offen offset:2048 nt lds
  buffer_load_dwordx4 v11, s[12:15], s35 offen offset:3072 nt lds
  s_mov_b32 m0, 126976
  s_add_u32 s35, s36, 33804288
  buffer_load_dwordx4 v10, s[12:15], s35 offen nt lds
  buffer_load_dwordx4 v11, s[12:15], s35 offen offset:1024 nt lds
  buffer_load_dwordx4 v10, s[12:15], s35 offen offset:2048 nt lds
  buffer_load_dwordx4 v11, s[12:15], s35 offen offset:3072 nt lds
  s_waitcnt vmcnt(32)
  s_barrier
  s_mov_b32 m0, 65536
  s_add_u32 s35, s36, 33808384
  buffer_load_dwordx4 v10, s[12:15], s35 offen nt lds
  buffer_load_dwordx4 v11, s[12:15], s35 offen offset:1024 nt lds
  buffer_load_dwordx4 v10, s[12:15], s35 offen offset:2048 nt lds
  buffer_load_dwordx4 v11, s[12:15], s35 offen offset:3072 nt lds
  s_mov_b32 m0, 69632
  s_add_u32 s35, s36, 33812480
  buffer_load_dwordx4 v10, s[12:15], s35 offen nt lds
  buffer_load_dwordx4 v11, s[12:15], s35 offen offset:1024 nt lds
  buffer_load_dwordx4 v10, s[12:15], s35 offen offset:2048 nt lds
  buffer_load_dwordx4 v11, s[12:15], s35 offen offset:3072 nt lds
  s_lshl_b32 s4, s31, 1
  s_add_u32 s4, s4, 0
  s_and_b32 s4, s4, 7
  s_lshl_b32 s5, s62, 3
  s_add_u32 s4, s4, s5
  s_lshl_b32 s4, s4, 17
  s_lshl_b32 s5, s61, 7
  s_add_u32 s4, s4, s5
  s_mov_b32 m0, 131072
  s_add_u32 s35, s4, 0
  buffer_load_dwordx4 v14, s[48:51], s35 offen lds
  buffer_load_dwordx4 v15, s[48:51], s35 offen offset:1024 lds
  buffer_load_dwordx4 v16, s[48:51], s35 offen offset:2048 lds
  buffer_load_dwordx4 v17, s[48:51], s35 offen offset:3072 lds
  s_mov_b32 m0, 135168
  s_add_u32 s35, s4, 32768
  buffer_load_dwordx4 v14, s[48:51], s35 offen lds
  buffer_load_dwordx4 v15, s[48:51], s35 offen offset:1024 lds
  buffer_load_dwordx4 v16, s[48:51], s35 offen offset:2048 lds
  buffer_load_dwordx4 v17, s[48:51], s35 offen offset:3072 lds
  s_mov_b32 m0, 139264
  s_add_u32 s35, s4, 65536
  buffer_load_dwordx4 v14, s[48:51], s35 offen lds
  buffer_load_dwordx4 v15, s[48:51], s35 offen offset:1024 lds
  buffer_load_dwordx4 v16, s[48:51], s35 offen offset:2048 lds
  buffer_load_dwordx4 v17, s[48:51], s35 offen offset:3072 lds
  s_mov_b32 m0, 143360
  s_add_u32 s35, s4, 98304
  buffer_load_dwordx4 v14, s[48:51], s35 offen lds
  buffer_load_dwordx4 v15, s[48:51], s35 offen offset:1024 lds
  buffer_load_dwordx4 v16, s[48:51], s35 offen offset:2048 lds
  buffer_load_dwordx4 v17, s[48:51], s35 offen offset:3072 lds
  s_waitcnt vmcnt(40)
  s_barrier
  s_lshl_b32 s4, s31, 1
  s_add_u32 s4, s4, 4
  s_and_b32 s4, s4, 7
  s_lshl_b32 s5, s62, 3
  s_add_u32 s4, s4, s5
  s_lshl_b32 s4, s4, 17
  s_lshl_b32 s5, s61, 7
  s_add_u32 s4, s4, s5
  s_mov_b32 m0, 81920
  s_add_u32 s35, s4, 0
  buffer_load_dwordx4 v14, s[48:51], s35 offen lds
  buffer_load_dwordx4 v15, s[48:51], s35 offen offset:1024 lds
  buffer_load_dwordx4 v16, s[48:51], s35 offen offset:2048 lds
  buffer_load_dwordx4 v17, s[48:51], s35 offen offset:3072 lds
  s_mov_b32 m0, 86016
  s_add_u32 s35, s4, 32768
  buffer_load_dwordx4 v14, s[48:51], s35 offen lds
  buffer_load_dwordx4 v15, s[48:51], s35 offen offset:1024 lds
  buffer_load_dwordx4 v16, s[48:51], s35 offen offset:2048 lds
  buffer_load_dwordx4 v17, s[48:51], s35 offen offset:3072 lds
  s_mov_b32 m0, 90112
  s_add_u32 s35, s4, 65536
  buffer_load_dwordx4 v14, s[48:51], s35 offen lds
  buffer_load_dwordx4 v15, s[48:51], s35 offen offset:1024 lds
  buffer_load_dwordx4 v16, s[48:51], s35 offen offset:2048 lds
  buffer_load_dwordx4 v17, s[48:51], s35 offen offset:3072 lds
  s_mov_b32 m0, 94208
  s_add_u32 s35, s4, 98304
  buffer_load_dwordx4 v14, s[48:51], s35 offen lds
  buffer_load_dwordx4 v15, s[48:51], s35 offen offset:1024 lds
  buffer_load_dwordx4 v16, s[48:51], s35 offen offset:2048 lds
  buffer_load_dwordx4 v17, s[48:51], s35 offen offset:3072 lds
  s_waitcnt vmcnt(40)
  s_barrier
  s_lshl_b32 s4, s31, 1
  s_add_u32 s4, s4, 6
  s_and_b32 s4, s4, 7
  s_lshl_b32 s5, s62, 3
  s_add_u32 s4, s4, s5
  s_lshl_b32 s4, s4, 17
  s_lshl_b32 s5, s61, 7
  s_add_u32 s4, s4, s5
  s_mov_b32 m0, 98304
  s_add_u32 s35, s4, 0
  buffer_load_dwordx4 v14, s[48:51], s35 offen lds
  buffer_load_dwordx4 v15, s[48:51], s35 offen offset:1024 lds
  buffer_load_dwordx4 v16, s[48:51], s35 offen offset:2048 lds
  buffer_load_dwordx4 v17, s[48:51], s35 offen offset:3072 lds
  s_mov_b32 m0, 102400
  s_add_u32 s35, s4, 32768
  buffer_load_dwordx4 v14, s[48:51], s35 offen lds
  buffer_load_dwordx4 v15, s[48:51], s35 offen offset:1024 lds
  buffer_load_dwordx4 v16, s[48:51], s35 offen offset:2048 lds
  buffer_load_dwordx4 v17, s[48:51], s35 offen offset:3072 lds
  s_mov_b32 m0, 106496
  s_add_u32 s35, s4, 65536
  buffer_load_dwordx4 v14, s[48:51], s35 offen lds
  buffer_load_dwordx4 v15, s[48:51], s35 offen offset:1024 lds
  buffer_load_dwordx4 v16, s[48:51], s35 offen offset:2048 lds
  buffer_load_dwordx4 v17, s[48:51], s35 offen offset:3072 lds
  s_mov_b32 m0, 110592
  s_add_u32 s35, s4, 98304
  buffer_load_dwordx4 v14, s[48:51], s35 offen lds
  buffer_load_dwordx4 v15, s[48:51], s35 offen offset:1024 lds
  buffer_load_dwordx4 v16, s[48:51], s35 offen offset:2048 lds
  buffer_load_dwordx4 v17, s[48:51], s35 offen offset:3072 lds
  s_waitcnt vmcnt(48)
  s_barrier
  s_waitcnt vmcnt(0)
  s_barrier
  s_endpgm
L_end:
  s_endpgm
.section .rodata,"a"
.p2align 6
.amdhsa_kernel concat_heads__gqa_block_cached__gqa_block_cached__near_ridge_kernel
  .amdhsa_next_free_vgpr 256
  .amdhsa_next_free_sgpr 102
  .amdhsa_accum_offset 256
  .amdhsa_group_segment_fixed_size 0
  .amdhsa_kernarg_size 104
  .amdhsa_user_sgpr_count 2
  .amdhsa_user_sgpr_kernarg_segment_ptr 1
  .amdhsa_system_sgpr_workgroup_id_x 1
.end_amdhsa_kernel
.text
```
